```python
import torch

def _softmax(x, axis=-1):
    return torch.softmax(x, dim=axis)
def _gelu(x):
    return torch.nn.functional.gelu(x, approximate="tanh")
def _silu(x):
    return torch.nn.functional.silu(x)
def _sigmoid(x):
    return torch.sigmoid(x)
def _layernorm(x, axis=-1, eps=1e-5):
    m = x.mean(dim=axis, keepdim=True)
    v = x.var(dim=axis, keepdim=True, unbiased=False)
    return (x - m) / torch.sqrt(v + eps)
def _scatter_add(tgt, idx, src, axis=0):
    return tgt.clone().index_add_(axis, idx, src)
def _segment_sum(src, seg, n):
    out = torch.zeros((n,) + src.shape[1:], dtype=src.dtype)
    return out.index_add_(0, seg, src)
def _pad(x, pw):
    flat = tuple(v for pair in reversed(pw) for v in pair)
    return torch.nn.functional.pad(x, flat)

kernel_name = 'concat_heads__gqa_block_cached__mha_block_cached__near_ridge'

def setup_inputs():

    _w = (lambda a: (lambda t: t.to(torch.bfloat16) if t.is_floating_point() else t)(torch.as_tensor(a)))
    def _A_setup():
        B, Sq, D = 8, 112, 640
        Hq, Hkv, Sk, Dh = 32, 32, 512, 192
        assert Hq % Hkv == 0, (Hq, Hkv)
        return {
            "x": _w((lambda *s: torch.randn(*s, dtype=torch.bfloat16) * 0.8)(B, Sq, D)),
            "k_cache": _w((lambda *s: torch.randn(*s, dtype=torch.bfloat16) * 0.8)(B, Hkv, Sk, Dh)),
            "v_cache": _w((lambda *s: torch.randn(*s, dtype=torch.bfloat16) * 0.05)(B, Hkv, Sk, Dh)),
            "wq": _w((lambda *s: torch.randn(*s, dtype=torch.bfloat16) * 0.8)(D, Hq * Dh) * (D ** -0.5)),
            "wo": _w((lambda *s: torch.randn(*s, dtype=torch.bfloat16) * 0.05)(Hq * Dh, D) * ((Hq * Dh) ** -0.5)),
        }
    _A_in = _A_setup()

    def _B_setup():
        B, Sq, D = 8, 112, 640
        H, Sk, Dh = 32, 512, 192
        return {
            "x": _w((lambda *s: torch.randn(*s, dtype=torch.bfloat16) * 0.8)(B, Sq, D)),
            "k_cache": _w((lambda *s: torch.randn(*s, dtype=torch.bfloat16) * 0.8)(B, H, Sk, Dh)),
            "v_cache": _w((lambda *s: torch.randn(*s, dtype=torch.bfloat16) * 0.05)(B, H, Sk, Dh)),
            "wq": _w((lambda *s: torch.randn(*s, dtype=torch.bfloat16) * 0.8)(D, H * Dh) * (D ** -0.5)),
            "wo": _w((lambda *s: torch.randn(*s, dtype=torch.bfloat16) * 0.05)(H * Dh, D) * ((H * Dh) ** -0.5)),
        }
    _B_in = _B_setup()

    return {
        "A_x": _A_in["x"],
        "A_k_cache": _A_in["k_cache"],
        "A_v_cache": _A_in["v_cache"],
        "A_wq": _A_in["wq"],
        "A_wo": _A_in["wo"],
        "B_x": _B_in["x"],
        "B_k_cache": _B_in["k_cache"],
        "B_v_cache": _B_in["v_cache"],
        "B_wq": _B_in["wq"],
        "B_wo": _B_in["wo"],
    }

def reference(A_x, A_k_cache, A_v_cache, A_wq, A_wo, B_x, B_k_cache, B_v_cache, B_wq, B_wo):
    def _A_ref(x, k_cache, v_cache, wq, wo):
        B, Sq, D = x.shape
        Hq, Dh = 32, 192
        Hkv = k_cache.shape[1]
        rep = Hq // Hkv
        q = (lambda x, *d: x.permute(*d))((x @ wq).reshape(B, Sq, Hq, Dh), 0, 2, 1, 3)
        k = (lambda x, n, axis: torch.repeat_interleave(x, n, dim=axis))(k_cache, rep, axis=1)
        v = (lambda x, n, axis: torch.repeat_interleave(x, n, dim=axis))(v_cache, rep, axis=1)
        scores = torch.einsum("bhqd,bhkd->bhqk", q, k) * (Dh ** -0.5)
        p = _softmax(scores, axis=-1)
        o = torch.einsum("bhqk,bhkd->bhqd", p, v)
        return (lambda x, *d: x.permute(*d))(o, 0, 2, 1, 3).reshape(B, Sq, Hq * Dh) @ wo

    def _B_ref(x, k_cache, v_cache, wq, wo):
        B, Sq, D = x.shape
        H, Dh = 32, 192
        q = (lambda x, *d: x.permute(*d))((x @ wq).reshape(B, Sq, H, Dh), 0, 2, 1, 3)
        scores = torch.einsum("bhqd,bhkd->bhqk", q, k_cache) * (Dh ** -0.5)
        p = _softmax(scores, axis=-1)
        o = torch.einsum("bhqk,bhkd->bhqd", p, v_cache)
        return (lambda x, *d: x.permute(*d))(o, 0, 2, 1, 3).reshape(B, Sq, H * Dh) @ wo

    a = _A_ref(A_x, A_k_cache, A_v_cache, A_wq, A_wo)
    b = _B_ref(B_x, B_k_cache, B_v_cache, B_wq, B_wo)
    return torch.concatenate([a, b], axis=-1)
```

```asm
; @launch grid=(256,1,1) block=(512,1,1) lds=163840
.amdgcn_target "amdgcn-amd-amdhsa--gfx950"
.text
.globl concat_heads__gqa_block_cached__mha_block_cached__near_ridge_kernel
.p2align 8
.type concat_heads__gqa_block_cached__mha_block_cached__near_ridge_kernel,@function
concat_heads__gqa_block_cached__mha_block_cached__near_ridge_kernel:
    s_cmp_ge_u32 s2, 256
    s_cbranch_scc1 K1_done
    s_load_dwordx16 s[16:31], s[0:1], 0
    s_load_dwordx8 s[32:39], s[0:1], 64
    s_load_dwordx2 s[40:41], s[0:1], 96
    v_lshrrev_b32 v1, 6, v0
    v_and_b32 v0, 63, v0
    v_readfirstlane_b32 s3, v1
    s_bfe_u32 s92, s2, 0x10002
    s_and_b32 s76, s2, 3
    s_bfe_u32 s82, s2, 0x20003
    s_lshr_b32 s75, s2, 5
    s_lshr_b32 s14, s2, 6
    s_sub_u32 s14, s82, s14
    s_and_b32 s14, s14, 3
    s_lshl_b32 s90, s92, 3
    s_add_u32 s90, s90, s75
    s_lshl_b32 s78, s76, 2
    s_add_u32 s78, s78, s82
    s_lshl_b32 s91, s90, 4
    s_add_u32 s91, s91, s78
    s_lshl_b32 s77, s91, 1
    s_mov_b32 s94, 0x3dd53b95
    s_mov_b32 s95, 0x3dd53b95
    s_and_b32 s73, s3, 3
    s_mul_i32 s81, s73, 3072
    s_lshl_b32 s73, s73, 11
    v_and_b32 v1, 31, v0
    v_lshrrev_b32 v2, 5, v0
    v_lshlrev_b32 v11, 4, v0
    v_add_u32 v11, s73, v11
    s_cmp_eq_u32 s73, 6144
    s_cselect_b32 s13, 0x40000000, 0
    s_mul_i32 s89, s75, 143360
    s_mul_i32 s67, s76, 1966080
    s_mul_i32 s74, s14, 320
    s_add_u32 s67, s67, s74
    s_lshl_b32 s73, s90, 2
    s_add_u32 s73, s73, s76
    s_mul_i32 s68, s73, 393216
    s_waitcnt lgkmcnt(0)
    s_cmp_eq_u32 s92, 0
    s_cselect_b64 s[16:17], s[16:17], s[26:27]
    s_cselect_b64 s[18:19], s[18:19], s[28:29]
    s_cselect_b64 s[20:21], s[20:21], s[30:31]
    s_cselect_b64 s[22:23], s[22:23], s[32:33]
    s_cselect_b64 s[24:25], s[24:25], s[34:35]
    s_mov_b32 s44, s22
    s_and_b32 s45, s23, 0xffff
    s_mov_b32 s46, 0x780000
    s_mov_b32 s47, 0x20000
    s_mov_b32 s48, s16
    s_and_b32 s49, s17, 0xffff
    s_mov_b32 s50, 0x118000
    s_mov_b32 s51, 0x20000
    s_mov_b32 s60, s40
    s_and_b32 s61, s41, 0xffff
    s_mov_b32 s62, 0x4000000
    s_mov_b32 s63, 0x20000
    s_mov_b32 s52, s18
    s_and_b32 s53, s19, 0xffff
    s_mov_b32 s54, 0x3000000
    s_mov_b32 s55, 0x20000
    s_mov_b32 s56, s20
    s_and_b32 s57, s21, 0xffff
    s_mov_b32 s58, 0x3000000
    s_mov_b32 s59, 0x20000
    s_lshl_b32 s79, s75, 4
    s_add_u32 s79, s79, s78
    s_mul_i32 s79, s79, 393216
    s_add_u32 s88, s79, 196608
    s_mov_b32 s9, s88
    s_lshr_b32 s73, s2, 4
    s_xor_b32 s12, s73, s2
    s_cmp_ge_u32 s3, 4
    s_cselect_b32 s73, 4, 0
    s_cselect_b32 s74, 4, 0
    s_add_u32 s73, s73, s12
    s_add_u32 s74, s74, s12
    s_and_b32 s73, s73, 15
    s_and_b32 s74, s74, 15
    s_mul_i32 s73, s73, 12288
    s_mul_i32 s74, s74, 12288
    s_add_u32 s80, s79, s74
    s_add_u32 s79, s79, s73
    s_cmp_ge_u32 s3, 4
    s_cbranch_scc1 K1_G
    s_lshr_b32 s73, s75, 2
    s_mul_i32 s73, s73, 5
    s_mul_i32 s74, s82, 3
    s_add_u32 s73, s73, s74
    s_add_u32 s73, s73, 4
    s_cmp_ge_u32 s73, 10
    s_cselect_b32 s74, 10, 0
    s_sub_u32 s73, s73, s74
    s_lshl_b32 s73, s73, 2
    s_and_b32 s74, s75, 3
    s_add_u32 s73, s73, s74
    s_lshl_b32 s73, s73, 2
    s_add_u32 s73, s73, s3
    s_mul_i32 s73, s73, 49152
    s_mul_i32 s74, s78, 768
    s_add_u32 s73, s73, s74
    v_lshrrev_b32 v3, 4, v0
    v_mul_u32_u24 v3, 0x3000, v3
    v_and_b32 v4, 15, v0
    v_lshl_add_u32 v3, v4, 4, v3
    buffer_load_dwordx4 v[152:155], v3, s[44:47], s73 offen offset:0
    buffer_load_dwordx4 v[152:155], v3, s[44:47], s73 offen offset:256
    buffer_load_dwordx4 v[152:155], v3, s[44:47], s73 offen offset:512
    s_mov_b32 s84, s38
    s_and_b32 s85, s39, 0xffff
    s_mov_b32 s86, 0x100
    s_mov_b32 s87, 0x20000
    v_lshrrev_b32 v2, 4, v0
    v_bfe_u32 v3, v0, 2, 2
    v_lshl_add_u32 v4, v2, 3, v3
    v_mul_u32_u24 v4, 0x180, v4
    v_and_b32 v3, 2, v3
    v_and_b32 v5, 1, v2
    v_or_b32 v3, v3, v5
    v_bfe_u32 v5, v0, 1, 1
    v_lshl_or_b32 v3, v3, 1, v5
    v_lshl_add_u32 v4, v3, 4, v4
    v_and_b32 v5, 1, v0
    v_lshl_add_u32 v4, v5, 3, v4
    s_and_b32 s73, s3, 3
    s_mul_i32 s73, s73, 96
    s_and_b32 s74, s73, 96
    v_xor_b32 v44, s74, v4
    s_andn2_b32 s74, s73, 127
    s_add_u32 s74, s74, 0
    v_add_u32 v44, s74, v44
    v_add_u32 v47, 0xc000, v44
    s_add_u32 s73, s73, 32
    s_and_b32 s74, s73, 96
    v_xor_b32 v45, s74, v4
    s_andn2_b32 s74, s73, 127
    s_add_u32 s74, s74, 0
    v_add_u32 v45, s74, v45
    v_add_u32 v48, 0xc000, v45
    s_add_u32 s73, s73, 32
    s_and_b32 s74, s73, 96
    v_xor_b32 v46, s74, v4
    s_andn2_b32 s74, s73, 127
    s_add_u32 s74, s74, 0
    v_add_u32 v46, s74, v46
    v_add_u32 v49, 0xc000, v46
    s_add_u32 s73, s73, 32
    v_and_b32 v3, 15, v0
    v_lshrrev_b32 v5, 1, v3
    v_xor_b32 v5, v5, v2
    v_lshlrev_b32 v5, 4, v5
    v_lshl_add_u32 v5, v3, 7, v5
    v_add_u32 v52, 0x18000, v5
    v_xor_b32 v53, 64, v52
    v_add_u32 v50, 0x8000, v52
    v_add_u32 v51, 0x8000, v53
    v_bfe_u32 v3, v0, 2, 1
    v_bfe_u32 v7, v0, 3, 1
    v_lshl_or_b32 v3, v3, 1, v7
    v_lshrrev_b32 v4, 1, v3
    v_xor_b32 v3, v3, v4
    v_bfe_u32 v4, v0, 4, 1
    v_bfe_u32 v7, v0, 5, 1
    v_lshl_or_b32 v4, v4, 1, v7
    v_and_b32 v5, 3, v0
    v_lshl_add_u32 v5, v3, 2, v5
    v_mul_u32_u24 v5, 0x180, v5
    v_and_b32 v6, 2, v0
    v_lshl_or_b32 v6, v6, 1, v3
    v_xor_b32 v6, v6, v4
    v_lshl_add_u32 v12, v6, 4, v5
    v_xor_b32 v13, 64, v12
    v_lshrrev_b32 v5, 1, v4
    v_xor_b32 v4, v4, v5
    v_bfe_u32 v5, v0, 2, 2
    v_and_b32 v6, 2, v5
    v_lshl_or_b32 v6, v6, 1, v4
    v_lshl_add_u32 v5, v4, 2, v5
    v_mul_u32_u24 v5, 0x180, v5
    v_bfe_u32 v7, v0, 1, 1
    v_xor_b32 v6, v6, v7
    v_lshl_add_u32 v5, v6, 4, v5
    v_and_b32 v7, 1, v0
    v_lshl_add_u32 v5, v7, 3, v5
    v_add_u32 v16, 0xc000, v5
    v_xor_b32 v17, 32, v16
    v_xor_b32 v18, 64, v16
    v_xor_b32 v19, 96, v16
    s_cmp_eq_u32 s3, 3
    s_cselect_b32 s65, 1.0, 0
    s_mul_i32 s73, s3, 192
    s_mov_b32 s74, 2731
    v_add_u32 v3, s73, v0
    v_mul_lo_u32 v4, v3, s74
    v_lshrrev_b32 v4, 16, v4
    v_and_b32 v5, 2, v4
    v_lshlrev_b32 v5, 1, v5
    v_bfe_u32 v6, v4, 2, 2
    v_or_b32 v5, v5, v6
    v_xor_b32 v6, v5, v0
    v_lshlrev_b32 v6, 4, v6
    v_add_u32 v252, s81, v6
    v_mul_u32_u24 v6, 24, v4
    v_sub_u32 v6, v3, v6
    v_xor_b32 v6, v6, v5
    v_lshlrev_b32 v6, 4, v6
    v_add_u32 v3, s73, v0
    v_add_u32 v3, 64, v3
    v_mul_lo_u32 v4, v3, s74
    v_lshrrev_b32 v4, 16, v4
    v_and_b32 v5, 2, v4
    v_lshlrev_b32 v5, 1, v5
    v_bfe_u32 v6, v4, 2, 2
    v_or_b32 v5, v5, v6
    v_xor_b32 v6, v5, v0
    v_lshlrev_b32 v6, 4, v6
    v_add_u32 v253, s81, v6
    v_mul_u32_u24 v6, 24, v4
    v_sub_u32 v6, v3, v6
    v_xor_b32 v6, v6, v5
    v_lshlrev_b32 v6, 4, v6
    v_subrev_u32 v6, 1024, v6
    v_add_u32 v3, s73, v0
    v_add_u32 v3, 128, v3
    v_mul_lo_u32 v4, v3, s74
    v_lshrrev_b32 v4, 16, v4
    v_and_b32 v5, 2, v4
    v_lshlrev_b32 v5, 1, v5
    v_bfe_u32 v6, v4, 2, 2
    v_or_b32 v5, v5, v6
    v_xor_b32 v6, v5, v0
    v_lshlrev_b32 v6, 4, v6
    v_add_u32 v254, s81, v6
    v_mul_u32_u24 v6, 24, v4
    v_sub_u32 v6, v3, v6
    v_xor_b32 v6, v6, v5
    v_lshlrev_b32 v6, 4, v6
    v_subrev_u32 v6, 2048, v6
    v_lshlrev_b32 v255, 4, v0
    v_add_u32 v255, s81, v255
    s_mov_b32 s93, 0
    v_mov_b64 v[156:157], 0
    v_mov_b64 v[158:159], 0
    v_mov_b64 v[160:161], 0
    v_mov_b64 v[162:163], 0
    v_mov_b64 v[164:165], 0
    v_mov_b64 v[166:167], 0
    v_mov_b64 v[168:169], 0
    v_mov_b64 v[170:171], 0
    v_mov_b64 v[172:173], 0
    v_mov_b64 v[174:175], 0
    v_mov_b64 v[176:177], 0
    v_mov_b64 v[178:179], 0
    v_mov_b64 v[180:181], 0
    v_mov_b64 v[182:183], 0
    v_mov_b64 v[184:185], 0
    v_mov_b64 v[186:187], 0
    v_mov_b64 v[188:189], 0
    v_mov_b64 v[190:191], 0
    v_mov_b64 v[192:193], 0
    v_mov_b64 v[194:195], 0
    v_mov_b64 v[196:197], 0
    v_mov_b64 v[198:199], 0
    v_mov_b64 v[200:201], 0
    v_mov_b64 v[202:203], 0
    v_mov_b64 v[204:205], 0
    v_mov_b64 v[206:207], 0
    v_mov_b64 v[208:209], 0
    v_mov_b64 v[210:211], 0
    v_mov_b64 v[212:213], 0
    v_mov_b64 v[214:215], 0
    v_mov_b64 v[216:217], 0
    v_mov_b64 v[218:219], 0
    v_mov_b64 v[220:221], 0
    v_mov_b64 v[222:223], 0
    v_mov_b64 v[224:225], 0
    v_mov_b64 v[226:227], 0
    v_mov_b64 v[228:229], 0
    v_mov_b64 v[230:231], 0
    v_mov_b64 v[232:233], 0
    v_mov_b64 v[234:235], 0
    v_mov_b64 v[236:237], 0
    v_mov_b64 v[238:239], 0
    s_barrier
    ds_read_b64_tr_b16 v[20:21], v44 offset:0
    ds_read_b64_tr_b16 v[22:23], v44 offset:1536
    ds_read_b128 v[92:95], v50 offset:0
    ds_read_b64_tr_b16 v[24:25], v45 offset:0
    ds_read_b64_tr_b16 v[26:27], v45 offset:1536
    ds_read_b64_tr_b16 v[28:29], v46 offset:0
    ds_read_b64_tr_b16 v[30:31], v46 offset:1536
    ds_read_b128 v[96:99], v50 offset:2048
    s_lshl_b32 s64, s2, 8
    s_add_u32 s64, s64, s3
K1_A_pro:
    ds_read_b128 v[100:103], v50 offset:4096
    s_waitcnt lgkmcnt(4)
    v_mfma_f32_16x16x32_bf16 v[156:159], v[20:23], v[92:95], v[156:159]
    v_mfma_f32_16x16x32_bf16 v[184:187], v[24:27], v[92:95], v[184:187]
    s_waitcnt lgkmcnt(1)
    v_mfma_f32_16x16x32_bf16 v[212:215], v[28:31], v[92:95], v[212:215]
    ds_read_b128 v[104:107], v50 offset:6144
    v_mfma_f32_16x16x32_bf16 v[160:163], v[20:23], v[96:99], v[160:163]
    s_cmp_eq_u32 s93, 1
    s_cbranch_scc0 K1_w1
    buffer_load_dwordx4 v[72:75], v252, s[52:55], s79 offen offset:0 nt
    buffer_load_dwordx4 v[76:79], v253, s[52:55], s79 offen offset:1024 nt
    buffer_load_dwordx4 v[80:83], v254, s[52:55], s79 offen offset:2048 nt
    s_add_u32 s79, s79, 12288
    s_cmp_eq_u32 s79, s88
    s_cselect_b32 s12, 196608, 0
    s_sub_u32 s79, s79, s12
K1_w1:
    v_mfma_f32_16x16x32_bf16 v[188:191], v[24:27], v[96:99], v[188:191]
    v_mfma_f32_16x16x32_bf16 v[216:219], v[28:31], v[96:99], v[216:219]
    s_cmp_eq_u32 s93, 2
    s_cbranch_scc0 K1_w2
    buffer_load_dwordx4 v[112:115], v252, s[56:59], s80 offen offset:0 nt
    buffer_load_dwordx4 v[116:119], v253, s[56:59], s80 offen offset:1024 nt
    buffer_load_dwordx4 v[120:123], v254, s[56:59], s80 offen offset:2048 nt
    s_add_u32 s80, s80, 12288
    s_cmp_eq_u32 s80, s9
    s_cselect_b32 s12, 196608, 0
    s_sub_u32 s80, s80, s12
K1_w2:
    ds_read_b128 v[92:95], v50 offset:8192
    s_waitcnt lgkmcnt(1)
    v_mfma_f32_16x16x32_bf16 v[164:167], v[20:23], v[100:103], v[164:167]
    v_mfma_f32_16x16x32_bf16 v[192:195], v[24:27], v[100:103], v[192:195]
    s_cmp_eq_u32 s93, 3
    s_cbranch_scc0 K1_w3
    buffer_load_dwordx4 v[56:59], v252, s[56:59], s80 offen offset:0 nt
    buffer_load_dwordx4 v[152:155], v253, s[56:59], s80 offen offset:1024 nt
    buffer_load_dwordx4 v[4:7], v254, s[56:59], s80 offen offset:2048 nt
    s_add_u32 s80, s80, 12288
    s_cmp_eq_u32 s80, s9
    s_cselect_b32 s12, 196608, 0
    s_sub_u32 s80, s80, s12
K1_w3:
    v_mfma_f32_16x16x32_bf16 v[220:223], v[28:31], v[100:103], v[220:223]
    ds_read_b128 v[96:99], v50 offset:10240
    v_mfma_f32_16x16x32_bf16 v[168:171], v[20:23], v[104:107], v[168:171]
    v_mfma_f32_16x16x32_bf16 v[196:199], v[24:27], v[104:107], v[196:199]
    v_mfma_f32_16x16x32_bf16 v[224:227], v[28:31], v[104:107], v[224:227]
    ds_read_b128 v[100:103], v50 offset:12288
    s_waitcnt lgkmcnt(2)
    v_mfma_f32_16x16x32_bf16 v[172:175], v[20:23], v[92:95], v[172:175]
    v_mfma_f32_16x16x32_bf16 v[200:203], v[24:27], v[92:95], v[200:203]
    v_mfma_f32_16x16x32_bf16 v[228:231], v[28:31], v[92:95], v[228:231]
    s_waitcnt lgkmcnt(0)
    s_barrier
    v_mfma_f32_16x16x32_bf16 v[176:179], v[20:23], v[96:99], v[176:179]
    ds_read_b64_tr_b16 v[32:33], v44 offset:24576
    ds_read_b64_tr_b16 v[34:35], v44 offset:26112
    ds_read_b128 v[104:107], v51 offset:0
    v_mfma_f32_16x16x32_bf16 v[204:207], v[24:27], v[96:99], v[204:207]
    ds_read_b64_tr_b16 v[36:37], v45 offset:24576
    ds_read_b64_tr_b16 v[38:39], v45 offset:26112
    ds_read_b64_tr_b16 v[40:41], v46 offset:24576
    v_mfma_f32_16x16x32_bf16 v[232:235], v[28:31], v[96:99], v[232:235]
    ds_read_b64_tr_b16 v[42:43], v46 offset:26112
    ds_read_b128 v[92:95], v51 offset:2048
    v_mfma_f32_16x16x32_bf16 v[180:183], v[20:23], v[100:103], v[180:183]
    v_mfma_f32_16x16x32_bf16 v[208:211], v[24:27], v[100:103], v[208:211]
    v_mfma_f32_16x16x32_bf16 v[236:239], v[28:31], v[100:103], v[236:239]
    ds_read_b128 v[96:99], v51 offset:4096
    s_waitcnt lgkmcnt(4)
    v_mfma_f32_16x16x32_bf16 v[156:159], v[32:35], v[104:107], v[156:159]
    v_mfma_f32_16x16x32_bf16 v[184:187], v[36:39], v[104:107], v[184:187]
    s_waitcnt lgkmcnt(1)
    v_mfma_f32_16x16x32_bf16 v[212:215], v[40:43], v[104:107], v[212:215]
    ds_read_b128 v[100:103], v51 offset:6144
    v_mfma_f32_16x16x32_bf16 v[160:163], v[32:35], v[92:95], v[160:163]
    v_mfma_f32_16x16x32_bf16 v[188:191], v[36:39], v[92:95], v[188:191]
    v_mfma_f32_16x16x32_bf16 v[216:219], v[40:43], v[92:95], v[216:219]
    s_cmp_eq_u32 s93, 2
    s_cbranch_scc0 K1_w4
    buffer_load_dwordx4 v[124:127], v252, s[52:55], s79 offen offset:0 nt
    buffer_load_dwordx4 v[128:131], v253, s[52:55], s79 offen offset:1024 nt
    buffer_load_dwordx4 v[132:135], v254, s[52:55], s79 offen offset:2048 nt
    s_add_u32 s79, s79, 12288
    s_cmp_eq_u32 s79, s88
    s_cselect_b32 s12, 196608, 0
    s_sub_u32 s79, s79, s12
K1_w4:
    ds_read_b128 v[104:107], v51 offset:8192
    s_waitcnt lgkmcnt(1)
    v_mfma_f32_16x16x32_bf16 v[164:167], v[32:35], v[96:99], v[164:167]
    v_mfma_f32_16x16x32_bf16 v[192:195], v[36:39], v[96:99], v[192:195]
    v_mfma_f32_16x16x32_bf16 v[220:223], v[40:43], v[96:99], v[220:223]
    ds_read_b128 v[92:95], v51 offset:10240
    v_mfma_f32_16x16x32_bf16 v[168:171], v[32:35], v[100:103], v[168:171]
    v_mfma_f32_16x16x32_bf16 v[196:199], v[36:39], v[100:103], v[196:199]
    v_mfma_f32_16x16x32_bf16 v[224:227], v[40:43], v[100:103], v[224:227]
    ds_read_b128 v[96:99], v51 offset:12288
    s_waitcnt lgkmcnt(2)
    v_mfma_f32_16x16x32_bf16 v[172:175], v[32:35], v[104:107], v[172:175]
    v_mfma_f32_16x16x32_bf16 v[200:203], v[36:39], v[104:107], v[200:203]
    v_mfma_f32_16x16x32_bf16 v[228:231], v[40:43], v[104:107], v[228:231]
    s_waitcnt lgkmcnt(0)
    s_barrier
    v_mfma_f32_16x16x32_bf16 v[176:179], v[32:35], v[92:95], v[176:179]
    ds_read_b64_tr_b16 v[20:21], v47 offset:0
    ds_read_b64_tr_b16 v[22:23], v47 offset:1536
    ds_read_b128 v[100:103], v50 offset:16384
    v_mfma_f32_16x16x32_bf16 v[204:207], v[36:39], v[92:95], v[204:207]
    ds_read_b64_tr_b16 v[24:25], v48 offset:0
    ds_read_b64_tr_b16 v[26:27], v48 offset:1536
    ds_read_b64_tr_b16 v[28:29], v49 offset:0
    v_mfma_f32_16x16x32_bf16 v[232:235], v[40:43], v[92:95], v[232:235]
    ds_read_b64_tr_b16 v[30:31], v49 offset:1536
    ds_read_b128 v[104:107], v50 offset:18432
    v_mfma_f32_16x16x32_bf16 v[180:183], v[32:35], v[96:99], v[180:183]
    v_mfma_f32_16x16x32_bf16 v[208:211], v[36:39], v[96:99], v[208:211]
    v_mfma_f32_16x16x32_bf16 v[236:239], v[40:43], v[96:99], v[236:239]
    ds_read_b128 v[92:95], v50 offset:20480
    s_waitcnt lgkmcnt(4)
    v_mfma_f32_16x16x32_bf16 v[156:159], v[20:23], v[100:103], v[156:159]
    v_mfma_f32_16x16x32_bf16 v[184:187], v[24:27], v[100:103], v[184:187]
    s_cmp_eq_u32 s93, 0
    s_cbranch_scc0 K1_w5
    buffer_load_dwordx4 v[60:63], v252, s[52:55], s79 offen offset:0 nt
    buffer_load_dwordx4 v[64:67], v253, s[52:55], s79 offen offset:1024 nt
    buffer_load_dwordx4 v[68:71], v254, s[52:55], s79 offen offset:2048 nt
    s_add_u32 s79, s79, 12288
    s_cmp_eq_u32 s79, s88
    s_cselect_b32 s12, 196608, 0
    s_sub_u32 s79, s79, s12
K1_w5:
    s_waitcnt lgkmcnt(1)
    v_mfma_f32_16x16x32_bf16 v[212:215], v[28:31], v[100:103], v[212:215]
    ds_read_b128 v[96:99], v50 offset:22528
    v_mfma_f32_16x16x32_bf16 v[160:163], v[20:23], v[104:107], v[160:163]
    s_cmp_eq_u32 s93, 1
    s_cbranch_scc0 K1_w6
    buffer_load_dwordx4 v[84:87], v252, s[52:55], s79 offen offset:0 nt
    buffer_load_dwordx4 v[88:91], v253, s[52:55], s79 offen offset:1024 nt
    buffer_load_dwordx4 v[108:111], v254, s[52:55], s79 offen offset:2048 nt
    s_add_u32 s79, s79, 12288
    s_cmp_eq_u32 s79, s88
    s_cselect_b32 s12, 196608, 0
    s_sub_u32 s79, s79, s12
K1_w6:
    v_mfma_f32_16x16x32_bf16 v[188:191], v[24:27], v[104:107], v[188:191]
    v_mfma_f32_16x16x32_bf16 v[216:219], v[28:31], v[104:107], v[216:219]
    s_cmp_eq_u32 s93, 2
    s_cbranch_scc0 K1_w7
    buffer_load_dwordx4 v[136:139], v252, s[56:59], s80 offen offset:0 nt
    buffer_load_dwordx4 v[140:143], v253, s[56:59], s80 offen offset:1024 nt
    buffer_load_dwordx4 v[144:147], v254, s[56:59], s80 offen offset:2048 nt
    s_add_u32 s80, s80, 12288
    s_cmp_eq_u32 s80, s9
    s_cselect_b32 s12, 196608, 0
    s_sub_u32 s80, s80, s12
K1_w7:
    ds_read_b128 v[100:103], v50 offset:24576
    s_waitcnt lgkmcnt(1)
    v_mfma_f32_16x16x32_bf16 v[164:167], v[20:23], v[92:95], v[164:167]
    v_mfma_f32_16x16x32_bf16 v[192:195], v[24:27], v[92:95], v[192:195]
    s_cmp_eq_u32 s93, 3
    s_cbranch_scc0 K1_w8
    buffer_load_dwordx4 v[240:243], v252, s[56:59], s80 offen offset:0 nt
    buffer_load_dwordx4 v[244:247], v253, s[56:59], s80 offen offset:1024 nt
    buffer_load_dwordx4 v[248:251], v254, s[56:59], s80 offen offset:2048 nt
    s_add_u32 s80, s80, 12288
    s_cmp_eq_u32 s80, s9
    s_cselect_b32 s12, 196608, 0
    s_sub_u32 s80, s80, s12
K1_w8:
    v_mfma_f32_16x16x32_bf16 v[220:223], v[28:31], v[92:95], v[220:223]
    ds_read_b128 v[104:107], v50 offset:26624
    v_mfma_f32_16x16x32_bf16 v[168:171], v[20:23], v[96:99], v[168:171]
    v_mfma_f32_16x16x32_bf16 v[196:199], v[24:27], v[96:99], v[196:199]
    s_cmp_eq_u32 s64, 32
    s_cbranch_scc0 K1_w9
    s_memrealtime s[4:5]
    s_waitcnt lgkmcnt(0)
    s_lshl_b32 s4, s4, 4
    s_or_b32 s83, s4, 8
    v_mov_b32 v148, s83
    v_mov_b32 v149, 0
    s_mov_b64 exec, 1
    buffer_store_dword v148, v149, s[84:87], 0 offen offset:0 sc1
    s_mov_b64 exec, -1
K1_w9:
    v_mfma_f32_16x16x32_bf16 v[224:227], v[28:31], v[96:99], v[224:227]
    ds_read_b128 v[92:95], v50 offset:28672
    s_waitcnt lgkmcnt(2)
    v_mfma_f32_16x16x32_bf16 v[172:175], v[20:23], v[100:103], v[172:175]
    v_mfma_f32_16x16x32_bf16 v[200:203], v[24:27], v[100:103], v[200:203]
    v_mfma_f32_16x16x32_bf16 v[228:231], v[28:31], v[100:103], v[228:231]
    s_waitcnt lgkmcnt(0)
    s_barrier
    v_mfma_f32_16x16x32_bf16 v[176:179], v[20:23], v[104:107], v[176:179]
    ds_read_b64_tr_b16 v[32:33], v47 offset:24576
    ds_read_b64_tr_b16 v[34:35], v47 offset:26112
    ds_read_b128 v[96:99], v51 offset:16384
    v_mfma_f32_16x16x32_bf16 v[204:207], v[24:27], v[104:107], v[204:207]
    ds_read_b64_tr_b16 v[36:37], v48 offset:24576
    ds_read_b64_tr_b16 v[38:39], v48 offset:26112
    ds_read_b64_tr_b16 v[40:41], v49 offset:24576
    v_mfma_f32_16x16x32_bf16 v[232:235], v[28:31], v[104:107], v[232:235]
    ds_read_b64_tr_b16 v[42:43], v49 offset:26112
    ds_read_b128 v[100:103], v51 offset:18432
    v_mfma_f32_16x16x32_bf16 v[180:183], v[20:23], v[92:95], v[180:183]
    v_mfma_f32_16x16x32_bf16 v[208:211], v[24:27], v[92:95], v[208:211]
    v_mfma_f32_16x16x32_bf16 v[236:239], v[28:31], v[92:95], v[236:239]
    ds_read_b128 v[104:107], v51 offset:20480
    s_waitcnt lgkmcnt(4)
    v_mfma_f32_16x16x32_bf16 v[156:159], v[32:35], v[96:99], v[156:159]
    v_mfma_f32_16x16x32_bf16 v[184:187], v[36:39], v[96:99], v[184:187]
    s_waitcnt lgkmcnt(1)
    v_mfma_f32_16x16x32_bf16 v[212:215], v[40:43], v[96:99], v[212:215]
    ds_read_b128 v[92:95], v51 offset:22528
    v_mfma_f32_16x16x32_bf16 v[160:163], v[32:35], v[100:103], v[160:163]
    v_mfma_f32_16x16x32_bf16 v[188:191], v[36:39], v[100:103], v[188:191]
    v_mfma_f32_16x16x32_bf16 v[216:219], v[40:43], v[100:103], v[216:219]
    ds_read_b128 v[96:99], v51 offset:24576
    s_waitcnt lgkmcnt(1)
    v_mfma_f32_16x16x32_bf16 v[164:167], v[32:35], v[104:107], v[164:167]
    v_mfma_f32_16x16x32_bf16 v[192:195], v[36:39], v[104:107], v[192:195]
    v_mfma_f32_16x16x32_bf16 v[220:223], v[40:43], v[104:107], v[220:223]
    ds_read_b128 v[100:103], v51 offset:26624
    v_mfma_f32_16x16x32_bf16 v[168:171], v[32:35], v[92:95], v[168:171]
    v_mfma_f32_16x16x32_bf16 v[196:199], v[36:39], v[92:95], v[196:199]
    v_mfma_f32_16x16x32_bf16 v[224:227], v[40:43], v[92:95], v[224:227]
    ds_read_b128 v[104:107], v51 offset:28672
    s_waitcnt lgkmcnt(2)
    v_mfma_f32_16x16x32_bf16 v[172:175], v[32:35], v[96:99], v[172:175]
    v_mfma_f32_16x16x32_bf16 v[200:203], v[36:39], v[96:99], v[200:203]
    v_mfma_f32_16x16x32_bf16 v[228:231], v[40:43], v[96:99], v[228:231]
    s_waitcnt lgkmcnt(0)
    s_barrier
    v_mfma_f32_16x16x32_bf16 v[176:179], v[32:35], v[100:103], v[176:179]
    ds_read_b64_tr_b16 v[20:21], v44 offset:0
    ds_read_b64_tr_b16 v[22:23], v44 offset:1536
    ds_read_b128 v[92:95], v52 offset:0
    v_mfma_f32_16x16x32_bf16 v[204:207], v[36:39], v[100:103], v[204:207]
    ds_read_b64_tr_b16 v[24:25], v45 offset:0
    ds_read_b64_tr_b16 v[26:27], v45 offset:1536
    ds_read_b64_tr_b16 v[28:29], v46 offset:0
    v_mfma_f32_16x16x32_bf16 v[232:235], v[40:43], v[100:103], v[232:235]
    ds_read_b64_tr_b16 v[30:31], v46 offset:1536
    ds_read_b128 v[96:99], v52 offset:2048
    v_mfma_f32_16x16x32_bf16 v[180:183], v[32:35], v[104:107], v[180:183]
    v_mfma_f32_16x16x32_bf16 v[208:211], v[36:39], v[104:107], v[208:211]
    v_mfma_f32_16x16x32_bf16 v[236:239], v[40:43], v[104:107], v[236:239]
    s_add_u32 s93, s93, 1
    v_swap_b32 v50, v52
    v_swap_b32 v51, v53
    s_add_u32 s64, s64, 16
    s_cmp_lt_u32 s93, 4
    s_cbranch_scc1 K1_A_pro
    ds_read_b128 v[100:103], v50 offset:4096
    s_waitcnt lgkmcnt(4)
    v_mfma_f32_16x16x32_bf16 v[156:159], v[20:23], v[92:95], v[156:159]
    v_mfma_f32_16x16x32_bf16 v[184:187], v[24:27], v[92:95], v[184:187]
    s_waitcnt lgkmcnt(1)
    v_mfma_f32_16x16x32_bf16 v[212:215], v[28:31], v[92:95], v[212:215]
    ds_read_b128 v[104:107], v50 offset:6144
    v_mfma_f32_16x16x32_bf16 v[160:163], v[20:23], v[96:99], v[160:163]
    v_mfma_f32_16x16x32_bf16 v[188:191], v[24:27], v[96:99], v[188:191]
    v_mfma_f32_16x16x32_bf16 v[216:219], v[28:31], v[96:99], v[216:219]
    ds_read_b128 v[92:95], v50 offset:8192
    s_waitcnt lgkmcnt(1)
    v_mfma_f32_16x16x32_bf16 v[164:167], v[20:23], v[100:103], v[164:167]
    v_mfma_f32_16x16x32_bf16 v[192:195], v[24:27], v[100:103], v[192:195]
    v_mfma_f32_16x16x32_bf16 v[220:223], v[28:31], v[100:103], v[220:223]
    ds_read_b128 v[96:99], v50 offset:10240
    v_mfma_f32_16x16x32_bf16 v[168:171], v[20:23], v[104:107], v[168:171]
    v_mfma_f32_16x16x32_bf16 v[196:199], v[24:27], v[104:107], v[196:199]
    v_mfma_f32_16x16x32_bf16 v[224:227], v[28:31], v[104:107], v[224:227]
    ds_read_b128 v[100:103], v50 offset:12288
    s_waitcnt lgkmcnt(2)
    v_mfma_f32_16x16x32_bf16 v[172:175], v[20:23], v[92:95], v[172:175]
    v_mfma_f32_16x16x32_bf16 v[200:203], v[24:27], v[92:95], v[200:203]
    v_mfma_f32_16x16x32_bf16 v[228:231], v[28:31], v[92:95], v[228:231]
    s_waitcnt lgkmcnt(0)
    s_barrier
    v_mfma_f32_16x16x32_bf16 v[176:179], v[20:23], v[96:99], v[176:179]
    s_waitcnt vmcnt(18)
    ds_write_b128 v255, v[60:63] offset:0
    ds_write_b128 v255, v[64:67] offset:1024
    ds_write_b128 v255, v[68:71] offset:2048
    ds_write_b128 v255, v[72:75] offset:12288
    ds_write_b128 v255, v[76:79] offset:13312
    ds_write_b128 v255, v[80:83] offset:14336
    ds_read_b64_tr_b16 v[32:33], v44 offset:24576
    ds_read_b64_tr_b16 v[34:35], v44 offset:26112
    ds_read_b128 v[104:107], v51 offset:0
    v_mfma_f32_16x16x32_bf16 v[204:207], v[24:27], v[96:99], v[204:207]
    ds_read_b64_tr_b16 v[36:37], v45 offset:24576
    ds_read_b64_tr_b16 v[38:39], v45 offset:26112
    ds_read_b64_tr_b16 v[40:41], v46 offset:24576
    v_mfma_f32_16x16x32_bf16 v[232:235], v[28:31], v[96:99], v[232:235]
    ds_read_b64_tr_b16 v[42:43], v46 offset:26112
    ds_read_b128 v[92:95], v51 offset:2048
    v_mfma_f32_16x16x32_bf16 v[180:183], v[20:23], v[100:103], v[180:183]
    v_mfma_f32_16x16x32_bf16 v[208:211], v[24:27], v[100:103], v[208:211]
    v_mfma_f32_16x16x32_bf16 v[236:239], v[28:31], v[100:103], v[236:239]
    ds_read_b128 v[96:99], v51 offset:4096
    s_waitcnt lgkmcnt(4)
    v_mfma_f32_16x16x32_bf16 v[156:159], v[32:35], v[104:107], v[156:159]
    v_mfma_f32_16x16x32_bf16 v[184:187], v[36:39], v[104:107], v[184:187]
    s_waitcnt lgkmcnt(1)
    v_mfma_f32_16x16x32_bf16 v[212:215], v[40:43], v[104:107], v[212:215]
    ds_read_b128 v[100:103], v51 offset:6144
    v_mfma_f32_16x16x32_bf16 v[160:163], v[32:35], v[92:95], v[160:163]
    v_mfma_f32_16x16x32_bf16 v[188:191], v[36:39], v[92:95], v[188:191]
    v_mfma_f32_16x16x32_bf16 v[216:219], v[40:43], v[92:95], v[216:219]
    ds_read_b128 v[104:107], v51 offset:8192
    s_waitcnt lgkmcnt(1)
    v_mfma_f32_16x16x32_bf16 v[164:167], v[32:35], v[96:99], v[164:167]
    v_mfma_f32_16x16x32_bf16 v[192:195], v[36:39], v[96:99], v[192:195]
    v_mfma_f32_16x16x32_bf16 v[220:223], v[40:43], v[96:99], v[220:223]
    ds_read_b128 v[92:95], v51 offset:10240
    v_mfma_f32_16x16x32_bf16 v[168:171], v[32:35], v[100:103], v[168:171]
    v_mfma_f32_16x16x32_bf16 v[196:199], v[36:39], v[100:103], v[196:199]
    v_mfma_f32_16x16x32_bf16 v[224:227], v[40:43], v[100:103], v[224:227]
    ds_read_b128 v[96:99], v51 offset:12288
    s_waitcnt lgkmcnt(2)
    v_mfma_f32_16x16x32_bf16 v[172:175], v[32:35], v[104:107], v[172:175]
    v_mfma_f32_16x16x32_bf16 v[200:203], v[36:39], v[104:107], v[200:203]
    v_mfma_f32_16x16x32_bf16 v[228:231], v[40:43], v[104:107], v[228:231]
    s_waitcnt lgkmcnt(0)
    s_barrier
    v_mfma_f32_16x16x32_bf16 v[176:179], v[32:35], v[92:95], v[176:179]
    s_waitcnt vmcnt(9)
    ds_write_b128 v255, v[84:87] offset:24576
    ds_write_b128 v255, v[88:91] offset:25600
    ds_write_b128 v255, v[108:111] offset:26624
    ds_write_b128 v255, v[124:127] offset:36864
    ds_write_b128 v255, v[128:131] offset:37888
    ds_write_b128 v255, v[132:135] offset:38912
    ds_read_b64_tr_b16 v[20:21], v47 offset:0
    ds_read_b64_tr_b16 v[22:23], v47 offset:1536
    ds_read_b128 v[100:103], v50 offset:16384
    v_mfma_f32_16x16x32_bf16 v[204:207], v[36:39], v[92:95], v[204:207]
    ds_read_b64_tr_b16 v[24:25], v48 offset:0
    ds_read_b64_tr_b16 v[26:27], v48 offset:1536
    ds_read_b64_tr_b16 v[28:29], v49 offset:0
    v_mfma_f32_16x16x32_bf16 v[232:235], v[40:43], v[92:95], v[232:235]
    ds_read_b64_tr_b16 v[30:31], v49 offset:1536
    ds_read_b128 v[104:107], v50 offset:18432
    v_mfma_f32_16x16x32_bf16 v[180:183], v[32:35], v[96:99], v[180:183]
    v_mfma_f32_16x16x32_bf16 v[208:211], v[36:39], v[96:99], v[208:211]
    v_mfma_f32_16x16x32_bf16 v[236:239], v[40:43], v[96:99], v[236:239]
    ds_read_b128 v[92:95], v50 offset:20480
    s_waitcnt lgkmcnt(4)
    v_mfma_f32_16x16x32_bf16 v[156:159], v[20:23], v[100:103], v[156:159]
    v_mfma_f32_16x16x32_bf16 v[184:187], v[24:27], v[100:103], v[184:187]
    s_waitcnt lgkmcnt(1)
    v_mfma_f32_16x16x32_bf16 v[212:215], v[28:31], v[100:103], v[212:215]
    ds_read_b128 v[96:99], v50 offset:22528
    v_mfma_f32_16x16x32_bf16 v[160:163], v[20:23], v[104:107], v[160:163]
    v_mfma_f32_16x16x32_bf16 v[188:191], v[24:27], v[104:107], v[188:191]
    v_mfma_f32_16x16x32_bf16 v[216:219], v[28:31], v[104:107], v[216:219]
    ds_read_b128 v[100:103], v50 offset:24576
    s_waitcnt lgkmcnt(1)
    v_mfma_f32_16x16x32_bf16 v[164:167], v[20:23], v[92:95], v[164:167]
    v_mfma_f32_16x16x32_bf16 v[192:195], v[24:27], v[92:95], v[192:195]
    v_mfma_f32_16x16x32_bf16 v[220:223], v[28:31], v[92:95], v[220:223]
    ds_read_b128 v[104:107], v50 offset:26624
    v_mfma_f32_16x16x32_bf16 v[168:171], v[20:23], v[96:99], v[168:171]
    v_mfma_f32_16x16x32_bf16 v[196:199], v[24:27], v[96:99], v[196:199]
    v_mfma_f32_16x16x32_bf16 v[224:227], v[28:31], v[96:99], v[224:227]
    ds_read_b128 v[92:95], v50 offset:28672
    s_waitcnt lgkmcnt(2)
    v_mfma_f32_16x16x32_bf16 v[172:175], v[20:23], v[100:103], v[172:175]
    v_mfma_f32_16x16x32_bf16 v[200:203], v[24:27], v[100:103], v[200:203]
    v_mfma_f32_16x16x32_bf16 v[228:231], v[28:31], v[100:103], v[228:231]
    s_waitcnt lgkmcnt(0)
    s_barrier
    v_mfma_f32_16x16x32_bf16 v[176:179], v[20:23], v[104:107], v[176:179]
    s_waitcnt vmcnt(6)
    ds_write_b128 v255, v[112:115] offset:49152
    ds_write_b128 v255, v[116:119] offset:50176
    ds_write_b128 v255, v[120:123] offset:51200
    ds_write_b128 v255, v[136:139] offset:61440
    ds_write_b128 v255, v[140:143] offset:62464
    ds_write_b128 v255, v[144:147] offset:63488
    ds_read_b64_tr_b16 v[32:33], v47 offset:24576
    ds_read_b64_tr_b16 v[34:35], v47 offset:26112
    ds_read_b128 v[96:99], v51 offset:16384
    v_mfma_f32_16x16x32_bf16 v[204:207], v[24:27], v[104:107], v[204:207]
    ds_read_b64_tr_b16 v[36:37], v48 offset:24576
    ds_read_b64_tr_b16 v[38:39], v48 offset:26112
    ds_read_b64_tr_b16 v[40:41], v49 offset:24576
    v_mfma_f32_16x16x32_bf16 v[232:235], v[28:31], v[104:107], v[232:235]
    ds_read_b64_tr_b16 v[42:43], v49 offset:26112
    ds_read_b128 v[100:103], v51 offset:18432
    v_mfma_f32_16x16x32_bf16 v[180:183], v[20:23], v[92:95], v[180:183]
    v_mfma_f32_16x16x32_bf16 v[208:211], v[24:27], v[92:95], v[208:211]
    v_mfma_f32_16x16x32_bf16 v[236:239], v[28:31], v[92:95], v[236:239]
    ds_read_b128 v[104:107], v51 offset:20480
    s_waitcnt lgkmcnt(4)
    v_mfma_f32_16x16x32_bf16 v[156:159], v[32:35], v[96:99], v[156:159]
    v_mfma_f32_16x16x32_bf16 v[184:187], v[36:39], v[96:99], v[184:187]
    s_waitcnt lgkmcnt(1)
    v_mfma_f32_16x16x32_bf16 v[212:215], v[40:43], v[96:99], v[212:215]
    ds_read_b128 v[92:95], v51 offset:22528
    v_mfma_f32_16x16x32_bf16 v[160:163], v[32:35], v[100:103], v[160:163]
    v_mfma_f32_16x16x32_bf16 v[188:191], v[36:39], v[100:103], v[188:191]
    v_mfma_f32_16x16x32_bf16 v[216:219], v[40:43], v[100:103], v[216:219]
    ds_read_b128 v[96:99], v51 offset:24576
    s_waitcnt lgkmcnt(1)
    v_mfma_f32_16x16x32_bf16 v[164:167], v[32:35], v[104:107], v[164:167]
    v_mfma_f32_16x16x32_bf16 v[192:195], v[36:39], v[104:107], v[192:195]
    v_mfma_f32_16x16x32_bf16 v[220:223], v[40:43], v[104:107], v[220:223]
    ds_read_b128 v[100:103], v51 offset:26624
    v_mfma_f32_16x16x32_bf16 v[168:171], v[32:35], v[92:95], v[168:171]
    v_mfma_f32_16x16x32_bf16 v[196:199], v[36:39], v[92:95], v[196:199]
    v_mfma_f32_16x16x32_bf16 v[224:227], v[40:43], v[92:95], v[224:227]
    ds_read_b128 v[104:107], v51 offset:28672
    s_waitcnt lgkmcnt(2)
    v_mfma_f32_16x16x32_bf16 v[172:175], v[32:35], v[96:99], v[172:175]
    v_mfma_f32_16x16x32_bf16 v[200:203], v[36:39], v[96:99], v[200:203]
    v_mfma_f32_16x16x32_bf16 v[228:231], v[40:43], v[96:99], v[228:231]
    s_waitcnt lgkmcnt(0)
    s_barrier
    v_mfma_f32_16x16x32_bf16 v[176:179], v[32:35], v[100:103], v[176:179]
    v_add_u32 v255, 0xf000, v255
    s_waitcnt vmcnt(0)
    ds_write_b128 v255, v[56:59] offset:12288
    ds_write_b128 v255, v[152:155] offset:13312
    ds_write_b128 v255, v[4:7] offset:14336
    ds_write_b128 v255, v[240:243] offset:24576
    ds_write_b128 v255, v[244:247] offset:25600
    ds_write_b128 v255, v[248:251] offset:26624
    v_mfma_f32_16x16x32_bf16 v[204:207], v[36:39], v[100:103], v[204:207]
    v_mfma_f32_16x16x32_bf16 v[232:235], v[40:43], v[100:103], v[232:235]
    v_mfma_f32_16x16x32_bf16 v[180:183], v[32:35], v[104:107], v[180:183]
    v_mfma_f32_16x16x32_bf16 v[208:211], v[36:39], v[104:107], v[208:211]
    v_mfma_f32_16x16x32_bf16 v[236:239], v[40:43], v[104:107], v[236:239]
    v_and_b32 v8, 15, v0
    v_lshlrev_b32 v8, 4, v8
    v_lshrrev_b32 v9, 5, v0
    v_lshl_add_u32 v8, v9, 9, v8
    v_bfe_u32 v9, v0, 4, 1
    v_lshl_add_u32 v8, v9, 3, v8
    s_and_b32 s73, s3, 3
    s_mul_i32 s73, s73, 3
    s_add_u32 s73, s73, 0
    s_and_b32 s74, s73, 1
    s_lshr_b32 s73, s73, 1
    s_lshl_b32 s73, s73, 3
    s_add_u32 s73, s73, s74
    s_lshl_b32 s73, s73, 8
    s_add_u32 s73, s73, 98304
    v_add_u32 v8, s73, v8
    v_pk_mul_f32 v[156:157], v[156:157], s[94:95]
    v_pk_mul_f32 v[158:159], v[158:159], s[94:95]
    v_cvt_pk_bf16_f32 v156, v156, v157
    v_cvt_pk_bf16_f32 v157, v158, v159
    ds_write_b64 v8, v[156:157] offset:0
    v_pk_mul_f32 v[160:161], v[160:161], s[94:95]
    v_pk_mul_f32 v[162:163], v[162:163], s[94:95]
    v_cvt_pk_bf16_f32 v160, v160, v161
    v_cvt_pk_bf16_f32 v161, v162, v163
    ds_write_b64 v8, v[160:161] offset:1024
    v_pk_mul_f32 v[164:165], v[164:165], s[94:95]
    v_pk_mul_f32 v[166:167], v[166:167], s[94:95]
    v_cvt_pk_bf16_f32 v164, v164, v165
    v_cvt_pk_bf16_f32 v165, v166, v167
    ds_write_b64 v8, v[164:165] offset:12288
    v_pk_mul_f32 v[168:169], v[168:169], s[94:95]
    v_pk_mul_f32 v[170:171], v[170:171], s[94:95]
    v_cvt_pk_bf16_f32 v168, v168, v169
    v_cvt_pk_bf16_f32 v169, v170, v171
    ds_write_b64 v8, v[168:169] offset:13312
    v_pk_mul_f32 v[172:173], v[172:173], s[94:95]
    v_pk_mul_f32 v[174:175], v[174:175], s[94:95]
    v_cvt_pk_bf16_f32 v172, v172, v173
    v_cvt_pk_bf16_f32 v173, v174, v175
    ds_write_b64 v8, v[172:173] offset:24576
    v_pk_mul_f32 v[176:177], v[176:177], s[94:95]
    v_pk_mul_f32 v[178:179], v[178:179], s[94:95]
    v_cvt_pk_bf16_f32 v176, v176, v177
    v_cvt_pk_bf16_f32 v177, v178, v179
    ds_write_b64 v8, v[176:177] offset:25600
    v_pk_mul_f32 v[180:181], v[180:181], s[94:95]
    v_pk_mul_f32 v[182:183], v[182:183], s[94:95]
    v_cvt_pk_bf16_f32 v180, v180, v181
    v_cvt_pk_bf16_f32 v181, v182, v183
    ds_write_b64 v8, v[180:181] offset:36864
    v_and_b32 v8, 15, v0
    v_lshlrev_b32 v8, 4, v8
    v_lshrrev_b32 v9, 5, v0
    v_lshl_add_u32 v8, v9, 9, v8
    v_bfe_u32 v9, v0, 4, 1
    v_lshl_add_u32 v8, v9, 3, v8
    s_and_b32 s73, s3, 3
    s_mul_i32 s73, s73, 3
    s_add_u32 s73, s73, 1
    s_and_b32 s74, s73, 1
    s_lshr_b32 s73, s73, 1
    s_lshl_b32 s73, s73, 3
    s_add_u32 s73, s73, s74
    s_lshl_b32 s73, s73, 8
    s_add_u32 s73, s73, 98304
    v_add_u32 v8, s73, v8
    v_pk_mul_f32 v[184:185], v[184:185], s[94:95]
    v_pk_mul_f32 v[186:187], v[186:187], s[94:95]
    v_cvt_pk_bf16_f32 v184, v184, v185
    v_cvt_pk_bf16_f32 v185, v186, v187
    ds_write_b64 v8, v[184:185] offset:0
    v_pk_mul_f32 v[188:189], v[188:189], s[94:95]
    v_pk_mul_f32 v[190:191], v[190:191], s[94:95]
    v_cvt_pk_bf16_f32 v188, v188, v189
    v_cvt_pk_bf16_f32 v189, v190, v191
    ds_write_b64 v8, v[188:189] offset:1024
    v_pk_mul_f32 v[192:193], v[192:193], s[94:95]
    v_pk_mul_f32 v[194:195], v[194:195], s[94:95]
    v_cvt_pk_bf16_f32 v192, v192, v193
    v_cvt_pk_bf16_f32 v193, v194, v195
    ds_write_b64 v8, v[192:193] offset:12288
    v_pk_mul_f32 v[196:197], v[196:197], s[94:95]
    v_pk_mul_f32 v[198:199], v[198:199], s[94:95]
    v_cvt_pk_bf16_f32 v196, v196, v197
    v_cvt_pk_bf16_f32 v197, v198, v199
    ds_write_b64 v8, v[196:197] offset:13312
    v_pk_mul_f32 v[200:201], v[200:201], s[94:95]
    v_pk_mul_f32 v[202:203], v[202:203], s[94:95]
    v_cvt_pk_bf16_f32 v200, v200, v201
    v_cvt_pk_bf16_f32 v201, v202, v203
    ds_write_b64 v8, v[200:201] offset:24576
    v_pk_mul_f32 v[204:205], v[204:205], s[94:95]
    v_pk_mul_f32 v[206:207], v[206:207], s[94:95]
    v_cvt_pk_bf16_f32 v204, v204, v205
    v_cvt_pk_bf16_f32 v205, v206, v207
    ds_write_b64 v8, v[204:205] offset:25600
    v_pk_mul_f32 v[208:209], v[208:209], s[94:95]
    v_pk_mul_f32 v[210:211], v[210:211], s[94:95]
    v_cvt_pk_bf16_f32 v208, v208, v209
    v_cvt_pk_bf16_f32 v209, v210, v211
    ds_write_b64 v8, v[208:209] offset:36864
    v_and_b32 v8, 15, v0
    v_lshlrev_b32 v8, 4, v8
    v_lshrrev_b32 v9, 5, v0
    v_lshl_add_u32 v8, v9, 9, v8
    v_bfe_u32 v9, v0, 4, 1
    v_lshl_add_u32 v8, v9, 3, v8
    s_and_b32 s73, s3, 3
    s_mul_i32 s73, s73, 3
    s_add_u32 s73, s73, 2
    s_and_b32 s74, s73, 1
    s_lshr_b32 s73, s73, 1
    s_lshl_b32 s73, s73, 3
    s_add_u32 s73, s73, s74
    s_lshl_b32 s73, s73, 8
    s_add_u32 s73, s73, 98304
    v_add_u32 v8, s73, v8
    v_pk_mul_f32 v[212:213], v[212:213], s[94:95]
    v_pk_mul_f32 v[214:215], v[214:215], s[94:95]
    v_cvt_pk_bf16_f32 v212, v212, v213
    v_cvt_pk_bf16_f32 v213, v214, v215
    ds_write_b64 v8, v[212:213] offset:0
    v_pk_mul_f32 v[216:217], v[216:217], s[94:95]
    v_pk_mul_f32 v[218:219], v[218:219], s[94:95]
    v_cvt_pk_bf16_f32 v216, v216, v217
    v_cvt_pk_bf16_f32 v217, v218, v219
    ds_write_b64 v8, v[216:217] offset:1024
    v_pk_mul_f32 v[220:221], v[220:221], s[94:95]
    v_pk_mul_f32 v[222:223], v[222:223], s[94:95]
    v_cvt_pk_bf16_f32 v220, v220, v221
    v_cvt_pk_bf16_f32 v221, v222, v223
    ds_write_b64 v8, v[220:221] offset:12288
    v_pk_mul_f32 v[224:225], v[224:225], s[94:95]
    v_pk_mul_f32 v[226:227], v[226:227], s[94:95]
    v_cvt_pk_bf16_f32 v224, v224, v225
    v_cvt_pk_bf16_f32 v225, v226, v227
    ds_write_b64 v8, v[224:225] offset:13312
    v_pk_mul_f32 v[228:229], v[228:229], s[94:95]
    v_pk_mul_f32 v[230:231], v[230:231], s[94:95]
    v_cvt_pk_bf16_f32 v228, v228, v229
    v_cvt_pk_bf16_f32 v229, v230, v231
    ds_write_b64 v8, v[228:229] offset:24576
    v_pk_mul_f32 v[232:233], v[232:233], s[94:95]
    v_pk_mul_f32 v[234:235], v[234:235], s[94:95]
    v_cvt_pk_bf16_f32 v232, v232, v233
    v_cvt_pk_bf16_f32 v233, v234, v235
    ds_write_b64 v8, v[232:233] offset:25600
    v_pk_mul_f32 v[236:237], v[236:237], s[94:95]
    v_pk_mul_f32 v[238:239], v[238:239], s[94:95]
    v_cvt_pk_bf16_f32 v236, v236, v237
    v_cvt_pk_bf16_f32 v237, v238, v239
    ds_write_b64 v8, v[236:237] offset:36864
    v_mov_b32 v132, 0
    v_mov_b32 v133, s65
    v_mov_b32 v134, 0
    v_mov_b32 v135, s65
    v_and_b32 v10, 3, v0
    s_lshl_b32 s73, s3, 4
    s_add_u32 s73, s73, 159808
    v_lshl_add_u32 v10, v10, 2, s73
    v_mov_b32 v255, 0
    ds_write_b32 v10, v255
    s_waitcnt lgkmcnt(0)
    s_mul_i32 s73, s3, 12288
    s_add_u32 s73, s73, 98304
    v_lshl_add_u32 v6, v0, 4, s73
    s_barrier
    ds_read_b128 v[44:47], v6 offset:0
    ds_read_b128 v[48:51], v6 offset:1024
    ds_read_b128 v[52:55], v6 offset:2048
    ds_read_b128 v[56:59], v6 offset:3072
    ds_read_b128 v[60:63], v6 offset:4096
    ds_read_b128 v[64:67], v6 offset:5120
    ds_read_b128 v[68:71], v6 offset:6144
    ds_read_b128 v[72:75], v6 offset:7168
    ds_read_b128 v[76:79], v6 offset:8192
    ds_read_b128 v[80:83], v6 offset:9216
    ds_read_b128 v[84:87], v6 offset:10240
    ds_read_b128 v[88:91], v6 offset:11264
    ds_read_b128 v[20:23], v12 offset:0
    ds_read_b128 v[24:27], v12 offset:6144
    ds_read_b128 v[28:31], v13 offset:0
    ds_read_b128 v[32:35], v13 offset:6144
    ds_read_b128 v[36:39], v12 offset:128
    s_mov_b32 s72, 0
    s_mov_b32 s64, s3
K1_A_head:
    s_cmp_eq_u32 s3, 3
    s_cbranch_scc0 K1_A_h2
    s_mov_b32 s93, 0
    ds_read_b128 v[40:43], v12 offset:6272
    s_waitcnt lgkmcnt(4)
    v_mfma_f32_16x16x32_bf16 v[92:95], v[20:23], v[44:47], 0
    v_mov_b64 v[156:157], 0
    v_mov_b64 v[158:159], 0
    v_mov_b64 v[160:161], 0
    v_mov_b64 v[162:163], 0
    ds_read_b128 v[20:23], v13 offset:128
    v_mfma_f32_16x16x32_bf16 v[96:99], v[24:27], v[44:47], 0
    v_mov_b64 v[164:165], 0
    v_mov_b64 v[166:167], 0
    v_mov_b64 v[168:169], 0
    v_mov_b64 v[170:171], 0
    ds_read_b128 v[24:27], v13 offset:6272
    ds_read_b32 v254, v10 offset:64
    s_waitcnt lgkmcnt(5)
    v_mfma_f32_16x16x32_bf16 v[92:95], v[28:31], v[52:55], v[92:95]
    v_mov_b64 v[172:173], 0
    v_mov_b64 v[174:175], 0
    v_mov_b64 v[176:177], 0
    v_mov_b64 v[178:179], 0
    ds_read_b128 v[28:31], v12 offset:256
    v_mfma_f32_16x16x32_bf16 v[96:99], v[32:35], v[52:55], v[96:99]
    v_mov_b64 v[180:181], 0
    v_mov_b64 v[182:183], 0
    v_mov_b64 v[184:185], 0
    v_mov_b64 v[186:187], 0
    ds_read_b128 v[32:35], v12 offset:6400
    s_waitcnt lgkmcnt(5)
    v_mfma_f32_16x16x32_bf16 v[92:95], v[36:39], v[60:63], v[92:95]
    v_mov_b64 v[188:189], 0
    v_mov_b64 v[190:191], 0
    v_mov_b64 v[192:193], 0
    v_mov_b64 v[194:195], 0
    ds_read_b128 v[36:39], v13 offset:256
    v_mfma_f32_16x16x32_bf16 v[96:99], v[40:43], v[60:63], v[96:99]
    v_mov_b64 v[196:197], 0
    v_mov_b64 v[198:199], 0
    v_mov_b64 v[200:201], 0
    v_mov_b64 v[202:203], 0
    ds_read_b128 v[40:43], v13 offset:6400
    s_waitcnt lgkmcnt(4)
    v_mfma_f32_16x16x32_bf16 v[92:95], v[20:23], v[68:71], v[92:95]
    v_mov_b64 v[204:205], 0
    v_mov_b64 v[206:207], 0
    v_mov_b64 v[208:209], 0
    v_mov_b64 v[210:211], 0
    v_cmp_ge_i32 vcc, v255, v254
    v_add_u32 v255, 1, v255
    ds_write_b32 v10, v255
    s_cbranch_vccnz K1_sp10
K1_sp10b:
    ds_read_b128 v[20:23], v12 offset:12288
    v_mfma_f32_16x16x32_bf16 v[96:99], v[24:27], v[68:71], v[96:99]
    v_mov_b64 v[212:213], 0
    v_mov_b64 v[214:215], 0
    v_mov_b64 v[216:217], 0
    v_mov_b64 v[218:219], 0
    ds_read_b128 v[24:27], v12 offset:18432
    s_waitcnt lgkmcnt(5)
    v_mfma_f32_16x16x32_bf16 v[92:95], v[28:31], v[76:79], v[92:95]
    v_mov_b64 v[220:221], 0
    v_mov_b64 v[222:223], 0
    v_mov_b64 v[224:225], 0
    v_mov_b64 v[226:227], 0
    ds_read_b128 v[28:31], v13 offset:12288
    v_mfma_f32_16x16x32_bf16 v[96:99], v[32:35], v[76:79], v[96:99]
    v_mov_b64 v[228:229], 0
    v_mov_b64 v[230:231], 0
    v_mov_b64 v[232:233], 0
    v_mov_b64 v[234:235], 0
    ds_read_b128 v[32:35], v13 offset:18432
    s_waitcnt lgkmcnt(5)
    v_mfma_f32_16x16x32_bf16 v[92:95], v[36:39], v[84:87], v[92:95]
    v_mov_b64 v[236:237], 0
    v_mov_b64 v[238:239], 0
    v_mov_b64 v[240:241], 0
    v_mov_b64 v[242:243], 0
    ds_read_b128 v[36:39], v12 offset:12416
    v_mfma_f32_16x16x32_bf16 v[96:99], v[40:43], v[84:87], v[96:99]
    v_mov_b64 v[244:245], 0
    v_mov_b64 v[246:247], 0
    v_mov_b64 v[248:249], 0
    v_mov_b64 v[250:251], 0
    s_nop 7
    v_max3_f32 v2, v92, v93, v94
    v_max3_f32 v3, v95, v96, v97
    v_max3_f32 v2, v2, v98, v99
    v_max_f32 v2, v2, v3
    v_mov_b32 v3, v2
    s_nop 1
    v_permlane32_swap_b32 v2, v3
    v_max_f32 v2, v2, v3
    v_mov_b32 v3, v2
    s_nop 1
    v_permlane16_swap_b32 v2, v3
    v_max_f32 v2, v2, v3
    v_mov_b32 v3, v2
    v_sub_f32 v124, 0, v2
    v_sub_f32 v125, 0, v2
    v_sub_f32 v126, 0, v2
    v_sub_f32 v127, 0, v2
    v_pk_add_f32 v[92:93], v[92:93], v[2:3] neg_lo:[0,1] neg_hi:[0,1]
    v_pk_add_f32 v[94:95], v[94:95], v[2:3] neg_lo:[0,1] neg_hi:[0,1]
    v_pk_add_f32 v[96:97], v[96:97], v[2:3] neg_lo:[0,1] neg_hi:[0,1]
    v_pk_add_f32 v[98:99], v[98:99], v[2:3] neg_lo:[0,1] neg_hi:[0,1]
    s_nop 0
    ds_read_b128 v[40:43], v12 offset:18560
    s_waitcnt lgkmcnt(4)
    v_mfma_f32_16x16x32_bf16 v[108:111], v[20:23], v[44:47], v[124:127]
    v_exp_f32 v2, v92
    ds_read_b128 v[20:23], v13 offset:12416
    v_mfma_f32_16x16x32_bf16 v[112:115], v[24:27], v[44:47], v[124:127]
    v_exp_f32 v3, v93
    ds_read_b128 v[24:27], v13 offset:18560
    ds_read_b32 v254, v10 offset:64
    s_waitcnt lgkmcnt(5)
    v_mfma_f32_16x16x32_bf16 v[108:111], v[28:31], v[52:55], v[108:111]
    v_exp_f32 v4, v94
    v_exp_f32 v5, v95
    ds_read_b128 v[28:31], v12 offset:12544
    v_mfma_f32_16x16x32_bf16 v[112:115], v[32:35], v[52:55], v[112:115]
    v_cvt_pk_bf16_f32 v140, v2, v3
    ds_read_b128 v[32:35], v12 offset:18688
    s_waitcnt lgkmcnt(5)
    v_mfma_f32_16x16x32_bf16 v[108:111], v[36:39], v[60:63], v[108:111]
    v_add_f32 v132, v134, v2
    v_add_f32 v132, v132, v3
    ds_read_b128 v[36:39], v13 offset:12544
    v_mfma_f32_16x16x32_bf16 v[112:115], v[40:43], v[60:63], v[112:115]
    v_exp_f32 v252, v96
    v_exp_f32 v253, v97
    ds_read_b128 v[40:43], v13 offset:18688
    s_waitcnt lgkmcnt(4)
    v_mfma_f32_16x16x32_bf16 v[108:111], v[20:23], v[68:71], v[108:111]
    v_cvt_pk_bf16_f32 v141, v4, v5
    v_cmp_ge_i32 vcc, v255, v254
    v_add_u32 v255, 1, v255
    ds_write_b32 v10, v255
    s_cbranch_vccnz K1_sp11
K1_sp11b:
    ds_read_b128 v[20:23], v12 offset:24576
    v_mfma_f32_16x16x32_bf16 v[112:115], v[24:27], v[68:71], v[112:115]
    v_add_f32 v132, v132, v4
    v_add_f32 v132, v132, v5
    ds_read_b128 v[24:27], v12 offset:30720
    s_waitcnt lgkmcnt(5)
    v_mfma_f32_16x16x32_bf16 v[108:111], v[28:31], v[76:79], v[108:111]
    v_exp_f32 v2, v98
    v_exp_f32 v3, v99
    ds_read_b128 v[28:31], v13 offset:24576
    v_mfma_f32_16x16x32_bf16 v[112:115], v[32:35], v[76:79], v[112:115]
    v_cvt_pk_bf16_f32 v142, v252, v253
    ds_read_b128 v[32:35], v13 offset:30720
    s_waitcnt lgkmcnt(5)
    v_mfma_f32_16x16x32_bf16 v[108:111], v[36:39], v[84:87], v[108:111]
    v_add_f32 v132, v132, v252
    v_add_f32 v132, v132, v253
    v_cvt_pk_bf16_f32 v143, v2, v3
    ds_read_b128 v[36:39], v12 offset:24704
    v_mfma_f32_16x16x32_bf16 v[112:115], v[40:43], v[84:87], v[112:115]
    v_add_f32 v132, v132, v2
    v_add_f32 v132, v132, v3
    s_nop 3
K1_A_loopx:
    ds_read_b128 v[40:43], v12 offset:30848
    s_waitcnt lgkmcnt(4)
    v_mfma_f32_16x16x32_bf16 v[92:95], v[20:23], v[44:47], v[124:127]
    v_exp_f32 v2, v108
    ds_read_b128 v[20:23], v13 offset:24704
    v_mfma_f32_16x16x32_bf16 v[96:99], v[24:27], v[44:47], v[124:127]
    s_add_u32 s73, s72, s93
    s_bitcmp0_b32 0x3f, s73
    s_cbranch_scc1 K1_np12
    s_sleep 4
K1_np12:
    ds_read_b128 v[24:27], v13 offset:30848
    ds_read_b32 v254, v10 offset:64
    s_waitcnt lgkmcnt(5)
    v_mfma_f32_16x16x32_bf16 v[92:95], v[28:31], v[52:55], v[92:95]
    v_exp_f32 v3, v109
    ds_read_b128 v[28:31], v12 offset:24832
    v_mfma_f32_16x16x32_bf16 v[96:99], v[32:35], v[52:55], v[96:99]
    v_exp_f32 v4, v110
    ds_read_b128 v[32:35], v12 offset:30976
    s_waitcnt lgkmcnt(5)
    v_mfma_f32_16x16x32_bf16 v[92:95], v[36:39], v[60:63], v[92:95]
    v_exp_f32 v5, v111
    ds_read_b128 v[36:39], v13 offset:24832
    v_mfma_f32_16x16x32_bf16 v[96:99], v[40:43], v[60:63], v[96:99]
    ds_read_b128 v[40:43], v13 offset:30976
    s_waitcnt lgkmcnt(4)
    v_mfma_f32_16x16x32_bf16 v[92:95], v[20:23], v[68:71], v[92:95]
    v_cvt_pk_bf16_f32 v148, v2, v3
    v_add_f32 v134, v132, v2
    v_cmp_ge_i32 vcc, v255, v254
    v_add_u32 v255, 1, v255
    ds_write_b32 v10, v255
    s_cbranch_vccnz K1_sp13
K1_sp13b:
    ds_read_b64_tr_b16 v[20:21], v16 offset:0
    ds_read_b64_tr_b16 v[22:23], v16 offset:6144
    v_mfma_f32_16x16x32_bf16 v[96:99], v[24:27], v[68:71], v[96:99]
    v_add_f32 v134, v134, v3
    ds_read_b64_tr_b16 v[24:25], v17 offset:0
    ds_read_b64_tr_b16 v[26:27], v17 offset:6144
    s_waitcnt lgkmcnt(7)
    v_mfma_f32_16x16x32_bf16 v[92:95], v[28:31], v[76:79], v[92:95]
    v_exp_f32 v252, v112
    ds_read_b64_tr_b16 v[28:29], v18 offset:0
    ds_read_b64_tr_b16 v[30:31], v18 offset:6144
    v_mfma_f32_16x16x32_bf16 v[96:99], v[32:35], v[76:79], v[96:99]
    ds_read_b64_tr_b16 v[32:33], v19 offset:0
    ds_read_b64_tr_b16 v[34:35], v19 offset:6144
    s_waitcnt lgkmcnt(9)
    v_mfma_f32_16x16x32_bf16 v[92:95], v[36:39], v[84:87], v[92:95]
    v_exp_f32 v253, v113
    ds_read_b64_tr_b16 v[36:37], v16 offset:128
    ds_read_b64_tr_b16 v[38:39], v16 offset:6272
    v_mfma_f32_16x16x32_bf16 v[96:99], v[40:43], v[84:87], v[96:99]
    ds_read_b64_tr_b16 v[40:41], v17 offset:128
    ds_read_b64_tr_b16 v[42:43], v17 offset:6272
    s_waitcnt lgkmcnt(8)
    v_mfma_f32_16x16x32_bf16 v[156:159], v[20:23], v[140:143], v[156:159]
    v_cvt_pk_bf16_f32 v149, v4, v5
    v_add_f32 v134, v134, v4
    ds_read_b64_tr_b16 v[20:21], v18 offset:128
    ds_read_b64_tr_b16 v[22:23], v18 offset:6272
    v_mfma_f32_16x16x32_bf16 v[164:167], v[24:27], v[140:143], v[164:167]
    v_add_f32 v134, v134, v5
    ds_read_b64_tr_b16 v[24:25], v19 offset:128
    ds_read_b64_tr_b16 v[26:27], v19 offset:6272
    ds_read_b32 v254, v10 offset:64
    s_waitcnt lgkmcnt(9)
    v_mfma_f32_16x16x32_bf16 v[172:175], v[28:31], v[140:143], v[172:175]
    ds_read_b64_tr_b16 v[28:29], v16 offset:256
    ds_read_b64_tr_b16 v[30:31], v16 offset:6400
    v_mfma_f32_16x16x32_bf16 v[180:183], v[32:35], v[140:143], v[180:183]
    v_exp_f32 v2, v114
    ds_read_b64_tr_b16 v[32:33], v17 offset:256
    ds_read_b64_tr_b16 v[34:35], v17 offset:6400
    s_waitcnt lgkmcnt(9)
    v_mfma_f32_16x16x32_bf16 v[188:191], v[36:39], v[140:143], v[188:191]
    v_exp_f32 v3, v115
    ds_read_b64_tr_b16 v[36:37], v18 offset:256
    ds_read_b64_tr_b16 v[38:39], v18 offset:6400
    v_mfma_f32_16x16x32_bf16 v[196:199], v[40:43], v[140:143], v[196:199]
    ds_read_b64_tr_b16 v[40:41], v19 offset:256
    ds_read_b64_tr_b16 v[42:43], v19 offset:6400
    s_waitcnt lgkmcnt(8)
    v_mfma_f32_16x16x32_bf16 v[204:207], v[20:23], v[140:143], v[204:207]
    v_cvt_pk_bf16_f32 v150, v252, v253
    v_cmp_ge_i32 vcc, v255, v254
    v_add_u32 v255, 1, v255
    ds_write_b32 v10, v255
    s_cbranch_vccnz K1_sp14
K1_sp14b:
    ds_read_b128 v[20:23], v12 offset:36864
    v_mfma_f32_16x16x32_bf16 v[212:215], v[24:27], v[140:143], v[212:215]
    v_add_f32 v134, v134, v252
    v_add_f32 v134, v134, v253
    ds_read_b128 v[24:27], v12 offset:43008
    s_waitcnt lgkmcnt(7)
    v_mfma_f32_16x16x32_bf16 v[220:223], v[28:31], v[140:143], v[220:223]
    v_cvt_pk_bf16_f32 v151, v2, v3
    ds_read_b128 v[28:31], v13 offset:36864
    v_mfma_f32_16x16x32_bf16 v[228:231], v[32:35], v[140:143], v[228:231]
    v_add_f32 v134, v134, v2
    v_add_f32 v134, v134, v3
    ds_read_b128 v[32:35], v13 offset:43008
    s_waitcnt lgkmcnt(5)
    v_mfma_f32_16x16x32_bf16 v[236:239], v[36:39], v[140:143], v[236:239]
    v_cmp_lt_f32 vcc, 0x4b800000, v134
    ds_read_b128 v[36:39], v12 offset:36992
    v_mfma_f32_16x16x32_bf16 v[244:247], v[40:43], v[140:143], v[244:247]
    s_cbranch_vccnz K1_sl15
K1_sl15b:
    ds_read_b128 v[40:43], v12 offset:43136
    s_waitcnt lgkmcnt(4)
    v_mfma_f32_16x16x32_bf16 v[108:111], v[20:23], v[44:47], v[124:127]
    v_exp_f32 v2, v92
    ds_read_b128 v[20:23], v13 offset:36992
    v_mfma_f32_16x16x32_bf16 v[112:115], v[24:27], v[44:47], v[124:127]
    s_add_u32 s73, s72, s93
    s_bitcmp0_b32 0x3f, s73
    s_cbranch_scc1 K1_np16
    s_sleep 4
K1_np16:
    ds_read_b128 v[24:27], v13 offset:43136
    ds_read_b32 v254, v10 offset:64
    s_waitcnt lgkmcnt(5)
    v_mfma_f32_16x16x32_bf16 v[108:111], v[28:31], v[52:55], v[108:111]
    v_exp_f32 v3, v93
    ds_read_b128 v[28:31], v12 offset:37120
    v_mfma_f32_16x16x32_bf16 v[112:115], v[32:35], v[52:55], v[112:115]
    v_exp_f32 v4, v94
    ds_read_b128 v[32:35], v12 offset:43264
    s_waitcnt lgkmcnt(5)
    v_mfma_f32_16x16x32_bf16 v[108:111], v[36:39], v[60:63], v[108:111]
    v_exp_f32 v5, v95
    ds_read_b128 v[36:39], v13 offset:37120
    v_mfma_f32_16x16x32_bf16 v[112:115], v[40:43], v[60:63], v[112:115]
    ds_read_b128 v[40:43], v13 offset:43264
    s_waitcnt lgkmcnt(4)
    v_mfma_f32_16x16x32_bf16 v[108:111], v[20:23], v[68:71], v[108:111]
    v_cvt_pk_bf16_f32 v140, v2, v3
    v_add_f32 v132, v134, v2
    v_cmp_ge_i32 vcc, v255, v254
    v_add_u32 v255, 1, v255
    ds_write_b32 v10, v255
    s_cbranch_vccnz K1_sp17
K1_sp17b:
    ds_read_b64_tr_b16 v[20:21], v16 offset:12288
    ds_read_b64_tr_b16 v[22:23], v16 offset:18432
    v_mfma_f32_16x16x32_bf16 v[112:115], v[24:27], v[68:71], v[112:115]
    v_add_f32 v132, v132, v3
    ds_read_b64_tr_b16 v[24:25], v17 offset:12288
    ds_read_b64_tr_b16 v[26:27], v17 offset:18432
    s_waitcnt lgkmcnt(7)
    v_mfma_f32_16x16x32_bf16 v[108:111], v[28:31], v[76:79], v[108:111]
    v_exp_f32 v252, v96
    ds_read_b64_tr_b16 v[28:29], v18 offset:12288
    ds_read_b64_tr_b16 v[30:31], v18 offset:18432
    v_mfma_f32_16x16x32_bf16 v[112:115], v[32:35], v[76:79], v[112:115]
    ds_read_b64_tr_b16 v[32:33], v19 offset:12288
    ds_read_b64_tr_b16 v[34:35], v19 offset:18432
    s_waitcnt lgkmcnt(9)
    v_mfma_f32_16x16x32_bf16 v[108:111], v[36:39], v[84:87], v[108:111]
    v_exp_f32 v253, v97
    ds_read_b64_tr_b16 v[36:37], v16 offset:12416
    ds_read_b64_tr_b16 v[38:39], v16 offset:18560
    v_mfma_f32_16x16x32_bf16 v[112:115], v[40:43], v[84:87], v[112:115]
    ds_read_b64_tr_b16 v[40:41], v17 offset:12416
    ds_read_b64_tr_b16 v[42:43], v17 offset:18560
    s_waitcnt lgkmcnt(8)
    v_mfma_f32_16x16x32_bf16 v[156:159], v[20:23], v[148:151], v[156:159]
    v_cvt_pk_bf16_f32 v141, v4, v5
    v_add_f32 v132, v132, v4
    ds_read_b64_tr_b16 v[20:21], v18 offset:12416
    ds_read_b64_tr_b16 v[22:23], v18 offset:18560
    v_mfma_f32_16x16x32_bf16 v[164:167], v[24:27], v[148:151], v[164:167]
    v_add_f32 v132, v132, v5
    ds_read_b64_tr_b16 v[24:25], v19 offset:12416
    ds_read_b64_tr_b16 v[26:27], v19 offset:18560
    ds_read_b32 v254, v10 offset:64
    s_waitcnt lgkmcnt(9)
    v_mfma_f32_16x16x32_bf16 v[172:175], v[28:31], v[148:151], v[172:175]
    ds_read_b64_tr_b16 v[28:29], v16 offset:12544
    ds_read_b64_tr_b16 v[30:31], v16 offset:18688
    v_mfma_f32_16x16x32_bf16 v[180:183], v[32:35], v[148:151], v[180:183]
    v_exp_f32 v2, v98
    ds_read_b64_tr_b16 v[32:33], v17 offset:12544
    ds_read_b64_tr_b16 v[34:35], v17 offset:18688
    s_waitcnt lgkmcnt(9)
    v_mfma_f32_16x16x32_bf16 v[188:191], v[36:39], v[148:151], v[188:191]
    v_exp_f32 v3, v99
    ds_read_b64_tr_b16 v[36:37], v18 offset:12544
    ds_read_b64_tr_b16 v[38:39], v18 offset:18688
    v_mfma_f32_16x16x32_bf16 v[196:199], v[40:43], v[148:151], v[196:199]
    ds_read_b64_tr_b16 v[40:41], v19 offset:12544
    ds_read_b64_tr_b16 v[42:43], v19 offset:18688
    s_waitcnt lgkmcnt(8)
    v_mfma_f32_16x16x32_bf16 v[204:207], v[20:23], v[148:151], v[204:207]
    v_cvt_pk_bf16_f32 v142, v252, v253
    v_cmp_ge_i32 vcc, v255, v254
    s_cmp_eq_u32 s93, 3
    s_cbranch_scc1 K1_A_endx
    v_add_u32 v255, 1, v255
    ds_write_b32 v10, v255
    s_cbranch_vccnz K1_sp18
K1_sp18b:
    ds_read_b128 v[20:23], v12 offset:0
    v_mfma_f32_16x16x32_bf16 v[212:215], v[24:27], v[148:151], v[212:215]
    v_add_f32 v132, v132, v252
    v_add_f32 v132, v132, v253
    ds_read_b128 v[24:27], v12 offset:6144
    s_waitcnt lgkmcnt(7)
    v_mfma_f32_16x16x32_bf16 v[220:223], v[28:31], v[148:151], v[220:223]
    v_cvt_pk_bf16_f32 v143, v2, v3
    ds_read_b128 v[28:31], v13 offset:0
    v_mfma_f32_16x16x32_bf16 v[228:231], v[32:35], v[148:151], v[228:231]
    v_add_f32 v132, v132, v2
    v_add_f32 v132, v132, v3
    ds_read_b128 v[32:35], v13 offset:6144
    s_waitcnt lgkmcnt(5)
    v_mfma_f32_16x16x32_bf16 v[236:239], v[36:39], v[148:151], v[236:239]
    v_cmp_lt_f32 vcc, 0x4b800000, v132
    ds_read_b128 v[36:39], v12 offset:128
    v_mfma_f32_16x16x32_bf16 v[244:247], v[40:43], v[148:151], v[244:247]
    s_cbranch_vccnz K1_sl19
K1_sl19b:
    ds_read_b128 v[40:43], v12 offset:6272
    s_waitcnt lgkmcnt(4)
    v_mfma_f32_16x16x32_bf16 v[92:95], v[20:23], v[44:47], v[124:127]
    v_exp_f32 v2, v108
    ds_read_b128 v[20:23], v13 offset:128
    v_mfma_f32_16x16x32_bf16 v[96:99], v[24:27], v[44:47], v[124:127]
    s_add_u32 s73, s72, s93
    s_bitcmp0_b32 0x3f, s73
    s_cbranch_scc1 K1_np20
    s_sleep 4
K1_np20:
    ds_read_b128 v[24:27], v13 offset:6272
    ds_read_b32 v254, v10 offset:64
    s_waitcnt lgkmcnt(5)
    v_mfma_f32_16x16x32_bf16 v[92:95], v[28:31], v[52:55], v[92:95]
    v_exp_f32 v3, v109
    ds_read_b128 v[28:31], v12 offset:256
    v_mfma_f32_16x16x32_bf16 v[96:99], v[32:35], v[52:55], v[96:99]
    v_exp_f32 v4, v110
    ds_read_b128 v[32:35], v12 offset:6400
    s_waitcnt lgkmcnt(5)
    v_mfma_f32_16x16x32_bf16 v[92:95], v[36:39], v[60:63], v[92:95]
    v_exp_f32 v5, v111
    ds_read_b128 v[36:39], v13 offset:256
    v_mfma_f32_16x16x32_bf16 v[96:99], v[40:43], v[60:63], v[96:99]
    ds_read_b128 v[40:43], v13 offset:6400
    s_waitcnt lgkmcnt(4)
    v_mfma_f32_16x16x32_bf16 v[92:95], v[20:23], v[68:71], v[92:95]
    v_cvt_pk_bf16_f32 v148, v2, v3
    v_add_f32 v134, v132, v2
    v_cmp_ge_i32 vcc, v255, v254
    v_add_u32 v255, 1, v255
    ds_write_b32 v10, v255
    s_cbranch_vccnz K1_sp21
K1_sp21b:
    ds_read_b64_tr_b16 v[20:21], v16 offset:24576
    ds_read_b64_tr_b16 v[22:23], v16 offset:30720
    v_mfma_f32_16x16x32_bf16 v[96:99], v[24:27], v[68:71], v[96:99]
    v_add_f32 v134, v134, v3
    ds_read_b64_tr_b16 v[24:25], v17 offset:24576
    ds_read_b64_tr_b16 v[26:27], v17 offset:30720
    s_waitcnt lgkmcnt(7)
    v_mfma_f32_16x16x32_bf16 v[92:95], v[28:31], v[76:79], v[92:95]
    v_exp_f32 v252, v112
    ds_read_b64_tr_b16 v[28:29], v18 offset:24576
    ds_read_b64_tr_b16 v[30:31], v18 offset:30720
    v_mfma_f32_16x16x32_bf16 v[96:99], v[32:35], v[76:79], v[96:99]
    ds_read_b64_tr_b16 v[32:33], v19 offset:24576
    ds_read_b64_tr_b16 v[34:35], v19 offset:30720
    s_waitcnt lgkmcnt(9)
    v_mfma_f32_16x16x32_bf16 v[92:95], v[36:39], v[84:87], v[92:95]
    v_exp_f32 v253, v113
    ds_read_b64_tr_b16 v[36:37], v16 offset:24704
    ds_read_b64_tr_b16 v[38:39], v16 offset:30848
    v_mfma_f32_16x16x32_bf16 v[96:99], v[40:43], v[84:87], v[96:99]
    ds_read_b64_tr_b16 v[40:41], v17 offset:24704
    ds_read_b64_tr_b16 v[42:43], v17 offset:30848
    s_waitcnt lgkmcnt(8)
    v_mfma_f32_16x16x32_bf16 v[156:159], v[20:23], v[140:143], v[156:159]
    v_cvt_pk_bf16_f32 v149, v4, v5
    v_add_f32 v134, v134, v4
    ds_read_b64_tr_b16 v[20:21], v18 offset:24704
    ds_read_b64_tr_b16 v[22:23], v18 offset:30848
    v_mfma_f32_16x16x32_bf16 v[164:167], v[24:27], v[140:143], v[164:167]
    v_add_f32 v134, v134, v5
    ds_read_b64_tr_b16 v[24:25], v19 offset:24704
    ds_read_b64_tr_b16 v[26:27], v19 offset:30848
    ds_read_b32 v254, v10 offset:64
    s_waitcnt lgkmcnt(9)
    v_mfma_f32_16x16x32_bf16 v[172:175], v[28:31], v[140:143], v[172:175]
    ds_read_b64_tr_b16 v[28:29], v16 offset:24832
    ds_read_b64_tr_b16 v[30:31], v16 offset:30976
    v_mfma_f32_16x16x32_bf16 v[180:183], v[32:35], v[140:143], v[180:183]
    v_exp_f32 v2, v114
    ds_read_b64_tr_b16 v[32:33], v17 offset:24832
    ds_read_b64_tr_b16 v[34:35], v17 offset:30976
    s_waitcnt lgkmcnt(9)
    v_mfma_f32_16x16x32_bf16 v[188:191], v[36:39], v[140:143], v[188:191]
    v_exp_f32 v3, v115
    ds_read_b64_tr_b16 v[36:37], v18 offset:24832
    ds_read_b64_tr_b16 v[38:39], v18 offset:30976
    v_mfma_f32_16x16x32_bf16 v[196:199], v[40:43], v[140:143], v[196:199]
    ds_read_b64_tr_b16 v[40:41], v19 offset:24832
    ds_read_b64_tr_b16 v[42:43], v19 offset:30976
    s_waitcnt lgkmcnt(8)
    v_mfma_f32_16x16x32_bf16 v[204:207], v[20:23], v[140:143], v[204:207]
    v_cvt_pk_bf16_f32 v150, v252, v253
    v_cmp_ge_i32 vcc, v255, v254
    v_add_u32 v255, 1, v255
    ds_write_b32 v10, v255
    s_cbranch_vccnz K1_sp22
K1_sp22b:
    ds_read_b128 v[20:23], v12 offset:12288
    v_mfma_f32_16x16x32_bf16 v[212:215], v[24:27], v[140:143], v[212:215]
    v_add_f32 v134, v134, v252
    v_add_f32 v134, v134, v253
    ds_read_b128 v[24:27], v12 offset:18432
    s_waitcnt lgkmcnt(7)
    v_mfma_f32_16x16x32_bf16 v[220:223], v[28:31], v[140:143], v[220:223]
    v_cvt_pk_bf16_f32 v151, v2, v3
    ds_read_b128 v[28:31], v13 offset:12288
    v_mfma_f32_16x16x32_bf16 v[228:231], v[32:35], v[140:143], v[228:231]
    v_add_f32 v134, v134, v2
    v_add_f32 v134, v134, v3
    ds_read_b128 v[32:35], v13 offset:18432
    s_waitcnt lgkmcnt(5)
    v_mfma_f32_16x16x32_bf16 v[236:239], v[36:39], v[140:143], v[236:239]
    v_cmp_lt_f32 vcc, 0x4b800000, v134
    ds_read_b128 v[36:39], v12 offset:12416
    v_mfma_f32_16x16x32_bf16 v[244:247], v[40:43], v[140:143], v[244:247]
    s_cbranch_vccnz K1_sl23
K1_sl23b:
    ds_read_b128 v[40:43], v12 offset:18560
    s_waitcnt lgkmcnt(4)
    v_mfma_f32_16x16x32_bf16 v[108:111], v[20:23], v[44:47], v[124:127]
    v_exp_f32 v2, v92
    ds_read_b128 v[20:23], v13 offset:12416
    v_mfma_f32_16x16x32_bf16 v[112:115], v[24:27], v[44:47], v[124:127]
    s_add_u32 s73, s72, s93
    s_bitcmp0_b32 0x3f, s73
    s_cbranch_scc1 K1_np24
    s_sleep 4
K1_np24:
    ds_read_b128 v[24:27], v13 offset:18560
    ds_read_b32 v254, v10 offset:64
    s_waitcnt lgkmcnt(5)
    v_mfma_f32_16x16x32_bf16 v[108:111], v[28:31], v[52:55], v[108:111]
    v_exp_f32 v3, v93
    ds_read_b128 v[28:31], v12 offset:12544
    v_mfma_f32_16x16x32_bf16 v[112:115], v[32:35], v[52:55], v[112:115]
    v_exp_f32 v4, v94
    ds_read_b128 v[32:35], v12 offset:18688
    s_waitcnt lgkmcnt(5)
    v_mfma_f32_16x16x32_bf16 v[108:111], v[36:39], v[60:63], v[108:111]
    v_exp_f32 v5, v95
    ds_read_b128 v[36:39], v13 offset:12544
    v_mfma_f32_16x16x32_bf16 v[112:115], v[40:43], v[60:63], v[112:115]
    ds_read_b128 v[40:43], v13 offset:18688
    s_waitcnt lgkmcnt(4)
    v_mfma_f32_16x16x32_bf16 v[108:111], v[20:23], v[68:71], v[108:111]
    v_cvt_pk_bf16_f32 v140, v2, v3
    v_add_f32 v132, v134, v2
    v_cmp_ge_i32 vcc, v255, v254
    v_add_u32 v255, 1, v255
    ds_write_b32 v10, v255
    s_cbranch_vccnz K1_sp25
K1_sp25b:
    ds_read_b64_tr_b16 v[20:21], v16 offset:36864
    ds_read_b64_tr_b16 v[22:23], v16 offset:43008
    v_mfma_f32_16x16x32_bf16 v[112:115], v[24:27], v[68:71], v[112:115]
    v_add_f32 v132, v132, v3
    ds_read_b64_tr_b16 v[24:25], v17 offset:36864
    ds_read_b64_tr_b16 v[26:27], v17 offset:43008
    s_waitcnt lgkmcnt(7)
    v_mfma_f32_16x16x32_bf16 v[108:111], v[28:31], v[76:79], v[108:111]
    v_exp_f32 v252, v96
    ds_read_b64_tr_b16 v[28:29], v18 offset:36864
    ds_read_b64_tr_b16 v[30:31], v18 offset:43008
    v_mfma_f32_16x16x32_bf16 v[112:115], v[32:35], v[76:79], v[112:115]
    ds_read_b64_tr_b16 v[32:33], v19 offset:36864
    ds_read_b64_tr_b16 v[34:35], v19 offset:43008
    s_waitcnt lgkmcnt(9)
    v_mfma_f32_16x16x32_bf16 v[108:111], v[36:39], v[84:87], v[108:111]
    v_exp_f32 v253, v97
    ds_read_b64_tr_b16 v[36:37], v16 offset:36992
    ds_read_b64_tr_b16 v[38:39], v16 offset:43136
    v_mfma_f32_16x16x32_bf16 v[112:115], v[40:43], v[84:87], v[112:115]
    ds_read_b64_tr_b16 v[40:41], v17 offset:36992
    ds_read_b64_tr_b16 v[42:43], v17 offset:43136
    s_waitcnt lgkmcnt(8)
    v_mfma_f32_16x16x32_bf16 v[156:159], v[20:23], v[148:151], v[156:159]
    v_cvt_pk_bf16_f32 v141, v4, v5
    v_add_f32 v132, v132, v4
    ds_read_b64_tr_b16 v[20:21], v18 offset:36992
    ds_read_b64_tr_b16 v[22:23], v18 offset:43136
    v_mfma_f32_16x16x32_bf16 v[164:167], v[24:27], v[148:151], v[164:167]
    v_add_f32 v132, v132, v5
    ds_read_b64_tr_b16 v[24:25], v19 offset:36992
    ds_read_b64_tr_b16 v[26:27], v19 offset:43136
    ds_read_b32 v254, v10 offset:64
    s_waitcnt lgkmcnt(9)
    v_mfma_f32_16x16x32_bf16 v[172:175], v[28:31], v[148:151], v[172:175]
    ds_read_b64_tr_b16 v[28:29], v16 offset:37120
    ds_read_b64_tr_b16 v[30:31], v16 offset:43264
    v_mfma_f32_16x16x32_bf16 v[180:183], v[32:35], v[148:151], v[180:183]
    v_exp_f32 v2, v98
    ds_read_b64_tr_b16 v[32:33], v17 offset:37120
    ds_read_b64_tr_b16 v[34:35], v17 offset:43264
    s_waitcnt lgkmcnt(9)
    v_mfma_f32_16x16x32_bf16 v[188:191], v[36:39], v[148:151], v[188:191]
    v_exp_f32 v3, v99
    ds_read_b64_tr_b16 v[36:37], v18 offset:37120
    ds_read_b64_tr_b16 v[38:39], v18 offset:43264
    v_mfma_f32_16x16x32_bf16 v[196:199], v[40:43], v[148:151], v[196:199]
    ds_read_b64_tr_b16 v[40:41], v19 offset:37120
    ds_read_b64_tr_b16 v[42:43], v19 offset:43264
    s_waitcnt lgkmcnt(8)
    v_mfma_f32_16x16x32_bf16 v[204:207], v[20:23], v[148:151], v[204:207]
    v_cvt_pk_bf16_f32 v142, v252, v253
    v_cmp_ge_i32 vcc, v255, v254
    v_add_u32 v255, 1, v255
    ds_write_b32 v10, v255
    s_cbranch_vccnz K1_sp26
K1_sp26b:
    ds_read_b128 v[20:23], v12 offset:24576
    v_mfma_f32_16x16x32_bf16 v[212:215], v[24:27], v[148:151], v[212:215]
    v_add_f32 v132, v132, v252
    v_add_f32 v132, v132, v253
    ds_read_b128 v[24:27], v12 offset:30720
    s_waitcnt lgkmcnt(7)
    v_mfma_f32_16x16x32_bf16 v[220:223], v[28:31], v[148:151], v[220:223]
    v_cvt_pk_bf16_f32 v143, v2, v3
    ds_read_b128 v[28:31], v13 offset:24576
    v_mfma_f32_16x16x32_bf16 v[228:231], v[32:35], v[148:151], v[228:231]
    v_add_f32 v132, v132, v2
    v_add_f32 v132, v132, v3
    ds_read_b128 v[32:35], v13 offset:30720
    s_waitcnt lgkmcnt(5)
    v_mfma_f32_16x16x32_bf16 v[236:239], v[36:39], v[148:151], v[236:239]
    v_cmp_lt_f32 vcc, 0x4b800000, v132
    ds_read_b128 v[36:39], v12 offset:24704
    v_mfma_f32_16x16x32_bf16 v[244:247], v[40:43], v[148:151], v[244:247]
    s_cbranch_vccnz K1_sl27
K1_sl27b:
    s_add_u32 s93, s93, 1
    s_branch K1_A_loopx
K1_A_endx:
    v_add_u32 v255, 1, v255
    ds_write_b32 v10, v255
    s_cbranch_vccnz K1_sp28
K1_sp28b:
    ds_read_b64_tr_b16 v[20:21], v16 offset:24576
    ds_read_b64_tr_b16 v[22:23], v16 offset:30720
    v_mfma_f32_16x16x32_bf16 v[212:215], v[24:27], v[148:151], v[212:215]
    v_add_f32 v132, v132, v252
    v_add_f32 v132, v132, v253
    ds_read_b64_tr_b16 v[24:25], v17 offset:24576
    ds_read_b64_tr_b16 v[26:27], v17 offset:30720
    s_waitcnt lgkmcnt(9)
    v_mfma_f32_16x16x32_bf16 v[220:223], v[28:31], v[148:151], v[220:223]
    v_cvt_pk_bf16_f32 v143, v2, v3
    ds_read_b64_tr_b16 v[28:29], v18 offset:24576
    ds_read_b64_tr_b16 v[30:31], v18 offset:30720
    v_mfma_f32_16x16x32_bf16 v[228:231], v[32:35], v[148:151], v[228:231]
    v_add_f32 v132, v132, v2
    v_add_f32 v132, v132, v3
    ds_read_b64_tr_b16 v[32:33], v19 offset:24576
    ds_read_b64_tr_b16 v[34:35], v19 offset:30720
    s_waitcnt lgkmcnt(9)
    v_mfma_f32_16x16x32_bf16 v[236:239], v[36:39], v[148:151], v[236:239]
    v_cmp_lt_f32 vcc, 0x4b800000, v132
    ds_read_b64_tr_b16 v[36:37], v16 offset:24704
    ds_read_b64_tr_b16 v[38:39], v16 offset:30848
    v_mfma_f32_16x16x32_bf16 v[244:247], v[40:43], v[148:151], v[244:247]
    s_cbranch_vccnz K1_sl29
K1_sl29b:
    ds_read_b64_tr_b16 v[40:41], v17 offset:24704
    ds_read_b64_tr_b16 v[42:43], v17 offset:30848
    s_waitcnt lgkmcnt(8)
    v_mfma_f32_16x16x32_bf16 v[156:159], v[20:23], v[140:143], v[156:159]
    v_exp_f32 v2, v108
    ds_read_b64_tr_b16 v[20:21], v18 offset:24704
    ds_read_b64_tr_b16 v[22:23], v18 offset:30848
    v_mfma_f32_16x16x32_bf16 v[164:167], v[24:27], v[140:143], v[164:167]
    v_exp_f32 v3, v109
    v_exp_f32 v4, v110
    ds_read_b64_tr_b16 v[24:25], v19 offset:24704
    ds_read_b64_tr_b16 v[26:27], v19 offset:30848
    ds_read_b32 v254, v10 offset:64
    s_waitcnt lgkmcnt(9)
    v_mfma_f32_16x16x32_bf16 v[172:175], v[28:31], v[140:143], v[172:175]
    v_exp_f32 v5, v111
    ds_read_b64_tr_b16 v[28:29], v16 offset:24832
    ds_read_b64_tr_b16 v[30:31], v16 offset:30976
    v_mfma_f32_16x16x32_bf16 v[180:183], v[32:35], v[140:143], v[180:183]
    v_cvt_pk_bf16_f32 v148, v2, v3
    v_add_f32 v134, v132, v2
    v_add_f32 v134, v134, v3
    ds_read_b64_tr_b16 v[32:33], v17 offset:24832
    ds_read_b64_tr_b16 v[34:35], v17 offset:30976
    s_waitcnt lgkmcnt(9)
    v_mfma_f32_16x16x32_bf16 v[188:191], v[36:39], v[140:143], v[188:191]
    v_exp_f32 v252, v112
    ds_read_b64_tr_b16 v[36:37], v18 offset:24832
    ds_read_b64_tr_b16 v[38:39], v18 offset:30976
    v_mfma_f32_16x16x32_bf16 v[196:199], v[40:43], v[140:143], v[196:199]
    v_exp_f32 v253, v113
    v_cvt_pk_bf16_f32 v149, v4, v5
    ds_read_b64_tr_b16 v[40:41], v19 offset:24832
    ds_read_b64_tr_b16 v[42:43], v19 offset:30976
    s_waitcnt lgkmcnt(8)
    v_mfma_f32_16x16x32_bf16 v[204:207], v[20:23], v[140:143], v[204:207]
    v_add_f32 v134, v134, v4
    v_add_f32 v134, v134, v5
    v_cmp_ge_i32 vcc, v255, v254
    v_add_u32 v255, 1, v255
    ds_write_b32 v10, v255
    s_cbranch_vccnz K1_sp30
K1_sp30b:
    ds_read_b64_tr_b16 v[20:21], v16 offset:36864
    ds_read_b64_tr_b16 v[22:23], v16 offset:43008
    v_mfma_f32_16x16x32_bf16 v[212:215], v[24:27], v[140:143], v[212:215]
    v_exp_f32 v2, v114
    v_exp_f32 v3, v115
    ds_read_b64_tr_b16 v[24:25], v17 offset:36864
    ds_read_b64_tr_b16 v[26:27], v17 offset:43008
    s_waitcnt lgkmcnt(9)
    v_mfma_f32_16x16x32_bf16 v[220:223], v[28:31], v[140:143], v[220:223]
    v_cvt_pk_bf16_f32 v150, v252, v253
    v_add_f32 v134, v134, v252
    ds_read_b64_tr_b16 v[28:29], v18 offset:36864
    ds_read_b64_tr_b16 v[30:31], v18 offset:43008
    v_mfma_f32_16x16x32_bf16 v[228:231], v[32:35], v[140:143], v[228:231]
    v_add_f32 v134, v134, v253
    v_cvt_pk_bf16_f32 v151, v2, v3
    ds_read_b64_tr_b16 v[32:33], v19 offset:36864
    ds_read_b64_tr_b16 v[34:35], v19 offset:43008
    s_waitcnt lgkmcnt(9)
    v_mfma_f32_16x16x32_bf16 v[236:239], v[36:39], v[140:143], v[236:239]
    v_add_f32 v134, v134, v2
    v_add_f32 v134, v134, v3
    v_cmp_lt_f32 vcc, 0x4b800000, v134
    ds_read_b64_tr_b16 v[36:37], v16 offset:36992
    ds_read_b64_tr_b16 v[38:39], v16 offset:43136
    v_mfma_f32_16x16x32_bf16 v[244:247], v[40:43], v[140:143], v[244:247]
    s_cbranch_vccnz K1_sl31
K1_sl31b:
    ds_read_b64_tr_b16 v[40:41], v17 offset:36992
    ds_read_b64_tr_b16 v[42:43], v17 offset:43136
    s_waitcnt lgkmcnt(8)
    v_mfma_f32_16x16x32_bf16 v[156:159], v[20:23], v[148:151], v[156:159]
    ds_read_b64_tr_b16 v[20:21], v18 offset:36992
    ds_read_b64_tr_b16 v[22:23], v18 offset:43136
    v_mfma_f32_16x16x32_bf16 v[164:167], v[24:27], v[148:151], v[164:167]
    ds_read_b64_tr_b16 v[24:25], v19 offset:36992
    ds_read_b64_tr_b16 v[26:27], v19 offset:43136
    ds_read_b32 v254, v10 offset:64
    s_waitcnt lgkmcnt(9)
    v_mfma_f32_16x16x32_bf16 v[172:175], v[28:31], v[148:151], v[172:175]
    ds_read_b64_tr_b16 v[28:29], v16 offset:37120
    ds_read_b64_tr_b16 v[30:31], v16 offset:43264
    v_mfma_f32_16x16x32_bf16 v[180:183], v[32:35], v[148:151], v[180:183]
    ds_read_b64_tr_b16 v[32:33], v17 offset:37120
    ds_read_b64_tr_b16 v[34:35], v17 offset:43264
    s_waitcnt lgkmcnt(9)
    v_mfma_f32_16x16x32_bf16 v[188:191], v[36:39], v[148:151], v[188:191]
    ds_read_b64_tr_b16 v[36:37], v18 offset:37120
    ds_read_b64_tr_b16 v[38:39], v18 offset:43264
    v_mfma_f32_16x16x32_bf16 v[196:199], v[40:43], v[148:151], v[196:199]
    ds_read_b64_tr_b16 v[40:41], v19 offset:37120
    ds_read_b64_tr_b16 v[42:43], v19 offset:43264
    s_waitcnt lgkmcnt(8)
    v_mfma_f32_16x16x32_bf16 v[204:207], v[20:23], v[148:151], v[204:207]
    v_cmp_ge_i32 vcc, v255, v254
    v_add_u32 v255, 1, v255
    ds_write_b32 v10, v255
    s_cbranch_vccnz K1_sp32
K1_sp32b:
    ds_read_b128 v[20:23], v12 offset:0
    v_mfma_f32_16x16x32_bf16 v[212:215], v[24:27], v[148:151], v[212:215]
    ds_read_b128 v[24:27], v12 offset:6144
    s_waitcnt lgkmcnt(7)
    v_mfma_f32_16x16x32_bf16 v[220:223], v[28:31], v[148:151], v[220:223]
    ds_read_b128 v[28:31], v13 offset:0
    v_mfma_f32_16x16x32_bf16 v[228:231], v[32:35], v[148:151], v[228:231]
    ds_read_b128 v[32:35], v13 offset:6144
    s_waitcnt lgkmcnt(5)
    v_mfma_f32_16x16x32_bf16 v[236:239], v[36:39], v[148:151], v[236:239]
    ds_read_b128 v[36:39], v12 offset:128
    v_mfma_f32_16x16x32_bf16 v[244:247], v[40:43], v[148:151], v[244:247]
    s_branch K1_A_hd
K1_A_h2:
    s_mov_b32 s93, 0
    ds_read_b128 v[40:43], v12 offset:6272
    s_waitcnt lgkmcnt(4)
    v_mfma_f32_16x16x32_bf16 v[92:95], v[20:23], v[44:47], 0
    v_mov_b64 v[156:157], 0
    v_mov_b64 v[158:159], 0
    v_mov_b64 v[160:161], 0
    v_mfma_f32_16x16x32_bf16 v[100:103], v[20:23], v[48:51], 0
    v_mov_b64 v[162:163], 0
    ds_read_b128 v[20:23], v13 offset:128
    v_mfma_f32_16x16x32_bf16 v[96:99], v[24:27], v[44:47], 0
    v_mov_b64 v[164:165], 0
    v_mov_b64 v[166:167], 0
    v_mov_b64 v[168:169], 0
    v_mfma_f32_16x16x32_bf16 v[104:107], v[24:27], v[48:51], 0
    v_mov_b64 v[170:171], 0
    ds_read_b128 v[24:27], v13 offset:6272
    ds_read_b32 v254, v10 offset:64
    s_waitcnt lgkmcnt(5)
    v_mfma_f32_16x16x32_bf16 v[92:95], v[28:31], v[52:55], v[92:95]
    v_mov_b64 v[172:173], 0
    v_mov_b64 v[174:175], 0
    v_mov_b64 v[176:177], 0
    v_mfma_f32_16x16x32_bf16 v[100:103], v[28:31], v[56:59], v[100:103]
    v_mov_b64 v[178:179], 0
    ds_read_b128 v[28:31], v12 offset:256
    v_mfma_f32_16x16x32_bf16 v[96:99], v[32:35], v[52:55], v[96:99]
    v_mov_b64 v[180:181], 0
    v_mov_b64 v[182:183], 0
    v_mov_b64 v[184:185], 0
    v_mfma_f32_16x16x32_bf16 v[104:107], v[32:35], v[56:59], v[104:107]
    v_mov_b64 v[186:187], 0
    ds_read_b128 v[32:35], v12 offset:6400
    s_waitcnt lgkmcnt(5)
    v_mfma_f32_16x16x32_bf16 v[92:95], v[36:39], v[60:63], v[92:95]
    v_mov_b64 v[188:189], 0
    v_mov_b64 v[190:191], 0
    v_mov_b64 v[192:193], 0
    v_mfma_f32_16x16x32_bf16 v[100:103], v[36:39], v[64:67], v[100:103]
    v_mov_b64 v[194:195], 0
    ds_read_b128 v[36:39], v13 offset:256
    v_mfma_f32_16x16x32_bf16 v[96:99], v[40:43], v[60:63], v[96:99]
    v_mov_b64 v[196:197], 0
    v_mov_b64 v[198:199], 0
    v_mov_b64 v[200:201], 0
    v_mfma_f32_16x16x32_bf16 v[104:107], v[40:43], v[64:67], v[104:107]
    v_mov_b64 v[202:203], 0
    ds_read_b128 v[40:43], v13 offset:6400
    s_waitcnt lgkmcnt(4)
    v_mfma_f32_16x16x32_bf16 v[92:95], v[20:23], v[68:71], v[92:95]
    v_mov_b64 v[204:205], 0
    v_mov_b64 v[206:207], 0
    v_mov_b64 v[208:209], 0
    v_mfma_f32_16x16x32_bf16 v[100:103], v[20:23], v[72:75], v[100:103]
    v_mov_b64 v[210:211], 0
    v_cmp_ge_i32 vcc, v255, v254
    v_add_u32 v255, 1, v255
    ds_write_b32 v10, v255
    s_cbranch_vccnz K1_sp33
K1_sp33b:
    ds_read_b128 v[20:23], v12 offset:12288
    v_mfma_f32_16x16x32_bf16 v[96:99], v[24:27], v[68:71], v[96:99]
    v_mov_b64 v[212:213], 0
    v_mov_b64 v[214:215], 0
    v_mov_b64 v[216:217], 0
    v_mfma_f32_16x16x32_bf16 v[104:107], v[24:27], v[72:75], v[104:107]
    v_mov_b64 v[218:219], 0
    ds_read_b128 v[24:27], v12 offset:18432
    s_waitcnt lgkmcnt(5)
    v_mfma_f32_16x16x32_bf16 v[92:95], v[28:31], v[76:79], v[92:95]
    v_mov_b64 v[220:221], 0
    v_mov_b64 v[222:223], 0
    v_mov_b64 v[224:225], 0
    v_mfma_f32_16x16x32_bf16 v[100:103], v[28:31], v[80:83], v[100:103]
    v_mov_b64 v[226:227], 0
    ds_read_b128 v[28:31], v13 offset:12288
    v_mfma_f32_16x16x32_bf16 v[96:99], v[32:35], v[76:79], v[96:99]
    v_mov_b64 v[228:229], 0
    v_mov_b64 v[230:231], 0
    v_mov_b64 v[232:233], 0
    v_mfma_f32_16x16x32_bf16 v[104:107], v[32:35], v[80:83], v[104:107]
    v_mov_b64 v[234:235], 0
    ds_read_b128 v[32:35], v13 offset:18432
    s_waitcnt lgkmcnt(5)
    v_mfma_f32_16x16x32_bf16 v[92:95], v[36:39], v[84:87], v[92:95]
    v_mov_b64 v[236:237], 0
    v_mov_b64 v[238:239], 0
    v_mov_b64 v[240:241], 0
    v_mfma_f32_16x16x32_bf16 v[100:103], v[36:39], v[88:91], v[100:103]
    v_mov_b64 v[242:243], 0
    ds_read_b128 v[36:39], v12 offset:12416
    v_mfma_f32_16x16x32_bf16 v[96:99], v[40:43], v[84:87], v[96:99]
    v_mov_b64 v[244:245], 0
    v_mov_b64 v[246:247], 0
    v_mov_b64 v[248:249], 0
    v_mfma_f32_16x16x32_bf16 v[104:107], v[40:43], v[88:91], v[104:107]
    v_mov_b64 v[250:251], 0
    s_nop 7
    v_max3_f32 v2, v92, v93, v94
    v_max3_f32 v3, v95, v96, v97
    v_max3_f32 v2, v2, v98, v99
    v_max3_f32 v4, v100, v101, v102
    v_max3_f32 v5, v103, v104, v105
    v_max3_f32 v4, v4, v106, v107
    v_max_f32 v2, v2, v3
    v_mov_b32 v3, v2
    v_max_f32 v4, v4, v5
    v_mov_b32 v5, v4
    s_nop 1
    v_permlane32_swap_b32 v2, v3
    v_permlane32_swap_b32 v4, v5
    v_max_f32 v2, v2, v3
    v_mov_b32 v3, v2
    v_max_f32 v4, v4, v5
    v_mov_b32 v5, v4
    s_nop 1
    v_permlane16_swap_b32 v2, v3
    v_permlane16_swap_b32 v4, v5
    v_max_f32 v2, v2, v3
    v_max_f32 v4, v4, v5
    v_mov_b32 v3, v2
    v_sub_f32 v124, 0, v2
    v_sub_f32 v125, 0, v2
    v_sub_f32 v126, 0, v2
    v_sub_f32 v127, 0, v2
    v_pk_add_f32 v[92:93], v[92:93], v[2:3] neg_lo:[0,1] neg_hi:[0,1]
    v_pk_add_f32 v[94:95], v[94:95], v[2:3] neg_lo:[0,1] neg_hi:[0,1]
    v_pk_add_f32 v[96:97], v[96:97], v[2:3] neg_lo:[0,1] neg_hi:[0,1]
    v_pk_add_f32 v[98:99], v[98:99], v[2:3] neg_lo:[0,1] neg_hi:[0,1]
    v_mov_b32 v5, v4
    v_sub_f32 v128, 0, v4
    v_sub_f32 v129, 0, v4
    v_sub_f32 v130, 0, v4
    v_sub_f32 v131, 0, v4
    v_pk_add_f32 v[100:101], v[100:101], v[4:5] neg_lo:[0,1] neg_hi:[0,1]
    v_pk_add_f32 v[102:103], v[102:103], v[4:5] neg_lo:[0,1] neg_hi:[0,1]
    v_pk_add_f32 v[104:105], v[104:105], v[4:5] neg_lo:[0,1] neg_hi:[0,1]
    v_pk_add_f32 v[106:107], v[106:107], v[4:5] neg_lo:[0,1] neg_hi:[0,1]
    s_nop 0
    ds_read_b128 v[40:43], v12 offset:18560
    s_waitcnt lgkmcnt(4)
    v_mfma_f32_16x16x32_bf16 v[108:111], v[20:23], v[44:47], v[124:127]
    v_exp_f32 v2, v92
    v_exp_f32 v3, v93
    v_mfma_f32_16x16x32_bf16 v[116:119], v[20:23], v[48:51], v[128:131]
    ds_read_b128 v[20:23], v13 offset:12416
    v_mfma_f32_16x16x32_bf16 v[112:115], v[24:27], v[44:47], v[124:127]
    v_exp_f32 v4, v94
    v_exp_f32 v5, v95
    v_cvt_pk_bf16_f32 v140, v2, v3
    v_mfma_f32_16x16x32_bf16 v[120:123], v[24:27], v[48:51], v[128:131]
    ds_read_b128 v[24:27], v13 offset:18560
    ds_read_b32 v254, v10 offset:64
    s_waitcnt lgkmcnt(5)
    v_mfma_f32_16x16x32_bf16 v[108:111], v[28:31], v[52:55], v[108:111]
    v_add_f32 v132, v134, v2
    v_add_f32 v132, v132, v3
    v_exp_f32 v252, v96
    v_mfma_f32_16x16x32_bf16 v[116:119], v[28:31], v[56:59], v[116:119]
    v_exp_f32 v253, v97
    ds_read_b128 v[28:31], v12 offset:12544
    v_mfma_f32_16x16x32_bf16 v[112:115], v[32:35], v[52:55], v[112:115]
    v_cvt_pk_bf16_f32 v141, v4, v5
    v_add_f32 v132, v132, v4
    v_add_f32 v132, v132, v5
    v_mfma_f32_16x16x32_bf16 v[120:123], v[32:35], v[56:59], v[120:123]
    ds_read_b128 v[32:35], v12 offset:18688
    s_waitcnt lgkmcnt(5)
    v_mfma_f32_16x16x32_bf16 v[108:111], v[36:39], v[60:63], v[108:111]
    v_exp_f32 v2, v98
    v_exp_f32 v3, v99
    v_cvt_pk_bf16_f32 v142, v252, v253
    v_mfma_f32_16x16x32_bf16 v[116:119], v[36:39], v[64:67], v[116:119]
    ds_read_b128 v[36:39], v13 offset:12544
    v_mfma_f32_16x16x32_bf16 v[112:115], v[40:43], v[60:63], v[112:115]
    v_add_f32 v132, v132, v252
    v_add_f32 v132, v132, v253
    v_exp_f32 v4, v100
    v_mfma_f32_16x16x32_bf16 v[120:123], v[40:43], v[64:67], v[120:123]
    v_exp_f32 v5, v101
    ds_read_b128 v[40:43], v13 offset:18688
    s_waitcnt lgkmcnt(4)
    v_mfma_f32_16x16x32_bf16 v[108:111], v[20:23], v[68:71], v[108:111]
    v_cvt_pk_bf16_f32 v143, v2, v3
    v_add_f32 v132, v132, v2
    v_add_f32 v132, v132, v3
    v_mfma_f32_16x16x32_bf16 v[116:119], v[20:23], v[72:75], v[116:119]
    v_cmp_ge_i32 vcc, v255, v254
    v_add_u32 v255, 1, v255
    ds_write_b32 v10, v255
    s_cbranch_vccnz K1_sp34
K1_sp34b:
    ds_read_b128 v[20:23], v12 offset:24576
    v_mfma_f32_16x16x32_bf16 v[112:115], v[24:27], v[68:71], v[112:115]
    v_exp_f32 v252, v102
    v_exp_f32 v253, v103
    v_cvt_pk_bf16_f32 v144, v4, v5
    v_mfma_f32_16x16x32_bf16 v[120:123], v[24:27], v[72:75], v[120:123]
    ds_read_b128 v[24:27], v12 offset:30720
    s_waitcnt lgkmcnt(5)
    v_mfma_f32_16x16x32_bf16 v[108:111], v[28:31], v[76:79], v[108:111]
    v_add_f32 v133, v135, v4
    v_add_f32 v133, v133, v5
    v_exp_f32 v2, v104
    v_mfma_f32_16x16x32_bf16 v[116:119], v[28:31], v[80:83], v[116:119]
    v_exp_f32 v3, v105
    ds_read_b128 v[28:31], v13 offset:24576
    v_mfma_f32_16x16x32_bf16 v[112:115], v[32:35], v[76:79], v[112:115]
    v_cvt_pk_bf16_f32 v145, v252, v253
    v_add_f32 v133, v133, v252
    v_add_f32 v133, v133, v253
    v_mfma_f32_16x16x32_bf16 v[120:123], v[32:35], v[80:83], v[120:123]
    ds_read_b128 v[32:35], v13 offset:30720
    s_waitcnt lgkmcnt(5)
    v_mfma_f32_16x16x32_bf16 v[108:111], v[36:39], v[84:87], v[108:111]
    v_exp_f32 v4, v106
    v_exp_f32 v5, v107
    v_cvt_pk_bf16_f32 v146, v2, v3
    v_mfma_f32_16x16x32_bf16 v[116:119], v[36:39], v[88:91], v[116:119]
    ds_read_b128 v[36:39], v12 offset:24704
    v_mfma_f32_16x16x32_bf16 v[112:115], v[40:43], v[84:87], v[112:115]
    v_add_f32 v133, v133, v2
    v_add_f32 v133, v133, v3
    v_cvt_pk_bf16_f32 v147, v4, v5
    v_mfma_f32_16x16x32_bf16 v[120:123], v[40:43], v[88:91], v[120:123]
    v_add_f32 v133, v133, v4
    v_add_f32 v133, v133, v5
    s_nop 3
K1_A_loop:
    ds_read_b128 v[40:43], v12 offset:30848
    s_waitcnt lgkmcnt(4)
    v_mfma_f32_16x16x32_bf16 v[92:95], v[20:23], v[44:47], v[124:127]
    v_exp_f32 v2, v108
    v_mfma_f32_16x16x32_bf16 v[100:103], v[20:23], v[48:51], v[128:131]
    ds_read_b128 v[20:23], v13 offset:24704
    v_mfma_f32_16x16x32_bf16 v[96:99], v[24:27], v[44:47], v[124:127]
    v_exp_f32 v3, v109
    v_exp_f32 v4, v110
    v_mfma_f32_16x16x32_bf16 v[104:107], v[24:27], v[48:51], v[128:131]
    s_add_u32 s73, s72, s93
    s_bitcmp0_b32 0x3f, s73
    s_cbranch_scc1 K1_np35
    s_sleep 4
K1_np35:
    ds_read_b128 v[24:27], v13 offset:30848
    ds_read_b32 v254, v10 offset:64
    s_waitcnt lgkmcnt(5)
    v_mfma_f32_16x16x32_bf16 v[92:95], v[28:31], v[52:55], v[92:95]
    v_exp_f32 v5, v111
    v_mfma_f32_16x16x32_bf16 v[100:103], v[28:31], v[56:59], v[100:103]
    ds_read_b128 v[28:31], v12 offset:24832
    v_mfma_f32_16x16x32_bf16 v[96:99], v[32:35], v[52:55], v[96:99]
    v_cvt_pk_bf16_f32 v148, v2, v3
    v_add_f32 v134, v132, v2
    v_add_f32 v134, v134, v3
    v_mfma_f32_16x16x32_bf16 v[104:107], v[32:35], v[56:59], v[104:107]
    ds_read_b128 v[32:35], v12 offset:30976
    s_waitcnt lgkmcnt(5)
    v_mfma_f32_16x16x32_bf16 v[92:95], v[36:39], v[60:63], v[92:95]
    v_exp_f32 v252, v112
    v_exp_f32 v253, v113
    v_mfma_f32_16x16x32_bf16 v[100:103], v[36:39], v[64:67], v[100:103]
    ds_read_b128 v[36:39], v13 offset:24832
    v_mfma_f32_16x16x32_bf16 v[96:99], v[40:43], v[60:63], v[96:99]
    v_cvt_pk_bf16_f32 v149, v4, v5
    v_add_f32 v134, v134, v4
    v_mfma_f32_16x16x32_bf16 v[104:107], v[40:43], v[64:67], v[104:107]
    ds_read_b128 v[40:43], v13 offset:30976
    s_waitcnt lgkmcnt(4)
    v_mfma_f32_16x16x32_bf16 v[92:95], v[20:23], v[68:71], v[92:95]
    v_add_f32 v134, v134, v5
    v_exp_f32 v2, v114
    v_cmp_ge_i32 vcc, v255, v254
    v_mfma_f32_16x16x32_bf16 v[100:103], v[20:23], v[72:75], v[100:103]
    v_add_u32 v255, 1, v255
    ds_write_b32 v10, v255
    s_cbranch_vccnz K1_sp36
K1_sp36b:
    ds_read_b64_tr_b16 v[20:21], v16 offset:0
    ds_read_b64_tr_b16 v[22:23], v16 offset:6144
    v_mfma_f32_16x16x32_bf16 v[96:99], v[24:27], v[68:71], v[96:99]
    v_exp_f32 v3, v115
    v_mfma_f32_16x16x32_bf16 v[104:107], v[24:27], v[72:75], v[104:107]
    ds_read_b64_tr_b16 v[24:25], v17 offset:0
    ds_read_b64_tr_b16 v[26:27], v17 offset:6144
    s_waitcnt lgkmcnt(7)
    v_mfma_f32_16x16x32_bf16 v[92:95], v[28:31], v[76:79], v[92:95]
    v_cvt_pk_bf16_f32 v150, v252, v253
    v_add_f32 v134, v134, v252
    v_mfma_f32_16x16x32_bf16 v[100:103], v[28:31], v[80:83], v[100:103]
    ds_read_b64_tr_b16 v[28:29], v18 offset:0
    ds_read_b64_tr_b16 v[30:31], v18 offset:6144
    v_mfma_f32_16x16x32_bf16 v[96:99], v[32:35], v[76:79], v[96:99]
    v_add_f32 v134, v134, v253
    v_exp_f32 v4, v116
    v_mfma_f32_16x16x32_bf16 v[104:107], v[32:35], v[80:83], v[104:107]
    ds_read_b64_tr_b16 v[32:33], v19 offset:0
    ds_read_b64_tr_b16 v[34:35], v19 offset:6144
    s_waitcnt lgkmcnt(9)
    v_mfma_f32_16x16x32_bf16 v[92:95], v[36:39], v[84:87], v[92:95]
    v_exp_f32 v5, v117
    v_mfma_f32_16x16x32_bf16 v[100:103], v[36:39], v[88:91], v[100:103]
    ds_read_b64_tr_b16 v[36:37], v16 offset:128
    ds_read_b64_tr_b16 v[38:39], v16 offset:6272
    v_mfma_f32_16x16x32_bf16 v[96:99], v[40:43], v[84:87], v[96:99]
    v_cvt_pk_bf16_f32 v151, v2, v3
    v_add_f32 v134, v134, v2
    v_mfma_f32_16x16x32_bf16 v[104:107], v[40:43], v[88:91], v[104:107]
    ds_read_b64_tr_b16 v[40:41], v17 offset:128
    ds_read_b64_tr_b16 v[42:43], v17 offset:6272
    s_waitcnt lgkmcnt(8)
    v_mfma_f32_16x16x32_bf16 v[156:159], v[20:23], v[140:143], v[156:159]
    v_add_f32 v134, v134, v3
    v_exp_f32 v252, v118
    v_mfma_f32_16x16x32_bf16 v[160:163], v[20:23], v[144:147], v[160:163]
    ds_read_b64_tr_b16 v[20:21], v18 offset:128
    ds_read_b64_tr_b16 v[22:23], v18 offset:6272
    v_mfma_f32_16x16x32_bf16 v[164:167], v[24:27], v[140:143], v[164:167]
    v_exp_f32 v253, v119
    v_mfma_f32_16x16x32_bf16 v[168:171], v[24:27], v[144:147], v[168:171]
    ds_read_b64_tr_b16 v[24:25], v19 offset:128
    ds_read_b64_tr_b16 v[26:27], v19 offset:6272
    ds_read_b32 v254, v10 offset:64
    s_waitcnt lgkmcnt(9)
    v_mfma_f32_16x16x32_bf16 v[172:175], v[28:31], v[140:143], v[172:175]
    v_cvt_pk_bf16_f32 v152, v4, v5
    v_add_f32 v135, v133, v4
    v_mfma_f32_16x16x32_bf16 v[176:179], v[28:31], v[144:147], v[176:179]
    ds_read_b64_tr_b16 v[28:29], v16 offset:256
    ds_read_b64_tr_b16 v[30:31], v16 offset:6400
    v_mfma_f32_16x16x32_bf16 v[180:183], v[32:35], v[140:143], v[180:183]
    v_add_f32 v135, v135, v5
    v_mfma_f32_16x16x32_bf16 v[184:187], v[32:35], v[144:147], v[184:187]
    ds_read_b64_tr_b16 v[32:33], v17 offset:256
    ds_read_b64_tr_b16 v[34:35], v17 offset:6400
    s_waitcnt lgkmcnt(9)
    v_mfma_f32_16x16x32_bf16 v[188:191], v[36:39], v[140:143], v[188:191]
    v_exp_f32 v2, v120
    v_exp_f32 v3, v121
    v_mfma_f32_16x16x32_bf16 v[192:195], v[36:39], v[144:147], v[192:195]
    ds_read_b64_tr_b16 v[36:37], v18 offset:256
    ds_read_b64_tr_b16 v[38:39], v18 offset:6400
    v_mfma_f32_16x16x32_bf16 v[196:199], v[40:43], v[140:143], v[196:199]
    v_cvt_pk_bf16_f32 v153, v252, v253
    v_mfma_f32_16x16x32_bf16 v[200:203], v[40:43], v[144:147], v[200:203]
    ds_read_b64_tr_b16 v[40:41], v19 offset:256
    ds_read_b64_tr_b16 v[42:43], v19 offset:6400
    s_waitcnt lgkmcnt(8)
    v_mfma_f32_16x16x32_bf16 v[204:207], v[20:23], v[140:143], v[204:207]
    v_add_f32 v135, v135, v252
    v_add_f32 v135, v135, v253
    v_cmp_ge_i32 vcc, v255, v254
    v_mfma_f32_16x16x32_bf16 v[208:211], v[20:23], v[144:147], v[208:211]
    v_add_u32 v255, 1, v255
    ds_write_b32 v10, v255
    s_cbranch_vccnz K1_sp37
K1_sp37b:
    ds_read_b128 v[20:23], v12 offset:36864
    v_mfma_f32_16x16x32_bf16 v[212:215], v[24:27], v[140:143], v[212:215]
    v_exp_f32 v4, v122
    v_exp_f32 v5, v123
    v_mfma_f32_16x16x32_bf16 v[216:219], v[24:27], v[144:147], v[216:219]
    ds_read_b128 v[24:27], v12 offset:43008
    s_waitcnt lgkmcnt(7)
    v_mfma_f32_16x16x32_bf16 v[220:223], v[28:31], v[140:143], v[220:223]
    v_cvt_pk_bf16_f32 v154, v2, v3
    v_add_f32 v135, v135, v2
    v_mfma_f32_16x16x32_bf16 v[224:227], v[28:31], v[144:147], v[224:227]
    ds_read_b128 v[28:31], v13 offset:36864
    v_mfma_f32_16x16x32_bf16 v[228:231], v[32:35], v[140:143], v[228:231]
    v_add_f32 v135, v135, v3
    v_cvt_pk_bf16_f32 v155, v4, v5
    v_add_f32 v135, v135, v4
    v_mfma_f32_16x16x32_bf16 v[232:235], v[32:35], v[144:147], v[232:235]
    ds_read_b128 v[32:35], v13 offset:43008
    s_waitcnt lgkmcnt(5)
    v_mfma_f32_16x16x32_bf16 v[236:239], v[36:39], v[140:143], v[236:239]
    v_add_f32 v135, v135, v5
    v_max_f32 v8, v134, v135
    v_cmp_lt_f32 vcc, 0x4b800000, v8
    v_mfma_f32_16x16x32_bf16 v[240:243], v[36:39], v[144:147], v[240:243]
    ds_read_b128 v[36:39], v12 offset:36992
    v_mfma_f32_16x16x32_bf16 v[244:247], v[40:43], v[140:143], v[244:247]
    v_mfma_f32_16x16x32_bf16 v[248:251], v[40:43], v[144:147], v[248:251]
    s_cbranch_vccnz K1_sl38
K1_sl38b:
    ds_read_b128 v[40:43], v12 offset:43136
    s_waitcnt lgkmcnt(4)
    v_mfma_f32_16x16x32_bf16 v[108:111], v[20:23], v[44:47], v[124:127]
    v_exp_f32 v2, v92
    v_mfma_f32_16x16x32_bf16 v[116:119], v[20:23], v[48:51], v[128:131]
    ds_read_b128 v[20:23], v13 offset:36992
    v_mfma_f32_16x16x32_bf16 v[112:115], v[24:27], v[44:47], v[124:127]
    v_exp_f32 v3, v93
    v_exp_f32 v4, v94
    v_mfma_f32_16x16x32_bf16 v[120:123], v[24:27], v[48:51], v[128:131]
    s_add_u32 s73, s72, s93
    s_bitcmp0_b32 0x3f, s73
    s_cbranch_scc1 K1_np39
    s_sleep 4
K1_np39:
    ds_read_b128 v[24:27], v13 offset:43136
    ds_read_b32 v254, v10 offset:64
    s_waitcnt lgkmcnt(5)
    v_mfma_f32_16x16x32_bf16 v[108:111], v[28:31], v[52:55], v[108:111]
    v_exp_f32 v5, v95
    v_mfma_f32_16x16x32_bf16 v[116:119], v[28:31], v[56:59], v[116:119]
    ds_read_b128 v[28:31], v12 offset:37120
    v_mfma_f32_16x16x32_bf16 v[112:115], v[32:35], v[52:55], v[112:115]
    v_cvt_pk_bf16_f32 v140, v2, v3
    v_add_f32 v132, v134, v2
    v_add_f32 v132, v132, v3
    v_mfma_f32_16x16x32_bf16 v[120:123], v[32:35], v[56:59], v[120:123]
    ds_read_b128 v[32:35], v12 offset:43264
    s_waitcnt lgkmcnt(5)
    v_mfma_f32_16x16x32_bf16 v[108:111], v[36:39], v[60:63], v[108:111]
    v_exp_f32 v252, v96
    v_exp_f32 v253, v97
    v_mfma_f32_16x16x32_bf16 v[116:119], v[36:39], v[64:67], v[116:119]
    ds_read_b128 v[36:39], v13 offset:37120
    v_mfma_f32_16x16x32_bf16 v[112:115], v[40:43], v[60:63], v[112:115]
    v_cvt_pk_bf16_f32 v141, v4, v5
    v_add_f32 v132, v132, v4
    v_mfma_f32_16x16x32_bf16 v[120:123], v[40:43], v[64:67], v[120:123]
    ds_read_b128 v[40:43], v13 offset:43264
    s_waitcnt lgkmcnt(4)
    v_mfma_f32_16x16x32_bf16 v[108:111], v[20:23], v[68:71], v[108:111]
    v_add_f32 v132, v132, v5
    v_exp_f32 v2, v98
    v_cmp_ge_i32 vcc, v255, v254
    v_mfma_f32_16x16x32_bf16 v[116:119], v[20:23], v[72:75], v[116:119]
    v_add_u32 v255, 1, v255
    ds_write_b32 v10, v255
    s_cbranch_vccnz K1_sp40
K1_sp40b:
    ds_read_b64_tr_b16 v[20:21], v16 offset:12288
    ds_read_b64_tr_b16 v[22:23], v16 offset:18432
    v_mfma_f32_16x16x32_bf16 v[112:115], v[24:27], v[68:71], v[112:115]
    v_exp_f32 v3, v99
    v_mfma_f32_16x16x32_bf16 v[120:123], v[24:27], v[72:75], v[120:123]
    ds_read_b64_tr_b16 v[24:25], v17 offset:12288
    ds_read_b64_tr_b16 v[26:27], v17 offset:18432
    s_waitcnt lgkmcnt(7)
    v_mfma_f32_16x16x32_bf16 v[108:111], v[28:31], v[76:79], v[108:111]
    v_cvt_pk_bf16_f32 v142, v252, v253
    v_add_f32 v132, v132, v252
    v_mfma_f32_16x16x32_bf16 v[116:119], v[28:31], v[80:83], v[116:119]
    ds_read_b64_tr_b16 v[28:29], v18 offset:12288
    ds_read_b64_tr_b16 v[30:31], v18 offset:18432
    v_mfma_f32_16x16x32_bf16 v[112:115], v[32:35], v[76:79], v[112:115]
    v_add_f32 v132, v132, v253
    v_exp_f32 v4, v100
    v_mfma_f32_16x16x32_bf16 v[120:123], v[32:35], v[80:83], v[120:123]
    ds_read_b64_tr_b16 v[32:33], v19 offset:12288
    ds_read_b64_tr_b16 v[34:35], v19 offset:18432
    s_waitcnt lgkmcnt(9)
    v_mfma_f32_16x16x32_bf16 v[108:111], v[36:39], v[84:87], v[108:111]
    v_exp_f32 v5, v101
    v_mfma_f32_16x16x32_bf16 v[116:119], v[36:39], v[88:91], v[116:119]
    ds_read_b64_tr_b16 v[36:37], v16 offset:12416
    ds_read_b64_tr_b16 v[38:39], v16 offset:18560
    v_mfma_f32_16x16x32_bf16 v[112:115], v[40:43], v[84:87], v[112:115]
    v_cvt_pk_bf16_f32 v143, v2, v3
    v_add_f32 v132, v132, v2
    v_mfma_f32_16x16x32_bf16 v[120:123], v[40:43], v[88:91], v[120:123]
    ds_read_b64_tr_b16 v[40:41], v17 offset:12416
    ds_read_b64_tr_b16 v[42:43], v17 offset:18560
    s_waitcnt lgkmcnt(8)
    v_mfma_f32_16x16x32_bf16 v[156:159], v[20:23], v[148:151], v[156:159]
    v_add_f32 v132, v132, v3
    v_exp_f32 v252, v102
    v_mfma_f32_16x16x32_bf16 v[160:163], v[20:23], v[152:155], v[160:163]
    ds_read_b64_tr_b16 v[20:21], v18 offset:12416
    ds_read_b64_tr_b16 v[22:23], v18 offset:18560
    v_mfma_f32_16x16x32_bf16 v[164:167], v[24:27], v[148:151], v[164:167]
    v_exp_f32 v253, v103
    v_mfma_f32_16x16x32_bf16 v[168:171], v[24:27], v[152:155], v[168:171]
    ds_read_b64_tr_b16 v[24:25], v19 offset:12416
    ds_read_b64_tr_b16 v[26:27], v19 offset:18560
    ds_read_b32 v254, v10 offset:64
    s_waitcnt lgkmcnt(9)
    v_mfma_f32_16x16x32_bf16 v[172:175], v[28:31], v[148:151], v[172:175]
    v_cvt_pk_bf16_f32 v144, v4, v5
    v_add_f32 v133, v135, v4
    v_mfma_f32_16x16x32_bf16 v[176:179], v[28:31], v[152:155], v[176:179]
    ds_read_b64_tr_b16 v[28:29], v16 offset:12544
    ds_read_b64_tr_b16 v[30:31], v16 offset:18688
    v_mfma_f32_16x16x32_bf16 v[180:183], v[32:35], v[148:151], v[180:183]
    v_add_f32 v133, v133, v5
    v_mfma_f32_16x16x32_bf16 v[184:187], v[32:35], v[152:155], v[184:187]
    ds_read_b64_tr_b16 v[32:33], v17 offset:12544
    ds_read_b64_tr_b16 v[34:35], v17 offset:18688
    s_waitcnt lgkmcnt(9)
    v_mfma_f32_16x16x32_bf16 v[188:191], v[36:39], v[148:151], v[188:191]
    v_exp_f32 v2, v104
    v_exp_f32 v3, v105
    v_mfma_f32_16x16x32_bf16 v[192:195], v[36:39], v[152:155], v[192:195]
    ds_read_b64_tr_b16 v[36:37], v18 offset:12544
    ds_read_b64_tr_b16 v[38:39], v18 offset:18688
    v_mfma_f32_16x16x32_bf16 v[196:199], v[40:43], v[148:151], v[196:199]
    v_cvt_pk_bf16_f32 v145, v252, v253
    v_mfma_f32_16x16x32_bf16 v[200:203], v[40:43], v[152:155], v[200:203]
    ds_read_b64_tr_b16 v[40:41], v19 offset:12544
    ds_read_b64_tr_b16 v[42:43], v19 offset:18688
    s_waitcnt lgkmcnt(8)
    v_mfma_f32_16x16x32_bf16 v[204:207], v[20:23], v[148:151], v[204:207]
    v_add_f32 v133, v133, v252
    v_add_f32 v133, v133, v253
    v_cmp_ge_i32 vcc, v255, v254
    v_mfma_f32_16x16x32_bf16 v[208:211], v[20:23], v[152:155], v[208:211]
    s_cmp_eq_u32 s93, 3
    s_cbranch_scc1 K1_A_end
    v_add_u32 v255, 1, v255
    ds_write_b32 v10, v255
    s_cbranch_vccnz K1_sp41
K1_sp41b:
    ds_read_b128 v[20:23], v12 offset:0
    v_mfma_f32_16x16x32_bf16 v[212:215], v[24:27], v[148:151], v[212:215]
    v_exp_f32 v4, v106
    v_exp_f32 v5, v107
    v_mfma_f32_16x16x32_bf16 v[216:219], v[24:27], v[152:155], v[216:219]
    ds_read_b128 v[24:27], v12 offset:6144
    s_waitcnt lgkmcnt(7)
    v_mfma_f32_16x16x32_bf16 v[220:223], v[28:31], v[148:151], v[220:223]
    v_cvt_pk_bf16_f32 v146, v2, v3
    v_add_f32 v133, v133, v2
    v_mfma_f32_16x16x32_bf16 v[224:227], v[28:31], v[152:155], v[224:227]
    ds_read_b128 v[28:31], v13 offset:0
    v_mfma_f32_16x16x32_bf16 v[228:231], v[32:35], v[148:151], v[228:231]
    v_add_f32 v133, v133, v3
    v_cvt_pk_bf16_f32 v147, v4, v5
    v_add_f32 v133, v133, v4
    v_mfma_f32_16x16x32_bf16 v[232:235], v[32:35], v[152:155], v[232:235]
    ds_read_b128 v[32:35], v13 offset:6144
    s_waitcnt lgkmcnt(5)
    v_mfma_f32_16x16x32_bf16 v[236:239], v[36:39], v[148:151], v[236:239]
    v_add_f32 v133, v133, v5
    v_max_f32 v8, v132, v133
    v_cmp_lt_f32 vcc, 0x4b800000, v8
    v_mfma_f32_16x16x32_bf16 v[240:243], v[36:39], v[152:155], v[240:243]
    ds_read_b128 v[36:39], v12 offset:128
    v_mfma_f32_16x16x32_bf16 v[244:247], v[40:43], v[148:151], v[244:247]
    v_mfma_f32_16x16x32_bf16 v[248:251], v[40:43], v[152:155], v[248:251]
    s_cbranch_vccnz K1_sl42
K1_sl42b:
    ds_read_b128 v[40:43], v12 offset:6272
    s_waitcnt lgkmcnt(4)
    v_mfma_f32_16x16x32_bf16 v[92:95], v[20:23], v[44:47], v[124:127]
    v_exp_f32 v2, v108
    v_mfma_f32_16x16x32_bf16 v[100:103], v[20:23], v[48:51], v[128:131]
    ds_read_b128 v[20:23], v13 offset:128
    v_mfma_f32_16x16x32_bf16 v[96:99], v[24:27], v[44:47], v[124:127]
    v_exp_f32 v3, v109
    v_exp_f32 v4, v110
    v_mfma_f32_16x16x32_bf16 v[104:107], v[24:27], v[48:51], v[128:131]
    s_add_u32 s73, s72, s93
    s_bitcmp0_b32 0x3f, s73
    s_cbranch_scc1 K1_np43
    s_sleep 4
K1_np43:
    ds_read_b128 v[24:27], v13 offset:6272
    ds_read_b32 v254, v10 offset:64
    s_waitcnt lgkmcnt(5)
    v_mfma_f32_16x16x32_bf16 v[92:95], v[28:31], v[52:55], v[92:95]
    v_exp_f32 v5, v111
    v_mfma_f32_16x16x32_bf16 v[100:103], v[28:31], v[56:59], v[100:103]
    ds_read_b128 v[28:31], v12 offset:256
    v_mfma_f32_16x16x32_bf16 v[96:99], v[32:35], v[52:55], v[96:99]
    v_cvt_pk_bf16_f32 v148, v2, v3
    v_add_f32 v134, v132, v2
    v_add_f32 v134, v134, v3
    v_mfma_f32_16x16x32_bf16 v[104:107], v[32:35], v[56:59], v[104:107]
    ds_read_b128 v[32:35], v12 offset:6400
    s_waitcnt lgkmcnt(5)
    v_mfma_f32_16x16x32_bf16 v[92:95], v[36:39], v[60:63], v[92:95]
    v_exp_f32 v252, v112
    v_exp_f32 v253, v113
    v_mfma_f32_16x16x32_bf16 v[100:103], v[36:39], v[64:67], v[100:103]
    ds_read_b128 v[36:39], v13 offset:256
    v_mfma_f32_16x16x32_bf16 v[96:99], v[40:43], v[60:63], v[96:99]
    v_cvt_pk_bf16_f32 v149, v4, v5
    v_add_f32 v134, v134, v4
    v_mfma_f32_16x16x32_bf16 v[104:107], v[40:43], v[64:67], v[104:107]
    ds_read_b128 v[40:43], v13 offset:6400
    s_waitcnt lgkmcnt(4)
    v_mfma_f32_16x16x32_bf16 v[92:95], v[20:23], v[68:71], v[92:95]
    v_add_f32 v134, v134, v5
    v_exp_f32 v2, v114
    v_cmp_ge_i32 vcc, v255, v254
    v_mfma_f32_16x16x32_bf16 v[100:103], v[20:23], v[72:75], v[100:103]
    v_add_u32 v255, 1, v255
    ds_write_b32 v10, v255
    s_cbranch_vccnz K1_sp44
K1_sp44b:
    ds_read_b64_tr_b16 v[20:21], v16 offset:24576
    ds_read_b64_tr_b16 v[22:23], v16 offset:30720
    v_mfma_f32_16x16x32_bf16 v[96:99], v[24:27], v[68:71], v[96:99]
    v_exp_f32 v3, v115
    v_mfma_f32_16x16x32_bf16 v[104:107], v[24:27], v[72:75], v[104:107]
    ds_read_b64_tr_b16 v[24:25], v17 offset:24576
    ds_read_b64_tr_b16 v[26:27], v17 offset:30720
    s_waitcnt lgkmcnt(7)
    v_mfma_f32_16x16x32_bf16 v[92:95], v[28:31], v[76:79], v[92:95]
    v_cvt_pk_bf16_f32 v150, v252, v253
    v_add_f32 v134, v134, v252
    v_mfma_f32_16x16x32_bf16 v[100:103], v[28:31], v[80:83], v[100:103]
    ds_read_b64_tr_b16 v[28:29], v18 offset:24576
    ds_read_b64_tr_b16 v[30:31], v18 offset:30720
    v_mfma_f32_16x16x32_bf16 v[96:99], v[32:35], v[76:79], v[96:99]
    v_add_f32 v134, v134, v253
    v_exp_f32 v4, v116
    v_mfma_f32_16x16x32_bf16 v[104:107], v[32:35], v[80:83], v[104:107]
    ds_read_b64_tr_b16 v[32:33], v19 offset:24576
    ds_read_b64_tr_b16 v[34:35], v19 offset:30720
    s_waitcnt lgkmcnt(9)
    v_mfma_f32_16x16x32_bf16 v[92:95], v[36:39], v[84:87], v[92:95]
    v_exp_f32 v5, v117
    v_mfma_f32_16x16x32_bf16 v[100:103], v[36:39], v[88:91], v[100:103]
    ds_read_b64_tr_b16 v[36:37], v16 offset:24704
    ds_read_b64_tr_b16 v[38:39], v16 offset:30848
    v_mfma_f32_16x16x32_bf16 v[96:99], v[40:43], v[84:87], v[96:99]
    v_cvt_pk_bf16_f32 v151, v2, v3
    v_add_f32 v134, v134, v2
    v_mfma_f32_16x16x32_bf16 v[104:107], v[40:43], v[88:91], v[104:107]
    ds_read_b64_tr_b16 v[40:41], v17 offset:24704
    ds_read_b64_tr_b16 v[42:43], v17 offset:30848
    s_waitcnt lgkmcnt(8)
    v_mfma_f32_16x16x32_bf16 v[156:159], v[20:23], v[140:143], v[156:159]
    v_add_f32 v134, v134, v3
    v_exp_f32 v252, v118
    v_mfma_f32_16x16x32_bf16 v[160:163], v[20:23], v[144:147], v[160:163]
    ds_read_b64_tr_b16 v[20:21], v18 offset:24704
    ds_read_b64_tr_b16 v[22:23], v18 offset:30848
    v_mfma_f32_16x16x32_bf16 v[164:167], v[24:27], v[140:143], v[164:167]
    v_exp_f32 v253, v119
    v_mfma_f32_16x16x32_bf16 v[168:171], v[24:27], v[144:147], v[168:171]
    ds_read_b64_tr_b16 v[24:25], v19 offset:24704
    ds_read_b64_tr_b16 v[26:27], v19 offset:30848
    ds_read_b32 v254, v10 offset:64
    s_waitcnt lgkmcnt(9)
    v_mfma_f32_16x16x32_bf16 v[172:175], v[28:31], v[140:143], v[172:175]
    v_cvt_pk_bf16_f32 v152, v4, v5
    v_add_f32 v135, v133, v4
    v_mfma_f32_16x16x32_bf16 v[176:179], v[28:31], v[144:147], v[176:179]
    ds_read_b64_tr_b16 v[28:29], v16 offset:24832
    ds_read_b64_tr_b16 v[30:31], v16 offset:30976
    v_mfma_f32_16x16x32_bf16 v[180:183], v[32:35], v[140:143], v[180:183]
    v_add_f32 v135, v135, v5
    v_mfma_f32_16x16x32_bf16 v[184:187], v[32:35], v[144:147], v[184:187]
    ds_read_b64_tr_b16 v[32:33], v17 offset:24832
    ds_read_b64_tr_b16 v[34:35], v17 offset:30976
    s_waitcnt lgkmcnt(9)
    v_mfma_f32_16x16x32_bf16 v[188:191], v[36:39], v[140:143], v[188:191]
    v_exp_f32 v2, v120
    v_exp_f32 v3, v121
    v_mfma_f32_16x16x32_bf16 v[192:195], v[36:39], v[144:147], v[192:195]
    ds_read_b64_tr_b16 v[36:37], v18 offset:24832
    ds_read_b64_tr_b16 v[38:39], v18 offset:30976
    v_mfma_f32_16x16x32_bf16 v[196:199], v[40:43], v[140:143], v[196:199]
    v_cvt_pk_bf16_f32 v153, v252, v253
    v_mfma_f32_16x16x32_bf16 v[200:203], v[40:43], v[144:147], v[200:203]
    ds_read_b64_tr_b16 v[40:41], v19 offset:24832
    ds_read_b64_tr_b16 v[42:43], v19 offset:30976
    s_waitcnt lgkmcnt(8)
    v_mfma_f32_16x16x32_bf16 v[204:207], v[20:23], v[140:143], v[204:207]
    v_add_f32 v135, v135, v252
    v_add_f32 v135, v135, v253
    v_cmp_ge_i32 vcc, v255, v254
    v_mfma_f32_16x16x32_bf16 v[208:211], v[20:23], v[144:147], v[208:211]
    v_add_u32 v255, 1, v255
    ds_write_b32 v10, v255
    s_cbranch_vccnz K1_sp45
K1_sp45b:
    ds_read_b128 v[20:23], v12 offset:12288
    v_mfma_f32_16x16x32_bf16 v[212:215], v[24:27], v[140:143], v[212:215]
    v_exp_f32 v4, v122
    v_exp_f32 v5, v123
    v_mfma_f32_16x16x32_bf16 v[216:219], v[24:27], v[144:147], v[216:219]
    ds_read_b128 v[24:27], v12 offset:18432
    s_waitcnt lgkmcnt(7)
    v_mfma_f32_16x16x32_bf16 v[220:223], v[28:31], v[140:143], v[220:223]
    v_cvt_pk_bf16_f32 v154, v2, v3
    v_add_f32 v135, v135, v2
    v_mfma_f32_16x16x32_bf16 v[224:227], v[28:31], v[144:147], v[224:227]
    ds_read_b128 v[28:31], v13 offset:12288
    v_mfma_f32_16x16x32_bf16 v[228:231], v[32:35], v[140:143], v[228:231]
    v_add_f32 v135, v135, v3
    v_cvt_pk_bf16_f32 v155, v4, v5
    v_add_f32 v135, v135, v4
    v_mfma_f32_16x16x32_bf16 v[232:235], v[32:35], v[144:147], v[232:235]
    ds_read_b128 v[32:35], v13 offset:18432
    s_waitcnt lgkmcnt(5)
    v_mfma_f32_16x16x32_bf16 v[236:239], v[36:39], v[140:143], v[236:239]
    v_add_f32 v135, v135, v5
    v_max_f32 v8, v134, v135
    v_cmp_lt_f32 vcc, 0x4b800000, v8
    v_mfma_f32_16x16x32_bf16 v[240:243], v[36:39], v[144:147], v[240:243]
    ds_read_b128 v[36:39], v12 offset:12416
    v_mfma_f32_16x16x32_bf16 v[244:247], v[40:43], v[140:143], v[244:247]
    v_mfma_f32_16x16x32_bf16 v[248:251], v[40:43], v[144:147], v[248:251]
    s_cbranch_vccnz K1_sl46
K1_sl46b:
    ds_read_b128 v[40:43], v12 offset:18560
    s_waitcnt lgkmcnt(4)
    v_mfma_f32_16x16x32_bf16 v[108:111], v[20:23], v[44:47], v[124:127]
    v_exp_f32 v2, v92
    v_mfma_f32_16x16x32_bf16 v[116:119], v[20:23], v[48:51], v[128:131]
    ds_read_b128 v[20:23], v13 offset:12416
    v_mfma_f32_16x16x32_bf16 v[112:115], v[24:27], v[44:47], v[124:127]
    v_exp_f32 v3, v93
    v_exp_f32 v4, v94
    v_mfma_f32_16x16x32_bf16 v[120:123], v[24:27], v[48:51], v[128:131]
    s_add_u32 s73, s72, s93
    s_bitcmp0_b32 0x3f, s73
    s_cbranch_scc1 K1_np47
    s_sleep 4
K1_np47:
    ds_read_b128 v[24:27], v13 offset:18560
    ds_read_b32 v254, v10 offset:64
    s_waitcnt lgkmcnt(5)
    v_mfma_f32_16x16x32_bf16 v[108:111], v[28:31], v[52:55], v[108:111]
    v_exp_f32 v5, v95
    v_mfma_f32_16x16x32_bf16 v[116:119], v[28:31], v[56:59], v[116:119]
    ds_read_b128 v[28:31], v12 offset:12544
    v_mfma_f32_16x16x32_bf16 v[112:115], v[32:35], v[52:55], v[112:115]
    v_cvt_pk_bf16_f32 v140, v2, v3
    v_add_f32 v132, v134, v2
    v_add_f32 v132, v132, v3
    v_mfma_f32_16x16x32_bf16 v[120:123], v[32:35], v[56:59], v[120:123]
    ds_read_b128 v[32:35], v12 offset:18688
    s_waitcnt lgkmcnt(5)
    v_mfma_f32_16x16x32_bf16 v[108:111], v[36:39], v[60:63], v[108:111]
    v_exp_f32 v252, v96
    v_exp_f32 v253, v97
    v_mfma_f32_16x16x32_bf16 v[116:119], v[36:39], v[64:67], v[116:119]
    ds_read_b128 v[36:39], v13 offset:12544
    v_mfma_f32_16x16x32_bf16 v[112:115], v[40:43], v[60:63], v[112:115]
    v_cvt_pk_bf16_f32 v141, v4, v5
    v_add_f32 v132, v132, v4
    v_mfma_f32_16x16x32_bf16 v[120:123], v[40:43], v[64:67], v[120:123]
    ds_read_b128 v[40:43], v13 offset:18688
    s_waitcnt lgkmcnt(4)
    v_mfma_f32_16x16x32_bf16 v[108:111], v[20:23], v[68:71], v[108:111]
    v_add_f32 v132, v132, v5
    v_exp_f32 v2, v98
    v_cmp_ge_i32 vcc, v255, v254
    v_mfma_f32_16x16x32_bf16 v[116:119], v[20:23], v[72:75], v[116:119]
    v_add_u32 v255, 1, v255
    ds_write_b32 v10, v255
    s_cbranch_vccnz K1_sp48
K1_sp48b:
    ds_read_b64_tr_b16 v[20:21], v16 offset:36864
    ds_read_b64_tr_b16 v[22:23], v16 offset:43008
    v_mfma_f32_16x16x32_bf16 v[112:115], v[24:27], v[68:71], v[112:115]
    v_exp_f32 v3, v99
    v_mfma_f32_16x16x32_bf16 v[120:123], v[24:27], v[72:75], v[120:123]
    ds_read_b64_tr_b16 v[24:25], v17 offset:36864
    ds_read_b64_tr_b16 v[26:27], v17 offset:43008
    s_waitcnt lgkmcnt(7)
    v_mfma_f32_16x16x32_bf16 v[108:111], v[28:31], v[76:79], v[108:111]
    v_cvt_pk_bf16_f32 v142, v252, v253
    v_add_f32 v132, v132, v252
    v_mfma_f32_16x16x32_bf16 v[116:119], v[28:31], v[80:83], v[116:119]
    ds_read_b64_tr_b16 v[28:29], v18 offset:36864
    ds_read_b64_tr_b16 v[30:31], v18 offset:43008
    v_mfma_f32_16x16x32_bf16 v[112:115], v[32:35], v[76:79], v[112:115]
    v_add_f32 v132, v132, v253
    v_exp_f32 v4, v100
    v_mfma_f32_16x16x32_bf16 v[120:123], v[32:35], v[80:83], v[120:123]
    ds_read_b64_tr_b16 v[32:33], v19 offset:36864
    ds_read_b64_tr_b16 v[34:35], v19 offset:43008
    s_waitcnt lgkmcnt(9)
    v_mfma_f32_16x16x32_bf16 v[108:111], v[36:39], v[84:87], v[108:111]
    v_exp_f32 v5, v101
    v_mfma_f32_16x16x32_bf16 v[116:119], v[36:39], v[88:91], v[116:119]
    ds_read_b64_tr_b16 v[36:37], v16 offset:36992
    ds_read_b64_tr_b16 v[38:39], v16 offset:43136
    v_mfma_f32_16x16x32_bf16 v[112:115], v[40:43], v[84:87], v[112:115]
    v_cvt_pk_bf16_f32 v143, v2, v3
    v_add_f32 v132, v132, v2
    v_mfma_f32_16x16x32_bf16 v[120:123], v[40:43], v[88:91], v[120:123]
    ds_read_b64_tr_b16 v[40:41], v17 offset:36992
    ds_read_b64_tr_b16 v[42:43], v17 offset:43136
    s_waitcnt lgkmcnt(8)
    v_mfma_f32_16x16x32_bf16 v[156:159], v[20:23], v[148:151], v[156:159]
    v_add_f32 v132, v132, v3
    v_exp_f32 v252, v102
    v_mfma_f32_16x16x32_bf16 v[160:163], v[20:23], v[152:155], v[160:163]
    ds_read_b64_tr_b16 v[20:21], v18 offset:36992
    ds_read_b64_tr_b16 v[22:23], v18 offset:43136
    v_mfma_f32_16x16x32_bf16 v[164:167], v[24:27], v[148:151], v[164:167]
    v_exp_f32 v253, v103
    v_mfma_f32_16x16x32_bf16 v[168:171], v[24:27], v[152:155], v[168:171]
    ds_read_b64_tr_b16 v[24:25], v19 offset:36992
    ds_read_b64_tr_b16 v[26:27], v19 offset:43136
    ds_read_b32 v254, v10 offset:64
    s_waitcnt lgkmcnt(9)
    v_mfma_f32_16x16x32_bf16 v[172:175], v[28:31], v[148:151], v[172:175]
    v_cvt_pk_bf16_f32 v144, v4, v5
    v_add_f32 v133, v135, v4
    v_mfma_f32_16x16x32_bf16 v[176:179], v[28:31], v[152:155], v[176:179]
    ds_read_b64_tr_b16 v[28:29], v16 offset:37120
    ds_read_b64_tr_b16 v[30:31], v16 offset:43264
    v_mfma_f32_16x16x32_bf16 v[180:183], v[32:35], v[148:151], v[180:183]
    v_add_f32 v133, v133, v5
    v_mfma_f32_16x16x32_bf16 v[184:187], v[32:35], v[152:155], v[184:187]
    ds_read_b64_tr_b16 v[32:33], v17 offset:37120
    ds_read_b64_tr_b16 v[34:35], v17 offset:43264
    s_waitcnt lgkmcnt(9)
    v_mfma_f32_16x16x32_bf16 v[188:191], v[36:39], v[148:151], v[188:191]
    v_exp_f32 v2, v104
    v_exp_f32 v3, v105
    v_mfma_f32_16x16x32_bf16 v[192:195], v[36:39], v[152:155], v[192:195]
    ds_read_b64_tr_b16 v[36:37], v18 offset:37120
    ds_read_b64_tr_b16 v[38:39], v18 offset:43264
    v_mfma_f32_16x16x32_bf16 v[196:199], v[40:43], v[148:151], v[196:199]
    v_cvt_pk_bf16_f32 v145, v252, v253
    v_mfma_f32_16x16x32_bf16 v[200:203], v[40:43], v[152:155], v[200:203]
    ds_read_b64_tr_b16 v[40:41], v19 offset:37120
    ds_read_b64_tr_b16 v[42:43], v19 offset:43264
    s_waitcnt lgkmcnt(8)
    v_mfma_f32_16x16x32_bf16 v[204:207], v[20:23], v[148:151], v[204:207]
    v_add_f32 v133, v133, v252
    v_add_f32 v133, v133, v253
    v_cmp_ge_i32 vcc, v255, v254
    v_mfma_f32_16x16x32_bf16 v[208:211], v[20:23], v[152:155], v[208:211]
    v_add_u32 v255, 1, v255
    ds_write_b32 v10, v255
    s_cbranch_vccnz K1_sp49
K1_sp49b:
    ds_read_b128 v[20:23], v12 offset:24576
    v_mfma_f32_16x16x32_bf16 v[212:215], v[24:27], v[148:151], v[212:215]
    v_exp_f32 v4, v106
    v_exp_f32 v5, v107
    v_mfma_f32_16x16x32_bf16 v[216:219], v[24:27], v[152:155], v[216:219]
    ds_read_b128 v[24:27], v12 offset:30720
    s_waitcnt lgkmcnt(7)
    v_mfma_f32_16x16x32_bf16 v[220:223], v[28:31], v[148:151], v[220:223]
    v_cvt_pk_bf16_f32 v146, v2, v3
    v_add_f32 v133, v133, v2
    v_mfma_f32_16x16x32_bf16 v[224:227], v[28:31], v[152:155], v[224:227]
    ds_read_b128 v[28:31], v13 offset:24576
    v_mfma_f32_16x16x32_bf16 v[228:231], v[32:35], v[148:151], v[228:231]
    v_add_f32 v133, v133, v3
    v_cvt_pk_bf16_f32 v147, v4, v5
    v_add_f32 v133, v133, v4
    v_mfma_f32_16x16x32_bf16 v[232:235], v[32:35], v[152:155], v[232:235]
    ds_read_b128 v[32:35], v13 offset:30720
    s_waitcnt lgkmcnt(5)
    v_mfma_f32_16x16x32_bf16 v[236:239], v[36:39], v[148:151], v[236:239]
    v_add_f32 v133, v133, v5
    v_max_f32 v8, v132, v133
    v_cmp_lt_f32 vcc, 0x4b800000, v8
    v_mfma_f32_16x16x32_bf16 v[240:243], v[36:39], v[152:155], v[240:243]
    ds_read_b128 v[36:39], v12 offset:24704
    v_mfma_f32_16x16x32_bf16 v[244:247], v[40:43], v[148:151], v[244:247]
    v_mfma_f32_16x16x32_bf16 v[248:251], v[40:43], v[152:155], v[248:251]
    s_cbranch_vccnz K1_sl50
K1_sl50b:
    s_add_u32 s93, s93, 1
    s_branch K1_A_loop
K1_A_end:
    v_add_u32 v255, 1, v255
    ds_write_b32 v10, v255
    s_cbranch_vccnz K1_sp51
K1_sp51b:
    ds_read_b64_tr_b16 v[20:21], v16 offset:24576
    ds_read_b64_tr_b16 v[22:23], v16 offset:30720
    v_mfma_f32_16x16x32_bf16 v[212:215], v[24:27], v[148:151], v[212:215]
    v_exp_f32 v4, v106
    v_exp_f32 v5, v107
    v_mfma_f32_16x16x32_bf16 v[216:219], v[24:27], v[152:155], v[216:219]
    ds_read_b64_tr_b16 v[24:25], v17 offset:24576
    ds_read_b64_tr_b16 v[26:27], v17 offset:30720
    s_waitcnt lgkmcnt(9)
    v_mfma_f32_16x16x32_bf16 v[220:223], v[28:31], v[148:151], v[220:223]
    v_cvt_pk_bf16_f32 v146, v2, v3
    v_add_f32 v133, v133, v2
    v_mfma_f32_16x16x32_bf16 v[224:227], v[28:31], v[152:155], v[224:227]
    ds_read_b64_tr_b16 v[28:29], v18 offset:24576
    ds_read_b64_tr_b16 v[30:31], v18 offset:30720
    v_mfma_f32_16x16x32_bf16 v[228:231], v[32:35], v[148:151], v[228:231]
    v_add_f32 v133, v133, v3
    v_cvt_pk_bf16_f32 v147, v4, v5
    v_add_f32 v133, v133, v4
    v_mfma_f32_16x16x32_bf16 v[232:235], v[32:35], v[152:155], v[232:235]
    ds_read_b64_tr_b16 v[32:33], v19 offset:24576
    ds_read_b64_tr_b16 v[34:35], v19 offset:30720
    s_waitcnt lgkmcnt(9)
    v_mfma_f32_16x16x32_bf16 v[236:239], v[36:39], v[148:151], v[236:239]
    v_add_f32 v133, v133, v5
    v_max_f32 v8, v132, v133
    v_cmp_lt_f32 vcc, 0x4b800000, v8
    v_mfma_f32_16x16x32_bf16 v[240:243], v[36:39], v[152:155], v[240:243]
    ds_read_b64_tr_b16 v[36:37], v16 offset:24704
    ds_read_b64_tr_b16 v[38:39], v16 offset:30848
    v_mfma_f32_16x16x32_bf16 v[244:247], v[40:43], v[148:151], v[244:247]
    v_mfma_f32_16x16x32_bf16 v[248:251], v[40:43], v[152:155], v[248:251]
    s_cbranch_vccnz K1_sl52
K1_sl52b:
    ds_read_b64_tr_b16 v[40:41], v17 offset:24704
    ds_read_b64_tr_b16 v[42:43], v17 offset:30848
    s_waitcnt lgkmcnt(8)
    v_mfma_f32_16x16x32_bf16 v[156:159], v[20:23], v[140:143], v[156:159]
    v_exp_f32 v2, v108
    v_exp_f32 v3, v109
    v_exp_f32 v4, v110
    v_mfma_f32_16x16x32_bf16 v[160:163], v[20:23], v[144:147], v[160:163]
    ds_read_b64_tr_b16 v[20:21], v18 offset:24704
    ds_read_b64_tr_b16 v[22:23], v18 offset:30848
    v_mfma_f32_16x16x32_bf16 v[164:167], v[24:27], v[140:143], v[164:167]
    v_exp_f32 v5, v111
    v_cvt_pk_bf16_f32 v148, v2, v3
    v_add_f32 v134, v132, v2
    v_mfma_f32_16x16x32_bf16 v[168:171], v[24:27], v[144:147], v[168:171]
    v_add_f32 v134, v134, v3
    ds_read_b64_tr_b16 v[24:25], v19 offset:24704
    ds_read_b64_tr_b16 v[26:27], v19 offset:30848
    ds_read_b32 v254, v10 offset:64
    s_waitcnt lgkmcnt(9)
    v_mfma_f32_16x16x32_bf16 v[172:175], v[28:31], v[140:143], v[172:175]
    v_exp_f32 v252, v112
    v_exp_f32 v253, v113
    v_cvt_pk_bf16_f32 v149, v4, v5
    v_mfma_f32_16x16x32_bf16 v[176:179], v[28:31], v[144:147], v[176:179]
    ds_read_b64_tr_b16 v[28:29], v16 offset:24832
    ds_read_b64_tr_b16 v[30:31], v16 offset:30976
    v_mfma_f32_16x16x32_bf16 v[180:183], v[32:35], v[140:143], v[180:183]
    v_add_f32 v134, v134, v4
    v_add_f32 v134, v134, v5
    v_exp_f32 v2, v114
    v_mfma_f32_16x16x32_bf16 v[184:187], v[32:35], v[144:147], v[184:187]
    v_exp_f32 v3, v115
    ds_read_b64_tr_b16 v[32:33], v17 offset:24832
    ds_read_b64_tr_b16 v[34:35], v17 offset:30976
    s_waitcnt lgkmcnt(9)
    v_mfma_f32_16x16x32_bf16 v[188:191], v[36:39], v[140:143], v[188:191]
    v_cvt_pk_bf16_f32 v150, v252, v253
    v_add_f32 v134, v134, v252
    v_add_f32 v134, v134, v253
    v_mfma_f32_16x16x32_bf16 v[192:195], v[36:39], v[144:147], v[192:195]
    v_exp_f32 v4, v116
    ds_read_b64_tr_b16 v[36:37], v18 offset:24832
    ds_read_b64_tr_b16 v[38:39], v18 offset:30976
    v_mfma_f32_16x16x32_bf16 v[196:199], v[40:43], v[140:143], v[196:199]
    v_exp_f32 v5, v117
    v_cvt_pk_bf16_f32 v151, v2, v3
    v_add_f32 v134, v134, v2
    v_mfma_f32_16x16x32_bf16 v[200:203], v[40:43], v[144:147], v[200:203]
    v_add_f32 v134, v134, v3
    ds_read_b64_tr_b16 v[40:41], v19 offset:24832
    ds_read_b64_tr_b16 v[42:43], v19 offset:30976
    s_waitcnt lgkmcnt(8)
    v_mfma_f32_16x16x32_bf16 v[204:207], v[20:23], v[140:143], v[204:207]
    v_exp_f32 v252, v118
    v_exp_f32 v253, v119
    v_cvt_pk_bf16_f32 v152, v4, v5
    v_mfma_f32_16x16x32_bf16 v[208:211], v[20:23], v[144:147], v[208:211]
    v_cmp_ge_i32 vcc, v255, v254
    v_add_u32 v255, 1, v255
    ds_write_b32 v10, v255
    s_cbranch_vccnz K1_sp53
K1_sp53b:
    ds_read_b64_tr_b16 v[20:21], v16 offset:36864
    ds_read_b64_tr_b16 v[22:23], v16 offset:43008
    v_mfma_f32_16x16x32_bf16 v[212:215], v[24:27], v[140:143], v[212:215]
    v_add_f32 v135, v133, v4
    v_add_f32 v135, v135, v5
    v_exp_f32 v2, v120
    v_mfma_f32_16x16x32_bf16 v[216:219], v[24:27], v[144:147], v[216:219]
    v_exp_f32 v3, v121
    ds_read_b64_tr_b16 v[24:25], v17 offset:36864
    ds_read_b64_tr_b16 v[26:27], v17 offset:43008
    s_waitcnt lgkmcnt(9)
    v_mfma_f32_16x16x32_bf16 v[220:223], v[28:31], v[140:143], v[220:223]
    v_cvt_pk_bf16_f32 v153, v252, v253
    v_add_f32 v135, v135, v252
    v_add_f32 v135, v135, v253
    v_mfma_f32_16x16x32_bf16 v[224:227], v[28:31], v[144:147], v[224:227]
    v_exp_f32 v4, v122
    ds_read_b64_tr_b16 v[28:29], v18 offset:36864
    ds_read_b64_tr_b16 v[30:31], v18 offset:43008
    v_mfma_f32_16x16x32_bf16 v[228:231], v[32:35], v[140:143], v[228:231]
    v_exp_f32 v5, v123
    v_cvt_pk_bf16_f32 v154, v2, v3
    v_add_f32 v135, v135, v2
    v_mfma_f32_16x16x32_bf16 v[232:235], v[32:35], v[144:147], v[232:235]
    v_add_f32 v135, v135, v3
    ds_read_b64_tr_b16 v[32:33], v19 offset:36864
    ds_read_b64_tr_b16 v[34:35], v19 offset:43008
    s_waitcnt lgkmcnt(9)
    v_mfma_f32_16x16x32_bf16 v[236:239], v[36:39], v[140:143], v[236:239]
    v_cvt_pk_bf16_f32 v155, v4, v5
    v_add_f32 v135, v135, v4
    v_add_f32 v135, v135, v5
    v_mfma_f32_16x16x32_bf16 v[240:243], v[36:39], v[144:147], v[240:243]
    v_max_f32 v8, v134, v135
    v_cmp_lt_f32 vcc, 0x4b800000, v8
    ds_read_b64_tr_b16 v[36:37], v16 offset:36992
    ds_read_b64_tr_b16 v[38:39], v16 offset:43136
    v_mfma_f32_16x16x32_bf16 v[244:247], v[40:43], v[140:143], v[244:247]
    v_mfma_f32_16x16x32_bf16 v[248:251], v[40:43], v[144:147], v[248:251]
    s_cbranch_vccnz K1_sl54
K1_sl54b:
    ds_read_b64_tr_b16 v[40:41], v17 offset:36992
    ds_read_b64_tr_b16 v[42:43], v17 offset:43136
    s_waitcnt lgkmcnt(8)
    v_mfma_f32_16x16x32_bf16 v[156:159], v[20:23], v[148:151], v[156:159]
    v_mfma_f32_16x16x32_bf16 v[160:163], v[20:23], v[152:155], v[160:163]
    ds_read_b64_tr_b16 v[20:21], v18 offset:36992
    ds_read_b64_tr_b16 v[22:23], v18 offset:43136
    v_mfma_f32_16x16x32_bf16 v[164:167], v[24:27], v[148:151], v[164:167]
    v_mfma_f32_16x16x32_bf16 v[168:171], v[24:27], v[152:155], v[168:171]
    ds_read_b64_tr_b16 v[24:25], v19 offset:36992
    ds_read_b64_tr_b16 v[26:27], v19 offset:43136
    ds_read_b32 v254, v10 offset:64
    s_waitcnt lgkmcnt(9)
    v_mfma_f32_16x16x32_bf16 v[172:175], v[28:31], v[148:151], v[172:175]
    v_mfma_f32_16x16x32_bf16 v[176:179], v[28:31], v[152:155], v[176:179]
    ds_read_b64_tr_b16 v[28:29], v16 offset:37120
    ds_read_b64_tr_b16 v[30:31], v16 offset:43264
    v_mfma_f32_16x16x32_bf16 v[180:183], v[32:35], v[148:151], v[180:183]
    v_mfma_f32_16x16x32_bf16 v[184:187], v[32:35], v[152:155], v[184:187]
    ds_read_b64_tr_b16 v[32:33], v17 offset:37120
    ds_read_b64_tr_b16 v[34:35], v17 offset:43264
    s_waitcnt lgkmcnt(9)
    v_mfma_f32_16x16x32_bf16 v[188:191], v[36:39], v[148:151], v[188:191]
    v_mfma_f32_16x16x32_bf16 v[192:195], v[36:39], v[152:155], v[192:195]
    ds_read_b64_tr_b16 v[36:37], v18 offset:37120
    ds_read_b64_tr_b16 v[38:39], v18 offset:43264
    v_mfma_f32_16x16x32_bf16 v[196:199], v[40:43], v[148:151], v[196:199]
    v_mfma_f32_16x16x32_bf16 v[200:203], v[40:43], v[152:155], v[200:203]
    ds_read_b64_tr_b16 v[40:41], v19 offset:37120
    ds_read_b64_tr_b16 v[42:43], v19 offset:43264
    s_waitcnt lgkmcnt(8)
    v_mfma_f32_16x16x32_bf16 v[204:207], v[20:23], v[148:151], v[204:207]
    v_cmp_ge_i32 vcc, v255, v254
    v_mfma_f32_16x16x32_bf16 v[208:211], v[20:23], v[152:155], v[208:211]
    v_add_u32 v255, 1, v255
    ds_write_b32 v10, v255
    s_cbranch_vccnz K1_sp55
K1_sp55b:
    ds_read_b128 v[20:23], v12 offset:0
    v_mfma_f32_16x16x32_bf16 v[212:215], v[24:27], v[148:151], v[212:215]
    v_mfma_f32_16x16x32_bf16 v[216:219], v[24:27], v[152:155], v[216:219]
    ds_read_b128 v[24:27], v12 offset:6144
    s_waitcnt lgkmcnt(7)
    v_mfma_f32_16x16x32_bf16 v[220:223], v[28:31], v[148:151], v[220:223]
    v_mfma_f32_16x16x32_bf16 v[224:227], v[28:31], v[152:155], v[224:227]
    ds_read_b128 v[28:31], v13 offset:0
    v_mfma_f32_16x16x32_bf16 v[228:231], v[32:35], v[148:151], v[228:231]
    v_mfma_f32_16x16x32_bf16 v[232:235], v[32:35], v[152:155], v[232:235]
    ds_read_b128 v[32:35], v13 offset:6144
    s_waitcnt lgkmcnt(5)
    v_mfma_f32_16x16x32_bf16 v[236:239], v[36:39], v[148:151], v[236:239]
    v_mfma_f32_16x16x32_bf16 v[240:243], v[36:39], v[152:155], v[240:243]
    ds_read_b128 v[36:39], v12 offset:128
    v_mfma_f32_16x16x32_bf16 v[244:247], v[40:43], v[148:151], v[244:247]
    v_mfma_f32_16x16x32_bf16 v[248:251], v[40:43], v[152:155], v[248:251]
K1_A_hd:
    s_add_u32 s72, s72, 4
    s_cmp_eq_u32 s72, 8
    s_cbranch_scc1 K1_A_last
    s_mul_i32 s73, s3, 12288
    s_add_u32 s73, s73, 98304
    v_lshlrev_b32 v6, 4, v0
    v_add_u32 v6, s73, v6
    v_mov_b32 v7, 159748
    s_waitcnt lgkmcnt(0)
    ds_read_b128 v[44:47], v6 offset:0
    ds_read_b128 v[48:51], v6 offset:1024
    ds_read_b128 v[52:55], v6 offset:2048
    ds_read_b128 v[56:59], v6 offset:3072
    ds_read_b128 v[60:63], v6 offset:4096
    ds_read_b128 v[64:67], v6 offset:5120
    ds_read_b128 v[68:71], v6 offset:6144
    ds_read_b128 v[72:75], v6 offset:7168
    ds_read_b128 v[76:79], v6 offset:8192
    ds_read_b128 v[80:83], v6 offset:9216
    ds_read_b128 v[84:87], v6 offset:10240
    ds_read_b128 v[88:91], v6 offset:11264
    ds_read_b32 v7, v7
    v_mov_b32 v2, v134
    v_mov_b32 v4, v135
    s_nop 1
    v_permlane16_swap_b32 v2, v4
    v_add_f32 v2, v2, v4
    v_mov_b32 v4, v2
    s_nop 1
    v_permlane32_swap_b32 v2, v4
    v_add_f32 v3, v2, v4
    v_rcp_f32 v2, v3
    v_rcp_f32 v4, v3
    s_mul_i32 s73, s77, 49152
    s_nop 0
    v_permlane16_swap_b32 v2, v4
    v_mov_b32 v3, v2
    v_mov_b32 v5, v4
    v_pk_mul_f32 v[156:157], v[156:157], v[2:3]
    v_pk_mul_f32 v[158:159], v[158:159], v[2:3]
    v_pk_mul_f32 v[164:165], v[164:165], v[2:3]
    v_pk_mul_f32 v[166:167], v[166:167], v[2:3]
    v_cvt_pk_bf16_f32 v92, v156, v157
    v_cvt_pk_bf16_f32 v93, v158, v159
    v_cvt_pk_bf16_f32 v94, v164, v165
    v_cvt_pk_bf16_f32 v95, v166, v167
    ds_write_b128 v6, v[92:95] offset:0
    v_pk_mul_f32 v[160:161], v[160:161], v[4:5]
    v_pk_mul_f32 v[162:163], v[162:163], v[4:5]
    v_pk_mul_f32 v[168:169], v[168:169], v[4:5]
    v_pk_mul_f32 v[170:171], v[170:171], v[4:5]
    v_cvt_pk_bf16_f32 v96, v160, v161
    v_cvt_pk_bf16_f32 v97, v162, v163
    v_cvt_pk_bf16_f32 v98, v168, v169
    v_cvt_pk_bf16_f32 v99, v170, v171
    ds_write_b128 v6, v[96:99] offset:1024
    v_pk_mul_f32 v[172:173], v[172:173], v[2:3]
    v_pk_mul_f32 v[174:175], v[174:175], v[2:3]
    v_pk_mul_f32 v[180:181], v[180:181], v[2:3]
    v_pk_mul_f32 v[182:183], v[182:183], v[2:3]
    v_cvt_pk_bf16_f32 v100, v172, v173
    v_cvt_pk_bf16_f32 v101, v174, v175
    v_cvt_pk_bf16_f32 v102, v180, v181
    v_cvt_pk_bf16_f32 v103, v182, v183
    ds_write_b128 v6, v[100:103] offset:2048
    v_pk_mul_f32 v[176:177], v[176:177], v[4:5]
    v_pk_mul_f32 v[178:179], v[178:179], v[4:5]
    v_pk_mul_f32 v[184:185], v[184:185], v[4:5]
    v_pk_mul_f32 v[186:187], v[186:187], v[4:5]
    v_cvt_pk_bf16_f32 v104, v176, v177
    v_cvt_pk_bf16_f32 v105, v178, v179
    v_cvt_pk_bf16_f32 v106, v184, v185
    v_cvt_pk_bf16_f32 v107, v186, v187
    ds_write_b128 v6, v[104:107] offset:3072
    v_pk_mul_f32 v[188:189], v[188:189], v[2:3]
    v_pk_mul_f32 v[190:191], v[190:191], v[2:3]
    v_pk_mul_f32 v[196:197], v[196:197], v[2:3]
    v_pk_mul_f32 v[198:199], v[198:199], v[2:3]
    v_cvt_pk_bf16_f32 v108, v188, v189
    v_cvt_pk_bf16_f32 v109, v190, v191
    v_cvt_pk_bf16_f32 v110, v196, v197
    v_cvt_pk_bf16_f32 v111, v198, v199
    ds_write_b128 v6, v[108:111] offset:4096
    v_pk_mul_f32 v[192:193], v[192:193], v[4:5]
    v_pk_mul_f32 v[194:195], v[194:195], v[4:5]
    v_pk_mul_f32 v[200:201], v[200:201], v[4:5]
    v_pk_mul_f32 v[202:203], v[202:203], v[4:5]
    v_cvt_pk_bf16_f32 v112, v192, v193
    v_cvt_pk_bf16_f32 v113, v194, v195
    v_cvt_pk_bf16_f32 v114, v200, v201
    v_cvt_pk_bf16_f32 v115, v202, v203
    ds_write_b128 v6, v[112:115] offset:5120
    v_pk_mul_f32 v[204:205], v[204:205], v[2:3]
    v_pk_mul_f32 v[206:207], v[206:207], v[2:3]
    v_pk_mul_f32 v[212:213], v[212:213], v[2:3]
    v_pk_mul_f32 v[214:215], v[214:215], v[2:3]
    v_cvt_pk_bf16_f32 v116, v204, v205
    v_cvt_pk_bf16_f32 v117, v206, v207
    v_cvt_pk_bf16_f32 v118, v212, v213
    v_cvt_pk_bf16_f32 v119, v214, v215
    ds_write_b128 v6, v[116:119] offset:6144
    v_pk_mul_f32 v[208:209], v[208:209], v[4:5]
    v_pk_mul_f32 v[210:211], v[210:211], v[4:5]
    v_pk_mul_f32 v[216:217], v[216:217], v[4:5]
    v_pk_mul_f32 v[218:219], v[218:219], v[4:5]
    v_cvt_pk_bf16_f32 v120, v208, v209
    v_cvt_pk_bf16_f32 v121, v210, v211
    v_cvt_pk_bf16_f32 v122, v216, v217
    v_cvt_pk_bf16_f32 v123, v218, v219
    ds_write_b128 v6, v[120:123] offset:7168
    v_pk_mul_f32 v[220:221], v[220:221], v[2:3]
    v_pk_mul_f32 v[222:223], v[222:223], v[2:3]
    v_pk_mul_f32 v[228:229], v[228:229], v[2:3]
    v_pk_mul_f32 v[230:231], v[230:231], v[2:3]
    v_cvt_pk_bf16_f32 v124, v220, v221
    v_cvt_pk_bf16_f32 v125, v222, v223
    v_cvt_pk_bf16_f32 v126, v228, v229
    v_cvt_pk_bf16_f32 v127, v230, v231
    ds_write_b128 v6, v[124:127] offset:8192
    v_pk_mul_f32 v[224:225], v[224:225], v[4:5]
    v_pk_mul_f32 v[226:227], v[226:227], v[4:5]
    v_pk_mul_f32 v[232:233], v[232:233], v[4:5]
    v_pk_mul_f32 v[234:235], v[234:235], v[4:5]
    v_cvt_pk_bf16_f32 v128, v224, v225
    v_cvt_pk_bf16_f32 v129, v226, v227
    v_cvt_pk_bf16_f32 v130, v232, v233
    v_cvt_pk_bf16_f32 v131, v234, v235
    ds_write_b128 v6, v[128:131] offset:9216
    v_pk_mul_f32 v[236:237], v[236:237], v[2:3]
    v_pk_mul_f32 v[238:239], v[238:239], v[2:3]
    v_pk_mul_f32 v[244:245], v[244:245], v[2:3]
    v_pk_mul_f32 v[246:247], v[246:247], v[2:3]
    v_cvt_pk_bf16_f32 v132, v236, v237
    v_cvt_pk_bf16_f32 v133, v238, v239
    v_cvt_pk_bf16_f32 v134, v244, v245
    v_cvt_pk_bf16_f32 v135, v246, v247
    ds_write_b128 v6, v[132:135] offset:10240
    v_pk_mul_f32 v[240:241], v[240:241], v[4:5]
    v_pk_mul_f32 v[242:243], v[242:243], v[4:5]
    v_pk_mul_f32 v[248:249], v[248:249], v[4:5]
    v_pk_mul_f32 v[250:251], v[250:251], v[4:5]
    v_cvt_pk_bf16_f32 v136, v240, v241
    v_cvt_pk_bf16_f32 v137, v242, v243
    v_cvt_pk_bf16_f32 v138, v248, v249
    v_cvt_pk_bf16_f32 v139, v250, v251
    ds_write_b128 v6, v[136:139] offset:11264
    s_nop 1
    v_mov_b32 v132, 0
    v_mov_b32 v133, s65
    v_mov_b32 v134, 0
    v_mov_b32 v135, s65
    s_add_u32 s77, s77, 1
    s_waitcnt lgkmcnt(12)
    v_readfirstlane_b32 s83, v7
    s_branch K1_A_head
K1_A_last:
    s_setprio 0
    s_waitcnt lgkmcnt(0)
    s_barrier
    s_mul_i32 s73, s3, 192
    s_mov_b32 s74, 2731
    v_add_u32 v3, s73, v0
    v_mul_lo_u32 v4, v3, s74
    v_lshrrev_b32 v4, 16, v4
    v_and_b32 v5, 2, v4
    v_lshlrev_b32 v5, 1, v5
    v_bfe_u32 v6, v4, 2, 2
    v_or_b32 v5, v5, v6
    v_and_b32 v5, 6, v4
    v_mul_u32_u24 v6, 24, v4
    v_sub_u32 v6, v3, v6
    v_xor_b32 v6, v6, v5
    v_add_u32 v3, 12, v6
    v_and_b32 v3, 32, v3
    v_lshl_or_b32 v6, v3, 21, v6
    v_lshlrev_b32 v6, 4, v6
    v_mul_u32_u24 v5, 0x500, v4
    v_add_u32 v12, v5, v6
    v_add_u32 v3, s73, v0
    v_add_u32 v3, 64, v3
    v_mul_lo_u32 v4, v3, s74
    v_lshrrev_b32 v4, 16, v4
    v_and_b32 v5, 2, v4
    v_lshlrev_b32 v5, 1, v5
    v_bfe_u32 v6, v4, 2, 2
    v_or_b32 v5, v5, v6
    v_and_b32 v5, 6, v4
    v_mul_u32_u24 v6, 24, v4
    v_sub_u32 v6, v3, v6
    v_xor_b32 v6, v6, v5
    v_add_u32 v3, 12, v6
    v_and_b32 v3, 32, v3
    v_lshl_or_b32 v6, v3, 21, v6
    v_lshlrev_b32 v6, 4, v6
    v_subrev_u32 v6, 1024, v6
    v_mul_u32_u24 v5, 0x500, v4
    v_add_u32 v13, v5, v6
    v_add_u32 v3, s73, v0
    v_add_u32 v3, 128, v3
    v_mul_lo_u32 v4, v3, s74
    v_lshrrev_b32 v4, 16, v4
    v_and_b32 v5, 2, v4
    v_lshlrev_b32 v5, 1, v5
    v_bfe_u32 v6, v4, 2, 2
    v_or_b32 v5, v5, v6
    v_and_b32 v5, 6, v4
    v_mul_u32_u24 v6, 24, v4
    v_sub_u32 v6, v3, v6
    v_xor_b32 v6, v6, v5
    v_add_u32 v3, 12, v6
    v_and_b32 v3, 32, v3
    v_lshl_or_b32 v6, v3, 21, v6
    v_lshlrev_b32 v6, 4, v6
    v_subrev_u32 v6, 2048, v6
    v_mul_u32_u24 v5, 0x500, v4
    v_add_u32 v14, v5, v6
    s_mov_b32 s44, s24
    s_and_b32 s45, s25, 0xffff
    s_mov_b32 s46, 0x780000
    s_mov_b32 s47, 0x20000
    s_mov_b32 s7, s82
    s_and_b32 s8, s75, 1
    s_mul_i32 s8, s8, 3
    s_mov_b32 s15, s8
    s_mov_b32 s6, 0
    s_add_u32 s6, s6, 1
    s_add_u32 s8, s8, 1
    s_cmp_eq_u32 s8, 6
    s_cselect_b32 s8, 0, s8
    s_cmp_eq_u32 s8, s15
    s_addc_u32 s7, s7, 0
    s_and_b32 s7, s7, 3
    s_add_u32 s6, s6, 1
    s_add_u32 s8, s8, 1
    s_cmp_eq_u32 s8, 6
    s_cselect_b32 s8, 0, s8
    s_cmp_eq_u32 s8, s15
    s_addc_u32 s7, s7, 0
    s_and_b32 s7, s7, 3
    s_add_u32 s6, s6, 1
    s_add_u32 s8, s8, 1
    s_cmp_eq_u32 s8, 6
    s_cselect_b32 s8, 0, s8
    s_cmp_eq_u32 s8, s15
    s_addc_u32 s7, s7, 0
    s_and_b32 s7, s7, 3
    s_add_u32 s6, s6, 1
    s_add_u32 s8, s8, 1
    s_cmp_eq_u32 s8, 6
    s_cselect_b32 s8, 0, s8
    s_cmp_eq_u32 s8, s15
    s_addc_u32 s7, s7, 0
    s_and_b32 s7, s7, 3
    s_add_u32 s6, s6, 1
    s_add_u32 s8, s8, 1
    s_cmp_eq_u32 s8, 6
    s_cselect_b32 s8, 0, s8
    s_cmp_eq_u32 s8, s15
    s_addc_u32 s7, s7, 0
    s_and_b32 s7, s7, 3
    s_add_u32 s6, s6, 1
    s_add_u32 s8, s8, 1
    s_cmp_eq_u32 s8, 6
    s_cselect_b32 s8, 0, s8
    s_cmp_eq_u32 s8, s15
    s_addc_u32 s7, s7, 0
    s_and_b32 s7, s7, 3
    s_add_u32 s6, s6, 1
    s_add_u32 s8, s8, 1
    s_cmp_eq_u32 s8, 6
    s_cselect_b32 s8, 0, s8
    s_cmp_eq_u32 s8, s15
    s_addc_u32 s7, s7, 0
    s_and_b32 s7, s7, 3
    s_add_u32 s80, s81, 86016
    v_mov_b32 v2, v134
    v_mov_b32 v4, v135
    s_nop 1
    v_permlane16_swap_b32 v2, v4
    v_add_f32 v2, v2, v4
    v_mov_b32 v4, v2
    s_nop 1
    v_permlane32_swap_b32 v2, v4
    v_add_f32 v3, v2, v4
    v_rcp_f32 v2, v3
    v_rcp_f32 v4, v3
    s_mul_i32 s73, s77, 49152
    s_nop 0
    v_permlane16_swap_b32 v2, v4
    v_mov_b32 v3, v2
    v_mov_b32 v5, v4
    v_mul_f32 v156, v2, v156
    v_mul_f32 v157, v2, v157
    v_mul_f32 v158, v2, v158
    v_mul_f32 v159, v2, v159
    v_mul_f32 v164, v2, v164
    v_mul_f32 v165, v2, v165
    v_mul_f32 v166, v2, v166
    v_mul_f32 v167, v2, v167
    v_cvt_pk_bf16_f32 v92, v156, v157
    v_cvt_pk_bf16_f32 v93, v158, v159
    v_cvt_pk_bf16_f32 v94, v164, v165
    v_cvt_pk_bf16_f32 v95, v166, v167
    buffer_store_dwordx4 v[92:95], v11, s[60:63], s73 offen offset:0 sc1
    v_mul_f32 v160, v4, v160
    v_mul_f32 v161, v4, v161
    v_mul_f32 v162, v4, v162
    v_mul_f32 v163, v4, v163
    v_mul_f32 v168, v4, v168
    v_mul_f32 v169, v4, v169
    v_mul_f32 v170, v4, v170
    v_mul_f32 v171, v4, v171
    v_cvt_pk_bf16_f32 v96, v160, v161
    v_cvt_pk_bf16_f32 v97, v162, v163
    v_cvt_pk_bf16_f32 v98, v168, v169
    v_cvt_pk_bf16_f32 v99, v170, v171
    s_or_b32 s42, s73, s13
    buffer_store_dwordx4 v[96:99], v11, s[60:63], s42 offen offset:1024 sc1
    s_add_u32 s73, s73, 8192
    s_barrier
    s_mov_b32 m0, s80
    s_mul_i32 s69, s7, 491520
    s_mul_i32 s79, s8, 40960
    s_add_u32 s69, s69, s79
    s_add_u32 s69, s69, s67
    buffer_load_dwordx4 v12, s[44:47], s69 offen offset:0 lds
    buffer_load_dwordx4 v13, s[44:47], s69 offen offset:1024 lds
    buffer_load_dwordx4 v14, s[44:47], s69 offen offset:2048 lds
    s_add_u32 s6, s6, 1
    s_add_u32 s8, s8, 1
    s_cmp_eq_u32 s8, 6
    s_cselect_b32 s8, 0, s8
    s_cmp_eq_u32 s8, s15
    s_addc_u32 s7, s7, 0
    s_and_b32 s7, s7, 3
    s_add_u32 s80, s80, 12288
    s_cmp_ge_u32 s80, 159744
    s_cselect_b32 s79, 98304, 0
    s_sub_u32 s80, s80, s79
    v_mul_f32 v172, v2, v172
    v_mul_f32 v173, v2, v173
    v_mul_f32 v174, v2, v174
    v_mul_f32 v175, v2, v175
    v_mul_f32 v180, v2, v180
    v_mul_f32 v181, v2, v181
    v_mul_f32 v182, v2, v182
    v_mul_f32 v183, v2, v183
    v_cvt_pk_bf16_f32 v100, v172, v173
    v_cvt_pk_bf16_f32 v101, v174, v175
    v_cvt_pk_bf16_f32 v102, v180, v181
    v_cvt_pk_bf16_f32 v103, v182, v183
    buffer_store_dwordx4 v[100:103], v11, s[60:63], s73 offen offset:0 sc1
    v_mul_f32 v176, v4, v176
    v_mul_f32 v177, v4, v177
    v_mul_f32 v178, v4, v178
    v_mul_f32 v179, v4, v179
    v_mul_f32 v184, v4, v184
    v_mul_f32 v185, v4, v185
    v_mul_f32 v186, v4, v186
    v_mul_f32 v187, v4, v187
    v_cvt_pk_bf16_f32 v104, v176, v177
    v_cvt_pk_bf16_f32 v105, v178, v179
    v_cvt_pk_bf16_f32 v106, v184, v185
    v_cvt_pk_bf16_f32 v107, v186, v187
    s_or_b32 s42, s73, s13
    buffer_store_dwordx4 v[104:107], v11, s[60:63], s42 offen offset:1024 sc1
    s_add_u32 s73, s73, 8192
    s_barrier
    s_mov_b32 m0, s80
    s_mul_i32 s69, s7, 491520
    s_mul_i32 s79, s8, 40960
    s_add_u32 s69, s69, s79
    s_add_u32 s69, s69, s67
    buffer_load_dwordx4 v12, s[44:47], s69 offen offset:0 lds
    buffer_load_dwordx4 v13, s[44:47], s69 offen offset:1024 lds
    buffer_load_dwordx4 v14, s[44:47], s69 offen offset:2048 lds
    s_add_u32 s6, s6, 1
    s_add_u32 s8, s8, 1
    s_cmp_eq_u32 s8, 6
    s_cselect_b32 s8, 0, s8
    s_cmp_eq_u32 s8, s15
    s_addc_u32 s7, s7, 0
    s_and_b32 s7, s7, 3
    s_add_u32 s80, s80, 12288
    s_cmp_ge_u32 s80, 159744
    s_cselect_b32 s79, 98304, 0
    s_sub_u32 s80, s80, s79
    v_mul_f32 v188, v2, v188
    v_mul_f32 v189, v2, v189
    v_mul_f32 v190, v2, v190
    v_mul_f32 v191, v2, v191
    v_mul_f32 v196, v2, v196
    v_mul_f32 v197, v2, v197
    v_mul_f32 v198, v2, v198
    v_mul_f32 v199, v2, v199
    v_cvt_pk_bf16_f32 v108, v188, v189
    v_cvt_pk_bf16_f32 v109, v190, v191
    v_cvt_pk_bf16_f32 v110, v196, v197
    v_cvt_pk_bf16_f32 v111, v198, v199
    buffer_store_dwordx4 v[108:111], v11, s[60:63], s73 offen offset:0 sc1
    v_mul_f32 v192, v4, v192
    v_mul_f32 v193, v4, v193
    v_mul_f32 v194, v4, v194
    v_mul_f32 v195, v4, v195
    v_mul_f32 v200, v4, v200
    v_mul_f32 v201, v4, v201
    v_mul_f32 v202, v4, v202
    v_mul_f32 v203, v4, v203
    v_cvt_pk_bf16_f32 v112, v192, v193
    v_cvt_pk_bf16_f32 v113, v194, v195
    v_cvt_pk_bf16_f32 v114, v200, v201
    v_cvt_pk_bf16_f32 v115, v202, v203
    s_or_b32 s42, s73, s13
    buffer_store_dwordx4 v[112:115], v11, s[60:63], s42 offen offset:1024 sc1
    s_add_u32 s73, s73, 8192
    s_barrier
    s_mov_b32 m0, s80
    s_mul_i32 s69, s7, 491520
    s_mul_i32 s79, s8, 40960
    s_add_u32 s69, s69, s79
    s_add_u32 s69, s69, s67
    buffer_load_dwordx4 v12, s[44:47], s69 offen offset:0 lds
    buffer_load_dwordx4 v13, s[44:47], s69 offen offset:1024 lds
    buffer_load_dwordx4 v14, s[44:47], s69 offen offset:2048 lds
    s_add_u32 s6, s6, 1
    s_add_u32 s8, s8, 1
    s_cmp_eq_u32 s8, 6
    s_cselect_b32 s8, 0, s8
    s_cmp_eq_u32 s8, s15
    s_addc_u32 s7, s7, 0
    s_and_b32 s7, s7, 3
    s_add_u32 s80, s80, 12288
    s_cmp_ge_u32 s80, 159744
    s_cselect_b32 s79, 98304, 0
    s_sub_u32 s80, s80, s79
    v_mul_f32 v204, v2, v204
    v_mul_f32 v205, v2, v205
    v_mul_f32 v206, v2, v206
    v_mul_f32 v207, v2, v207
    v_mul_f32 v212, v2, v212
    v_mul_f32 v213, v2, v213
    v_mul_f32 v214, v2, v214
    v_mul_f32 v215, v2, v215
    v_cvt_pk_bf16_f32 v116, v204, v205
    v_cvt_pk_bf16_f32 v117, v206, v207
    v_cvt_pk_bf16_f32 v118, v212, v213
    v_cvt_pk_bf16_f32 v119, v214, v215
    buffer_store_dwordx4 v[116:119], v11, s[60:63], s73 offen offset:0 sc1
    v_mul_f32 v208, v4, v208
    v_mul_f32 v209, v4, v209
    v_mul_f32 v210, v4, v210
    v_mul_f32 v211, v4, v211
    v_mul_f32 v216, v4, v216
    v_mul_f32 v217, v4, v217
    v_mul_f32 v218, v4, v218
    v_mul_f32 v219, v4, v219
    v_cvt_pk_bf16_f32 v120, v208, v209
    v_cvt_pk_bf16_f32 v121, v210, v211
    v_cvt_pk_bf16_f32 v122, v216, v217
    v_cvt_pk_bf16_f32 v123, v218, v219
    s_or_b32 s42, s73, s13
    buffer_store_dwordx4 v[120:123], v11, s[60:63], s42 offen offset:1024 sc1
    s_add_u32 s73, s73, 8192
    s_barrier
    s_mov_b32 m0, s80
    s_mul_i32 s69, s7, 491520
    s_mul_i32 s79, s8, 40960
    s_add_u32 s69, s69, s79
    s_add_u32 s69, s69, s67
    buffer_load_dwordx4 v12, s[44:47], s69 offen offset:0 lds
    buffer_load_dwordx4 v13, s[44:47], s69 offen offset:1024 lds
    buffer_load_dwordx4 v14, s[44:47], s69 offen offset:2048 lds
    s_add_u32 s6, s6, 1
    s_add_u32 s8, s8, 1
    s_cmp_eq_u32 s8, 6
    s_cselect_b32 s8, 0, s8
    s_cmp_eq_u32 s8, s15
    s_addc_u32 s7, s7, 0
    s_and_b32 s7, s7, 3
    s_add_u32 s80, s80, 12288
    s_cmp_ge_u32 s80, 159744
    s_cselect_b32 s79, 98304, 0
    s_sub_u32 s80, s80, s79
    v_mul_f32 v220, v2, v220
    v_mul_f32 v221, v2, v221
    v_mul_f32 v222, v2, v222
    v_mul_f32 v223, v2, v223
    v_mul_f32 v228, v2, v228
    v_mul_f32 v229, v2, v229
    v_mul_f32 v230, v2, v230
    v_mul_f32 v231, v2, v231
    v_cvt_pk_bf16_f32 v124, v220, v221
    v_cvt_pk_bf16_f32 v125, v222, v223
    v_cvt_pk_bf16_f32 v126, v228, v229
    v_cvt_pk_bf16_f32 v127, v230, v231
    buffer_store_dwordx4 v[124:127], v11, s[60:63], s73 offen offset:0 sc1
    v_mul_f32 v224, v4, v224
    v_mul_f32 v225, v4, v225
    v_mul_f32 v226, v4, v226
    v_mul_f32 v227, v4, v227
    v_mul_f32 v232, v4, v232
    v_mul_f32 v233, v4, v233
    v_mul_f32 v234, v4, v234
    v_mul_f32 v235, v4, v235
    v_cvt_pk_bf16_f32 v128, v224, v225
    v_cvt_pk_bf16_f32 v129, v226, v227
    v_cvt_pk_bf16_f32 v130, v232, v233
    v_cvt_pk_bf16_f32 v131, v234, v235
    s_or_b32 s42, s73, s13
    buffer_store_dwordx4 v[128:131], v11, s[60:63], s42 offen offset:1024 sc1
    s_add_u32 s73, s73, 8192
    s_barrier
    s_mov_b32 m0, s80
    s_mul_i32 s69, s7, 491520
    s_mul_i32 s79, s8, 40960
    s_add_u32 s69, s69, s79
    s_add_u32 s69, s69, s67
    buffer_load_dwordx4 v12, s[44:47], s69 offen offset:0 lds
    buffer_load_dwordx4 v13, s[44:47], s69 offen offset:1024 lds
    buffer_load_dwordx4 v14, s[44:47], s69 offen offset:2048 lds
    s_add_u32 s6, s6, 1
    s_add_u32 s8, s8, 1
    s_cmp_eq_u32 s8, 6
    s_cselect_b32 s8, 0, s8
    s_cmp_eq_u32 s8, s15
    s_addc_u32 s7, s7, 0
    s_and_b32 s7, s7, 3
    s_add_u32 s80, s80, 12288
    s_cmp_ge_u32 s80, 159744
    s_cselect_b32 s79, 98304, 0
    s_sub_u32 s80, s80, s79
    v_mul_f32 v236, v2, v236
    v_mul_f32 v237, v2, v237
    v_mul_f32 v238, v2, v238
    v_mul_f32 v239, v2, v239
    v_mul_f32 v244, v2, v244
    v_mul_f32 v245, v2, v245
    v_mul_f32 v246, v2, v246
    v_mul_f32 v247, v2, v247
    v_cvt_pk_bf16_f32 v132, v236, v237
    v_cvt_pk_bf16_f32 v133, v238, v239
    v_cvt_pk_bf16_f32 v134, v244, v245
    v_cvt_pk_bf16_f32 v135, v246, v247
    buffer_store_dwordx4 v[132:135], v11, s[60:63], s73 offen offset:0 sc1
    v_mul_f32 v240, v4, v240
    v_mul_f32 v241, v4, v241
    v_mul_f32 v242, v4, v242
    v_mul_f32 v243, v4, v243
    v_mul_f32 v248, v4, v248
    v_mul_f32 v249, v4, v249
    v_mul_f32 v250, v4, v250
    v_mul_f32 v251, v4, v251
    v_cvt_pk_bf16_f32 v136, v240, v241
    v_cvt_pk_bf16_f32 v137, v242, v243
    v_cvt_pk_bf16_f32 v138, v248, v249
    v_cvt_pk_bf16_f32 v139, v250, v251
    s_or_b32 s42, s73, s13
    buffer_store_dwordx4 v[136:139], v11, s[60:63], s42 offen offset:1024 sc1
    s_barrier
    s_mov_b32 m0, s80
    s_mul_i32 s69, s7, 491520
    s_mul_i32 s79, s8, 40960
    s_add_u32 s69, s69, s79
    s_add_u32 s69, s69, s67
    buffer_load_dwordx4 v12, s[44:47], s69 offen offset:0 lds
    buffer_load_dwordx4 v13, s[44:47], s69 offen offset:1024 lds
    buffer_load_dwordx4 v14, s[44:47], s69 offen offset:2048 lds
    s_add_u32 s6, s6, 1
    s_add_u32 s8, s8, 1
    s_cmp_eq_u32 s8, 6
    s_cselect_b32 s8, 0, s8
    s_cmp_eq_u32 s8, s15
    s_addc_u32 s7, s7, 0
    s_and_b32 s7, s7, 3
    s_add_u32 s80, s80, 12288
    s_cmp_ge_u32 s80, 159744
    s_cselect_b32 s79, 98304, 0
    s_sub_u32 s80, s80, s79
    s_nop 1
    s_mov_b32 s72, 18
K1_A_tl:
    s_cmp_eq_u32 s6, s72
    s_cbranch_scc1 K1_A_ev
K1_A_evb:
    s_mov_b32 m0, s80
    s_mul_i32 s69, s7, 491520
    s_mul_i32 s79, s8, 40960
    s_add_u32 s69, s69, s79
    s_add_u32 s69, s69, s67
    s_add_u32 s6, s6, 1
    s_add_u32 s8, s8, 1
    s_cmp_eq_u32 s8, 6
    s_cselect_b32 s8, 0, s8
    s_cmp_eq_u32 s8, s15
    s_addc_u32 s7, s7, 0
    s_and_b32 s7, s7, 3
    s_add_u32 s80, s80, 12288
    s_cmp_ge_u32 s80, 159744
    s_cselect_b32 s79, 98304, 0
    s_sub_u32 s80, s80, s79
    s_cmp_lt_u32 s6, 48
    s_waitcnt vmcnt(15)
    s_barrier
    buffer_load_dwordx4 v12, s[44:47], s69 offen offset:0 lds
    buffer_load_dwordx4 v13, s[44:47], s69 offen offset:1024 lds
    buffer_load_dwordx4 v14, s[44:47], s69 offen offset:2048 lds
    s_cbranch_scc1 K1_A_tl
    s_waitcnt vmcnt(15)
    s_barrier
    s_waitcnt vmcnt(12)
    s_barrier
    s_waitcnt vmcnt(9)
    s_barrier
    s_waitcnt vmcnt(6)
    s_barrier
    s_waitcnt vmcnt(3)
    s_barrier
    s_waitcnt vmcnt(0)
    s_barrier
    s_waitcnt vmcnt(0)
    s_barrier
    s_branch K1_pend
K1_A_ev:
    s_lshl_b32 s64, s3, 8
    s_add_u32 s64, s64, s6
    s_cmp_eq_u32 s64, 18
    s_cbranch_scc0 K1_w56
    s_lshl_b32 s73, s91, 7
    s_add_u32 s73, s73, 0x3e00000
    s_add_u32 s74, s83, 4
    v_mov_b32 v5, 0
    v_mov_b32 v6, s74
    s_mov_b64 exec, 1
    buffer_store_dword v6, v5, s[60:63], s73 offen offset:0 sc1
    s_mov_b64 exec, -1
K1_w56:
    s_cmp_eq_u32 s64, 29
    s_cbranch_scc0 K1_w57
    s_waitcnt vmcnt(9)
    s_add_u32 s73, s83, 4
    v_subrev_u32 v7, s73, v7
    v_cmp_lt_u32 vcc, 3, v7
    s_cbranch_vccz K1_polld59
    s_mov_b32 s74, 0
K1_poll58:
    buffer_load_dword v7, v6, s[60:63], 0 offen sc1
    s_waitcnt vmcnt(0)
    s_add_u32 s73, s83, 4
    v_subrev_u32 v7, s73, v7
    v_cmp_lt_u32 vcc, 3, v7
    s_cbranch_vccz K1_polld59
    s_sleep 4
    s_add_u32 s74, s74, 1
    s_cmp_lt_u32 s74, 0x400000
    s_cbranch_scc1 K1_poll58
K1_polld59:
K1_w57:
    s_cmp_eq_u32 s64, 26
    s_cbranch_scc0 K1_w60
    s_sub_u32 s73, s91, s82
    v_min_u32 v6, 3, v0
    v_add_u32 v6, s73, v6
    v_lshlrev_b32 v6, 7, v6
    v_add_u32 v6, 0x3e00000, v6
    buffer_load_dword v7, v6, s[60:63], 0 offen sc1
K1_w60:
    s_cmp_eq_u32 s6, 24
    s_cbranch_scc0 K1_w61
    s_add_u32 s67, s67, 245760
K1_w61:
    s_cmp_eq_u32 s6, 26
    s_cselect_b32 s72, 29, s72
    s_cmp_eq_u32 s6, 24
    s_cselect_b32 s72, 26, s72
    s_cmp_eq_u32 s6, 18
    s_cselect_b32 s72, 24, s72
    s_branch K1_A_evb
K1_G:
    s_mul_i32 s65, s78, 768
    s_sub_u32 s73, s3, 4
    s_lshl_b32 s78, s73, 12
    s_lshl_b32 s74, s73, 5
    v_lshrrev_b32 v3, 3, v0
    v_add_u32 v3, s74, v3
    v_lshrrev_b32 v4, 4, v0
    v_and_b32 v5, 7, v0
    v_xor_b32 v4, v4, v5
    v_add_u32 v5, 0, v3
    v_mul_u32_u24 v6, 0x500, v5
    v_lshl_add_u32 v6, v4, 4, v6
    v_cmp_gt_u32 vcc, 112, v5
    v_mov_b32 v7, 0x40000000
    s_nop 0
    v_cndmask_b32 v56, v7, v6, vcc
    v_add_u32 v5, 8, v3
    v_mul_u32_u24 v6, 0x500, v5
    v_xor_b32 v7, 4, v4
    v_lshl_add_u32 v6, v7, 4, v6
    v_subrev_u32 v6, 1024, v6
    v_cmp_gt_u32 vcc, 112, v5
    v_mov_b32 v7, 0x40000000
    s_nop 0
    v_cndmask_b32 v57, v7, v6, vcc
    v_add_u32 v5, 16, v3
    v_mul_u32_u24 v6, 0x500, v5
    v_lshl_add_u32 v6, v4, 4, v6
    v_subrev_u32 v6, 2048, v6
    v_cmp_gt_u32 vcc, 112, v5
    v_mov_b32 v7, 0x40000000
    s_nop 0
    v_cndmask_b32 v58, v7, v6, vcc
    v_add_u32 v5, 24, v3
    v_mul_u32_u24 v6, 0x500, v5
    v_xor_b32 v7, 4, v4
    v_lshl_add_u32 v6, v7, 4, v6
    v_subrev_u32 v6, 3072, v6
    v_cmp_gt_u32 vcc, 112, v5
    v_mov_b32 v7, 0x40000000
    s_nop 0
    v_cndmask_b32 v59, v7, v6, vcc
    s_mul_i32 s73, s73, 192
    s_mov_b32 s74, 2731
    v_add_u32 v3, s73, v0
    v_mul_lo_u32 v4, v3, s74
    v_lshrrev_b32 v4, 16, v4
    v_and_b32 v5, 2, v4
    v_lshlrev_b32 v5, 1, v5
    v_bfe_u32 v6, v4, 2, 2
    v_or_b32 v5, v5, v6
    v_xor_b32 v6, v5, v0
    v_lshlrev_b32 v6, 4, v6
    v_add_u32 v52, s81, v6
    v_and_b32 v5, 6, v5
    v_mul_u32_u24 v6, 24, v4
    v_sub_u32 v6, v3, v6
    v_xor_b32 v6, v6, v5
    v_lshlrev_b32 v6, 4, v6
    v_mul_u32_u24 v5, 0x3000, v4
    v_add_u32 v44, v5, v6
    v_add_u32 v3, s73, v0
    v_add_u32 v3, 64, v3
    v_mul_lo_u32 v4, v3, s74
    v_lshrrev_b32 v4, 16, v4
    v_and_b32 v5, 2, v4
    v_lshlrev_b32 v5, 1, v5
    v_bfe_u32 v6, v4, 2, 2
    v_or_b32 v5, v5, v6
    v_xor_b32 v6, v5, v0
    v_lshlrev_b32 v6, 4, v6
    v_add_u32 v53, s81, v6
    v_and_b32 v5, 6, v5
    v_mul_u32_u24 v6, 24, v4
    v_sub_u32 v6, v3, v6
    v_xor_b32 v6, v6, v5
    v_lshlrev_b32 v6, 4, v6
    v_subrev_u32 v6, 1024, v6
    v_mul_u32_u24 v5, 0x3000, v4
    v_add_u32 v45, v5, v6
    v_add_u32 v3, s73, v0
    v_add_u32 v3, 128, v3
    v_mul_lo_u32 v4, v3, s74
    v_lshrrev_b32 v4, 16, v4
    v_and_b32 v5, 2, v4
    v_lshlrev_b32 v5, 1, v5
    v_bfe_u32 v6, v4, 2, 2
    v_or_b32 v5, v5, v6
    v_xor_b32 v6, v5, v0
    v_lshlrev_b32 v6, 4, v6
    v_add_u32 v54, s81, v6
    v_and_b32 v5, 6, v5
    v_mul_u32_u24 v6, 24, v4
    v_sub_u32 v6, v3, v6
    v_xor_b32 v6, v6, v5
    v_lshlrev_b32 v6, 4, v6
    v_subrev_u32 v6, 2048, v6
    v_mul_u32_u24 v5, 0x3000, v4
    v_add_u32 v46, v5, v6
    s_mul_i32 s73, s82, 3
    s_add_u32 s73, s73, s75
    s_lshr_b32 s74, s75, 2
    s_add_u32 s73, s73, s74
    s_cmp_ge_u32 s73, 10
    s_cselect_b32 s74, 10, 0
    s_sub_u32 s73, s73, s74
    s_lshl_b32 s70, s73, 7
    s_lshl_b32 s64, s73, 1
    s_setprio 2
    s_add_u32 m0, s78, 131072
    s_add_u32 s73, s70, s89
    s_add_u32 s70, s70, 128
    s_cmp_eq_u32 s70, 1280
    s_cselect_b32 s70, 0, s70
    buffer_load_dwordx4 v56, s[48:51], s73 offen offset:0 lds
    buffer_load_dwordx4 v57, s[48:51], s73 offen offset:1024 lds
    buffer_load_dwordx4 v58, s[48:51], s73 offen offset:2048 lds
    buffer_load_dwordx4 v59, s[48:51], s73 offen offset:3072 lds
    s_add_u32 m0, s81, 0
    s_mul_i32 s69, s64, 0x60000
    s_add_u32 s69, s69, s65
    buffer_load_dwordx4 v44, s[44:47], s69 offen offset:0 lds
    buffer_load_dwordx4 v45, s[44:47], s69 offen offset:1024 lds
    buffer_load_dwordx4 v46, s[44:47], s69 offen offset:2048 lds
    s_add_u32 m0, s81, 12288
    s_add_u32 s69, s69, 384
    s_add_u32 s64, s64, 1
    s_cmp_eq_u32 s64, 20
    s_cselect_b32 s64, 0, s64
    buffer_load_dwordx4 v44, s[44:47], s69 offen offset:0 lds
    buffer_load_dwordx4 v45, s[44:47], s69 offen offset:1024 lds
    buffer_load_dwordx4 v46, s[44:47], s69 offen offset:2048 lds
    s_add_u32 m0, s81, 24576
    s_mul_i32 s69, s64, 0x60000
    s_add_u32 s69, s69, s65
    buffer_load_dwordx4 v44, s[44:47], s69 offen offset:0 lds
    buffer_load_dwordx4 v45, s[44:47], s69 offen offset:1024 lds
    buffer_load_dwordx4 v46, s[44:47], s69 offen offset:2048 lds
    s_add_u32 m0, s81, 36864
    s_add_u32 s69, s69, 384
    s_add_u32 s64, s64, 1
    s_cmp_eq_u32 s64, 20
    s_cselect_b32 s64, 0, s64
    buffer_load_dwordx4 v44, s[44:47], s69 offen offset:0 lds
    buffer_load_dwordx4 v45, s[44:47], s69 offen offset:1024 lds
    buffer_load_dwordx4 v46, s[44:47], s69 offen offset:2048 lds
    s_memrealtime s[32:33]
    v_lshrrev_b32 v2, 4, v0
    v_bfe_u32 v3, v0, 2, 2
    v_lshl_add_u32 v4, v2, 3, v3
    v_mul_u32_u24 v4, 0x180, v4
    v_and_b32 v3, 2, v3
    v_and_b32 v5, 1, v2
    v_or_b32 v3, v3, v5
    v_bfe_u32 v5, v0, 1, 1
    v_lshl_or_b32 v3, v3, 1, v5
    v_lshl_add_u32 v4, v3, 4, v4
    v_and_b32 v5, 1, v0
    v_lshl_add_u32 v4, v5, 3, v4
    s_and_b32 s73, s3, 3
    s_mul_i32 s73, s73, 96
    s_and_b32 s74, s73, 96
    v_xor_b32 v12, s74, v4
    s_andn2_b32 s74, s73, 127
    s_add_u32 s74, s74, 12288
    v_add_u32 v12, s74, v12
    v_add_u32 v15, 0xc000, v12
    s_add_u32 s73, s73, 32
    s_and_b32 s74, s73, 96
    v_xor_b32 v13, s74, v4
    s_andn2_b32 s74, s73, 127
    s_add_u32 s74, s74, 12288
    v_add_u32 v13, s74, v13
    v_add_u32 v16, 0xc000, v13
    s_add_u32 s73, s73, 32
    s_and_b32 s74, s73, 96
    v_xor_b32 v14, s74, v4
    s_andn2_b32 s74, s73, 127
    s_add_u32 s74, s74, 12288
    v_add_u32 v14, s74, v14
    v_add_u32 v17, 0xc000, v14
    s_add_u32 s73, s73, 32
    v_and_b32 v3, 15, v0
    v_lshrrev_b32 v5, 1, v3
    v_xor_b32 v5, v5, v2
    v_lshlrev_b32 v5, 4, v5
    v_lshl_add_u32 v5, v3, 7, v5
    v_add_u32 v18, 0x18000, v5
    v_xor_b32 v19, 64, v18
    s_waitcnt lgkmcnt(0)
    v_lshlrev_b32 v8, 4, v0
    v_add_u32 v8, s81, v8
    v_add_u32 v9, 0xf000, v8
    v_mov_b64 v[88:89], 0
    v_mov_b64 v[90:91], 0
    v_mov_b64 v[92:93], 0
    v_mov_b64 v[94:95], 0
    v_mov_b64 v[96:97], 0
    v_mov_b64 v[98:99], 0
    v_mov_b64 v[100:101], 0
    v_mov_b64 v[102:103], 0
    v_mov_b64 v[104:105], 0
    v_mov_b64 v[106:107], 0
    v_mov_b64 v[108:109], 0
    v_mov_b64 v[110:111], 0
    v_mov_b64 v[112:113], 0
    v_mov_b64 v[114:115], 0
    v_mov_b64 v[116:117], 0
    v_mov_b64 v[118:119], 0
    v_mov_b64 v[120:121], 0
    v_mov_b64 v[122:123], 0
    v_mov_b64 v[124:125], 0
    v_mov_b64 v[126:127], 0
    v_mov_b64 v[128:129], 0
    v_mov_b64 v[130:131], 0
    v_mov_b64 v[132:133], 0
    v_mov_b64 v[134:135], 0
    v_mov_b64 v[136:137], 0
    v_mov_b64 v[138:139], 0
    v_mov_b64 v[140:141], 0
    v_mov_b64 v[142:143], 0
    v_mov_b64 v[144:145], 0
    v_mov_b64 v[146:147], 0
    v_mov_b64 v[148:149], 0
    v_mov_b64 v[150:151], 0
    v_mov_b64 v[152:153], 0
    v_mov_b64 v[154:155], 0
    v_mov_b64 v[156:157], 0
    v_mov_b64 v[158:159], 0
    v_mov_b64 v[160:161], 0
    v_mov_b64 v[162:163], 0
    v_mov_b64 v[164:165], 0
    v_mov_b64 v[166:167], 0
    v_mov_b64 v[168:169], 0
    v_mov_b64 v[170:171], 0
    s_waitcnt vmcnt(6)
    s_barrier
    ds_read_b64_tr_b16 v[20:21], v12 offset:0
    ds_read_b64_tr_b16 v[22:23], v12 offset:1536
    ds_read_b128 v[60:63], v18 offset:32768
    ds_read_b64_tr_b16 v[24:25], v13 offset:0
    ds_read_b64_tr_b16 v[26:27], v13 offset:1536
    ds_read_b64_tr_b16 v[28:29], v14 offset:0
    ds_read_b64_tr_b16 v[30:31], v14 offset:1536
    ds_read_b128 v[64:67], v18 offset:34816
    ds_read_b128 v[68:71], v18 offset:36864
    s_waitcnt lgkmcnt(4)
    v_mfma_f32_16x16x32_bf16 v[88:91], v[20:23], v[60:63], v[88:91]
    s_add_u32 m0, s78, 147456
    s_add_u32 s73, s70, s89
    s_add_u32 s70, s70, 128
    s_cmp_eq_u32 s70, 1280
    s_cselect_b32 s70, 0, s70
    buffer_load_dwordx4 v56, s[48:51], s73 offen offset:0 lds
    buffer_load_dwordx4 v57, s[48:51], s73 offen offset:1024 lds
    v_mfma_f32_16x16x32_bf16 v[116:119], v[24:27], v[60:63], v[116:119]
    buffer_load_dwordx4 v58, s[48:51], s73 offen offset:2048 lds
    buffer_load_dwordx4 v59, s[48:51], s73 offen offset:3072 lds
    s_waitcnt lgkmcnt(1)
    v_mfma_f32_16x16x32_bf16 v[144:147], v[28:31], v[60:63], v[144:147]
    s_add_u32 m0, s81, 49152
    s_mul_i32 s69, s64, 0x60000
    s_add_u32 s69, s69, s65
    buffer_load_dwordx4 v44, s[44:47], s69 offen offset:0 lds
    buffer_load_dwordx4 v45, s[44:47], s69 offen offset:1024 lds
    ds_read_b128 v[72:75], v18 offset:38912
    v_mfma_f32_16x16x32_bf16 v[92:95], v[20:23], v[64:67], v[92:95]
    buffer_load_dwordx4 v46, s[44:47], s69 offen offset:2048 lds
    s_add_u32 m0, s81, 61440
    s_add_u32 s69, s69, 384
    s_add_u32 s64, s64, 1
    s_cmp_eq_u32 s64, 20
    s_cselect_b32 s64, 0, s64
    buffer_load_dwordx4 v44, s[44:47], s69 offen offset:0 lds
    v_mfma_f32_16x16x32_bf16 v[120:123], v[24:27], v[64:67], v[120:123]
    buffer_load_dwordx4 v45, s[44:47], s69 offen offset:1024 lds
    buffer_load_dwordx4 v46, s[44:47], s69 offen offset:2048 lds
    v_mfma_f32_16x16x32_bf16 v[148:151], v[28:31], v[64:67], v[148:151]
    s_add_u32 m0, s81, 73728
    s_mul_i32 s69, s64, 0x60000
    s_add_u32 s69, s69, s65
    buffer_load_dwordx4 v44, s[44:47], s69 offen offset:0 lds
    buffer_load_dwordx4 v45, s[44:47], s69 offen offset:1024 lds
    ds_read_b128 v[60:63], v18 offset:40960
    s_waitcnt lgkmcnt(1)
    v_mfma_f32_16x16x32_bf16 v[96:99], v[20:23], v[68:71], v[96:99]
    buffer_load_dwordx4 v46, s[44:47], s69 offen offset:2048 lds
    s_add_u32 m0, s81, 86016
    s_add_u32 s69, s69, 384
    s_add_u32 s64, s64, 1
    s_cmp_eq_u32 s64, 20
    s_cselect_b32 s64, 0, s64
    buffer_load_dwordx4 v44, s[44:47], s69 offen offset:0 lds
    v_mfma_f32_16x16x32_bf16 v[124:127], v[24:27], v[68:71], v[124:127]
    buffer_load_dwordx4 v45, s[44:47], s69 offen offset:1024 lds
    buffer_load_dwordx4 v46, s[44:47], s69 offen offset:2048 lds
    v_mfma_f32_16x16x32_bf16 v[152:155], v[28:31], v[68:71], v[152:155]
    ds_read_b128 v[64:67], v18 offset:43008
    v_mfma_f32_16x16x32_bf16 v[100:103], v[20:23], v[72:75], v[100:103]
    v_mfma_f32_16x16x32_bf16 v[128:131], v[24:27], v[72:75], v[128:131]
    v_mfma_f32_16x16x32_bf16 v[156:159], v[28:31], v[72:75], v[156:159]
    ds_read_b128 v[68:71], v18 offset:45056
    s_waitcnt lgkmcnt(2)
    v_mfma_f32_16x16x32_bf16 v[104:107], v[20:23], v[60:63], v[104:107]
    v_mfma_f32_16x16x32_bf16 v[132:135], v[24:27], v[60:63], v[132:135]
    v_mfma_f32_16x16x32_bf16 v[160:163], v[28:31], v[60:63], v[160:163]
    s_waitcnt vmcnt(16) lgkmcnt(0)
    s_barrier
    v_mfma_f32_16x16x32_bf16 v[108:111], v[20:23], v[64:67], v[108:111]
    ds_read_b64_tr_b16 v[32:33], v12 offset:24576
    ds_read_b64_tr_b16 v[34:35], v12 offset:26112
    ds_read_b128 v[72:75], v19 offset:32768
    s_add_u32 m0, s81, 0
    s_mul_i32 s69, s64, 0x60000
    s_add_u32 s69, s69, s65
    buffer_load_dwordx4 v44, s[44:47], s69 offen offset:0 lds
    v_mfma_f32_16x16x32_bf16 v[136:139], v[24:27], v[64:67], v[136:139]
    ds_read_b64_tr_b16 v[36:37], v13 offset:24576
    ds_read_b64_tr_b16 v[38:39], v13 offset:26112
    ds_read_b64_tr_b16 v[40:41], v14 offset:24576
    buffer_load_dwordx4 v45, s[44:47], s69 offen offset:1024 lds
    v_mfma_f32_16x16x32_bf16 v[164:167], v[28:31], v[64:67], v[164:167]
    ds_read_b64_tr_b16 v[42:43], v14 offset:26112
    ds_read_b128 v[60:63], v19 offset:34816
    buffer_load_dwordx4 v46, s[44:47], s69 offen offset:2048 lds
    v_mfma_f32_16x16x32_bf16 v[112:115], v[20:23], v[68:71], v[112:115]
    s_add_u32 m0, s81, 12288
    s_add_u32 s69, s69, 384
    s_add_u32 s64, s64, 1
    s_cmp_eq_u32 s64, 20
    s_cselect_b32 s64, 0, s64
    buffer_load_dwordx4 v44, s[44:47], s69 offen offset:0 lds
    v_mfma_f32_16x16x32_bf16 v[140:143], v[24:27], v[68:71], v[140:143]
    buffer_load_dwordx4 v45, s[44:47], s69 offen offset:1024 lds
    v_mfma_f32_16x16x32_bf16 v[168:171], v[28:31], v[68:71], v[168:171]
    buffer_load_dwordx4 v46, s[44:47], s69 offen offset:2048 lds
    ds_read_b128 v[64:67], v19 offset:36864
    s_waitcnt lgkmcnt(4)
    v_mfma_f32_16x16x32_bf16 v[88:91], v[32:35], v[72:75], v[88:91]
    s_add_u32 m0, s78, 98304
    s_add_u32 s73, s70, s89
    s_add_u32 s70, s70, 128
    s_cmp_eq_u32 s70, 1280
    s_cselect_b32 s70, 0, s70
    buffer_load_dwordx4 v56, s[48:51], s73 offen offset:0 lds
    v_mfma_f32_16x16x32_bf16 v[116:119], v[36:39], v[72:75], v[116:119]
    buffer_load_dwordx4 v57, s[48:51], s73 offen offset:1024 lds
    s_waitcnt lgkmcnt(1)
    v_mfma_f32_16x16x32_bf16 v[144:147], v[40:43], v[72:75], v[144:147]
    buffer_load_dwordx4 v58, s[48:51], s73 offen offset:2048 lds
    ds_read_b128 v[68:71], v19 offset:38912
    v_mfma_f32_16x16x32_bf16 v[92:95], v[32:35], v[60:63], v[92:95]
    buffer_load_dwordx4 v59, s[48:51], s73 offen offset:3072 lds
    v_mfma_f32_16x16x32_bf16 v[120:123], v[36:39], v[60:63], v[120:123]
    v_mfma_f32_16x16x32_bf16 v[148:151], v[40:43], v[60:63], v[148:151]
    ds_read_b128 v[72:75], v19 offset:40960
    s_waitcnt lgkmcnt(1)
    v_mfma_f32_16x16x32_bf16 v[96:99], v[32:35], v[64:67], v[96:99]
    v_mfma_f32_16x16x32_bf16 v[124:127], v[36:39], v[64:67], v[124:127]
    v_mfma_f32_16x16x32_bf16 v[152:155], v[40:43], v[64:67], v[152:155]
    ds_read_b128 v[60:63], v19 offset:43008
    v_mfma_f32_16x16x32_bf16 v[100:103], v[32:35], v[68:71], v[100:103]
    v_mfma_f32_16x16x32_bf16 v[128:131], v[36:39], v[68:71], v[128:131]
    v_mfma_f32_16x16x32_bf16 v[156:159], v[40:43], v[68:71], v[156:159]
    ds_read_b128 v[64:67], v19 offset:45056
    s_waitcnt lgkmcnt(2)
    v_mfma_f32_16x16x32_bf16 v[104:107], v[32:35], v[72:75], v[104:107]
    v_mfma_f32_16x16x32_bf16 v[132:135], v[36:39], v[72:75], v[132:135]
    v_mfma_f32_16x16x32_bf16 v[160:163], v[40:43], v[72:75], v[160:163]
    s_waitcnt vmcnt(16) lgkmcnt(0)
    s_barrier
    v_mfma_f32_16x16x32_bf16 v[108:111], v[32:35], v[60:63], v[108:111]
    ds_read_b64_tr_b16 v[20:21], v15 offset:0
    ds_read_b64_tr_b16 v[22:23], v15 offset:1536
    ds_read_b128 v[68:71], v18 offset:49152
    s_add_u32 m0, s81, 24576
    s_mul_i32 s69, s64, 0x60000
    s_add_u32 s69, s69, s65
    buffer_load_dwordx4 v44, s[44:47], s69 offen offset:0 lds
    v_mfma_f32_16x16x32_bf16 v[136:139], v[36:39], v[60:63], v[136:139]
    ds_read_b64_tr_b16 v[24:25], v16 offset:0
    ds_read_b64_tr_b16 v[26:27], v16 offset:1536
    ds_read_b64_tr_b16 v[28:29], v17 offset:0
    buffer_load_dwordx4 v45, s[44:47], s69 offen offset:1024 lds
    v_mfma_f32_16x16x32_bf16 v[164:167], v[40:43], v[60:63], v[164:167]
    ds_read_b64_tr_b16 v[30:31], v17 offset:1536
    ds_read_b128 v[72:75], v18 offset:51200
    buffer_load_dwordx4 v46, s[44:47], s69 offen offset:2048 lds
    v_mfma_f32_16x16x32_bf16 v[112:115], v[32:35], v[64:67], v[112:115]
    s_add_u32 m0, s81, 36864
    s_add_u32 s69, s69, 384
    s_add_u32 s64, s64, 1
    s_cmp_eq_u32 s64, 20
    s_cselect_b32 s64, 0, s64
    buffer_load_dwordx4 v44, s[44:47], s69 offen offset:0 lds
    v_mfma_f32_16x16x32_bf16 v[140:143], v[36:39], v[64:67], v[140:143]
    buffer_load_dwordx4 v45, s[44:47], s69 offen offset:1024 lds
    v_mfma_f32_16x16x32_bf16 v[168:171], v[40:43], v[64:67], v[168:171]
    buffer_load_dwordx4 v46, s[44:47], s69 offen offset:2048 lds
    ds_read_b128 v[60:63], v18 offset:53248
    s_waitcnt lgkmcnt(4)
    v_mfma_f32_16x16x32_bf16 v[88:91], v[20:23], v[68:71], v[88:91]
    s_add_u32 m0, s78, 114688
    s_add_u32 s73, s70, s89
    s_add_u32 s70, s70, 128
    s_cmp_eq_u32 s70, 1280
    s_cselect_b32 s70, 0, s70
    buffer_load_dwordx4 v56, s[48:51], s73 offen offset:0 lds
    v_mfma_f32_16x16x32_bf16 v[116:119], v[24:27], v[68:71], v[116:119]
    buffer_load_dwordx4 v57, s[48:51], s73 offen offset:1024 lds
    s_waitcnt lgkmcnt(1)
    v_mfma_f32_16x16x32_bf16 v[144:147], v[28:31], v[68:71], v[144:147]
    buffer_load_dwordx4 v58, s[48:51], s73 offen offset:2048 lds
    ds_read_b128 v[64:67], v18 offset:55296
    v_mfma_f32_16x16x32_bf16 v[92:95], v[20:23], v[72:75], v[92:95]
    buffer_load_dwordx4 v59, s[48:51], s73 offen offset:3072 lds
    v_mfma_f32_16x16x32_bf16 v[120:123], v[24:27], v[72:75], v[120:123]
    v_mfma_f32_16x16x32_bf16 v[148:151], v[28:31], v[72:75], v[148:151]
    ds_read_b128 v[68:71], v18 offset:57344
    s_waitcnt lgkmcnt(1)
    v_mfma_f32_16x16x32_bf16 v[96:99], v[20:23], v[60:63], v[96:99]
    v_mfma_f32_16x16x32_bf16 v[124:127], v[24:27], v[60:63], v[124:127]
    v_mfma_f32_16x16x32_bf16 v[152:155], v[28:31], v[60:63], v[152:155]
    ds_read_b128 v[72:75], v18 offset:59392
    v_mfma_f32_16x16x32_bf16 v[100:103], v[20:23], v[64:67], v[100:103]
    v_mfma_f32_16x16x32_bf16 v[128:131], v[24:27], v[64:67], v[128:131]
    v_mfma_f32_16x16x32_bf16 v[156:159], v[28:31], v[64:67], v[156:159]
    ds_read_b128 v[60:63], v18 offset:61440
    s_waitcnt lgkmcnt(2)
    v_mfma_f32_16x16x32_bf16 v[104:107], v[20:23], v[68:71], v[104:107]
    v_mfma_f32_16x16x32_bf16 v[132:135], v[24:27], v[68:71], v[132:135]
    v_mfma_f32_16x16x32_bf16 v[160:163], v[28:31], v[68:71], v[160:163]
    s_waitcnt vmcnt(20) lgkmcnt(0)
    s_barrier
    v_mfma_f32_16x16x32_bf16 v[108:111], v[20:23], v[72:75], v[108:111]
    ds_read_b64_tr_b16 v[32:33], v15 offset:24576
    ds_read_b64_tr_b16 v[34:35], v15 offset:26112
    ds_read_b128 v[64:67], v19 offset:49152
    s_add_u32 m0, s81, 49152
    s_mul_i32 s69, s64, 0x60000
    s_add_u32 s69, s69, s65
    buffer_load_dwordx4 v44, s[44:47], s69 offen offset:0 lds
    v_mfma_f32_16x16x32_bf16 v[136:139], v[24:27], v[72:75], v[136:139]
    ds_read_b64_tr_b16 v[36:37], v16 offset:24576
    ds_read_b64_tr_b16 v[38:39], v16 offset:26112
    ds_read_b64_tr_b16 v[40:41], v17 offset:24576
    buffer_load_dwordx4 v45, s[44:47], s69 offen offset:1024 lds
    v_mfma_f32_16x16x32_bf16 v[164:167], v[28:31], v[72:75], v[164:167]
    ds_read_b64_tr_b16 v[42:43], v17 offset:26112
    ds_read_b128 v[68:71], v19 offset:51200
    buffer_load_dwordx4 v46, s[44:47], s69 offen offset:2048 lds
    v_mfma_f32_16x16x32_bf16 v[112:115], v[20:23], v[60:63], v[112:115]
    s_add_u32 m0, s81, 61440
    s_add_u32 s69, s69, 384
    s_add_u32 s64, s64, 1
    s_cmp_eq_u32 s64, 20
    s_cselect_b32 s64, 0, s64
    buffer_load_dwordx4 v44, s[44:47], s69 offen offset:0 lds
    v_mfma_f32_16x16x32_bf16 v[140:143], v[24:27], v[60:63], v[140:143]
    buffer_load_dwordx4 v45, s[44:47], s69 offen offset:1024 lds
    v_mfma_f32_16x16x32_bf16 v[168:171], v[28:31], v[60:63], v[168:171]
    buffer_load_dwordx4 v46, s[44:47], s69 offen offset:2048 lds
    ds_read_b128 v[72:75], v19 offset:53248
    s_waitcnt lgkmcnt(4)
    v_mfma_f32_16x16x32_bf16 v[88:91], v[32:35], v[64:67], v[88:91]
    s_add_u32 m0, s78, 131072
    s_add_u32 s73, s70, s89
    s_add_u32 s70, s70, 128
    s_cmp_eq_u32 s70, 1280
    s_cselect_b32 s70, 0, s70
    buffer_load_dwordx4 v56, s[48:51], s73 offen offset:0 lds
    v_mfma_f32_16x16x32_bf16 v[116:119], v[36:39], v[64:67], v[116:119]
    buffer_load_dwordx4 v57, s[48:51], s73 offen offset:1024 lds
    s_waitcnt lgkmcnt(1)
    v_mfma_f32_16x16x32_bf16 v[144:147], v[40:43], v[64:67], v[144:147]
    buffer_load_dwordx4 v58, s[48:51], s73 offen offset:2048 lds
    ds_read_b128 v[60:63], v19 offset:55296
    v_mfma_f32_16x16x32_bf16 v[92:95], v[32:35], v[68:71], v[92:95]
    buffer_load_dwordx4 v59, s[48:51], s73 offen offset:3072 lds
    v_mfma_f32_16x16x32_bf16 v[120:123], v[36:39], v[68:71], v[120:123]
    v_mfma_f32_16x16x32_bf16 v[148:151], v[40:43], v[68:71], v[148:151]
    ds_read_b128 v[64:67], v19 offset:57344
    s_waitcnt lgkmcnt(1)
    v_mfma_f32_16x16x32_bf16 v[96:99], v[32:35], v[72:75], v[96:99]
    v_mfma_f32_16x16x32_bf16 v[124:127], v[36:39], v[72:75], v[124:127]
    v_mfma_f32_16x16x32_bf16 v[152:155], v[40:43], v[72:75], v[152:155]
    ds_read_b128 v[68:71], v19 offset:59392
    v_mfma_f32_16x16x32_bf16 v[100:103], v[32:35], v[60:63], v[100:103]
    v_mfma_f32_16x16x32_bf16 v[128:131], v[36:39], v[60:63], v[128:131]
    v_mfma_f32_16x16x32_bf16 v[156:159], v[40:43], v[60:63], v[156:159]
    ds_read_b128 v[72:75], v19 offset:61440
    s_waitcnt lgkmcnt(2)
    v_mfma_f32_16x16x32_bf16 v[104:107], v[32:35], v[64:67], v[104:107]
    v_mfma_f32_16x16x32_bf16 v[132:135], v[36:39], v[64:67], v[132:135]
    v_mfma_f32_16x16x32_bf16 v[160:163], v[40:43], v[64:67], v[160:163]
    s_waitcnt vmcnt(20) lgkmcnt(0)
    s_barrier
    v_mfma_f32_16x16x32_bf16 v[108:111], v[32:35], v[68:71], v[108:111]
    ds_read_b64_tr_b16 v[20:21], v12 offset:0
    ds_read_b64_tr_b16 v[22:23], v12 offset:1536
    ds_read_b128 v[60:63], v18 offset:0
    s_add_u32 m0, s81, 73728
    s_mul_i32 s69, s64, 0x60000
    s_add_u32 s69, s69, s65
    buffer_load_dwordx4 v44, s[44:47], s69 offen offset:0 lds
    v_mfma_f32_16x16x32_bf16 v[136:139], v[36:39], v[68:71], v[136:139]
    ds_read_b64_tr_b16 v[24:25], v13 offset:0
    ds_read_b64_tr_b16 v[26:27], v13 offset:1536
    ds_read_b64_tr_b16 v[28:29], v14 offset:0
    buffer_load_dwordx4 v45, s[44:47], s69 offen offset:1024 lds
    v_mfma_f32_16x16x32_bf16 v[164:167], v[40:43], v[68:71], v[164:167]
    ds_read_b64_tr_b16 v[30:31], v14 offset:1536
    ds_read_b128 v[64:67], v18 offset:2048
    buffer_load_dwordx4 v46, s[44:47], s69 offen offset:2048 lds
    v_mfma_f32_16x16x32_bf16 v[112:115], v[32:35], v[72:75], v[112:115]
    s_add_u32 m0, s81, 86016
    s_add_u32 s69, s69, 384
    s_add_u32 s64, s64, 1
    s_cmp_eq_u32 s64, 20
    s_cselect_b32 s64, 0, s64
    buffer_load_dwordx4 v44, s[44:47], s69 offen offset:0 lds
    v_mfma_f32_16x16x32_bf16 v[140:143], v[36:39], v[72:75], v[140:143]
    buffer_load_dwordx4 v45, s[44:47], s69 offen offset:1024 lds
    v_mfma_f32_16x16x32_bf16 v[168:171], v[40:43], v[72:75], v[168:171]
    buffer_load_dwordx4 v46, s[44:47], s69 offen offset:2048 lds
    ds_read_b128 v[68:71], v18 offset:4096
    s_waitcnt lgkmcnt(4)
    v_mfma_f32_16x16x32_bf16 v[88:91], v[20:23], v[60:63], v[88:91]
    v_mfma_f32_16x16x32_bf16 v[116:119], v[24:27], v[60:63], v[116:119]
    s_waitcnt lgkmcnt(1)
    v_mfma_f32_16x16x32_bf16 v[144:147], v[28:31], v[60:63], v[144:147]
    ds_read_b128 v[72:75], v18 offset:6144
    v_mfma_f32_16x16x32_bf16 v[92:95], v[20:23], v[64:67], v[92:95]
    v_mfma_f32_16x16x32_bf16 v[120:123], v[24:27], v[64:67], v[120:123]
    v_mfma_f32_16x16x32_bf16 v[148:151], v[28:31], v[64:67], v[148:151]
    ds_read_b128 v[60:63], v18 offset:8192
    s_waitcnt lgkmcnt(1)
    v_mfma_f32_16x16x32_bf16 v[96:99], v[20:23], v[68:71], v[96:99]
    v_mfma_f32_16x16x32_bf16 v[124:127], v[24:27], v[68:71], v[124:127]
    v_mfma_f32_16x16x32_bf16 v[152:155], v[28:31], v[68:71], v[152:155]
    ds_read_b128 v[64:67], v18 offset:10240
    v_mfma_f32_16x16x32_bf16 v[100:103], v[20:23], v[72:75], v[100:103]
    v_mfma_f32_16x16x32_bf16 v[128:131], v[24:27], v[72:75], v[128:131]
    v_mfma_f32_16x16x32_bf16 v[156:159], v[28:31], v[72:75], v[156:159]
    ds_read_b128 v[68:71], v18 offset:12288
    s_waitcnt lgkmcnt(2)
    v_mfma_f32_16x16x32_bf16 v[104:107], v[20:23], v[60:63], v[104:107]
    v_mfma_f32_16x16x32_bf16 v[132:135], v[24:27], v[60:63], v[132:135]
    v_mfma_f32_16x16x32_bf16 v[160:163], v[28:31], v[60:63], v[160:163]
    s_waitcnt vmcnt(20) lgkmcnt(0)
    s_barrier
    v_mfma_f32_16x16x32_bf16 v[108:111], v[20:23], v[64:67], v[108:111]
    ds_read_b64_tr_b16 v[32:33], v12 offset:24576
    ds_read_b64_tr_b16 v[34:35], v12 offset:26112
    ds_read_b128 v[72:75], v19 offset:0
    s_add_u32 m0, s81, 0
    s_mul_i32 s69, s64, 0x60000
    s_add_u32 s69, s69, s65
    buffer_load_dwordx4 v44, s[44:47], s69 offen offset:0 lds
    v_mfma_f32_16x16x32_bf16 v[136:139], v[24:27], v[64:67], v[136:139]
    ds_read_b64_tr_b16 v[36:37], v13 offset:24576
    ds_read_b64_tr_b16 v[38:39], v13 offset:26112
    ds_read_b64_tr_b16 v[40:41], v14 offset:24576
    buffer_load_dwordx4 v45, s[44:47], s69 offen offset:1024 lds
    v_mfma_f32_16x16x32_bf16 v[164:167], v[28:31], v[64:67], v[164:167]
    ds_read_b64_tr_b16 v[42:43], v14 offset:26112
    ds_read_b128 v[60:63], v19 offset:2048
    buffer_load_dwordx4 v46, s[44:47], s69 offen offset:2048 lds
    v_mfma_f32_16x16x32_bf16 v[112:115], v[20:23], v[68:71], v[112:115]
    s_add_u32 m0, s81, 12288
    s_add_u32 s69, s69, 384
    s_add_u32 s64, s64, 1
    s_cmp_eq_u32 s64, 20
    s_cselect_b32 s64, 0, s64
    buffer_load_dwordx4 v44, s[44:47], s69 offen offset:0 lds
    v_mfma_f32_16x16x32_bf16 v[140:143], v[24:27], v[68:71], v[140:143]
    buffer_load_dwordx4 v45, s[44:47], s69 offen offset:1024 lds
    v_mfma_f32_16x16x32_bf16 v[168:171], v[28:31], v[68:71], v[168:171]
    buffer_load_dwordx4 v46, s[44:47], s69 offen offset:2048 lds
    ds_read_b128 v[64:67], v19 offset:4096
    s_waitcnt lgkmcnt(4)
    v_mfma_f32_16x16x32_bf16 v[88:91], v[32:35], v[72:75], v[88:91]
    s_add_u32 m0, s78, 147456
    s_add_u32 s73, s70, s89
    s_add_u32 s70, s70, 128
    s_cmp_eq_u32 s70, 1280
    s_cselect_b32 s70, 0, s70
    buffer_load_dwordx4 v56, s[48:51], s73 offen offset:0 lds
    v_mfma_f32_16x16x32_bf16 v[116:119], v[36:39], v[72:75], v[116:119]
    buffer_load_dwordx4 v57, s[48:51], s73 offen offset:1024 lds
    s_waitcnt lgkmcnt(1)
    v_mfma_f32_16x16x32_bf16 v[144:147], v[40:43], v[72:75], v[144:147]
    buffer_load_dwordx4 v58, s[48:51], s73 offen offset:2048 lds
    ds_read_b128 v[68:71], v19 offset:6144
    v_mfma_f32_16x16x32_bf16 v[92:95], v[32:35], v[60:63], v[92:95]
    buffer_load_dwordx4 v59, s[48:51], s73 offen offset:3072 lds
    v_mfma_f32_16x16x32_bf16 v[120:123], v[36:39], v[60:63], v[120:123]
    v_mfma_f32_16x16x32_bf16 v[148:151], v[40:43], v[60:63], v[148:151]
    ds_read_b128 v[72:75], v19 offset:8192
    s_waitcnt lgkmcnt(1)
    v_mfma_f32_16x16x32_bf16 v[96:99], v[32:35], v[64:67], v[96:99]
    v_mfma_f32_16x16x32_bf16 v[124:127], v[36:39], v[64:67], v[124:127]
    v_mfma_f32_16x16x32_bf16 v[152:155], v[40:43], v[64:67], v[152:155]
    ds_read_b128 v[60:63], v19 offset:10240
    v_mfma_f32_16x16x32_bf16 v[100:103], v[32:35], v[68:71], v[100:103]
    v_mfma_f32_16x16x32_bf16 v[128:131], v[36:39], v[68:71], v[128:131]
    v_mfma_f32_16x16x32_bf16 v[156:159], v[40:43], v[68:71], v[156:159]
    ds_read_b128 v[64:67], v19 offset:12288
    s_waitcnt lgkmcnt(2)
    v_mfma_f32_16x16x32_bf16 v[104:107], v[32:35], v[72:75], v[104:107]
    v_mfma_f32_16x16x32_bf16 v[132:135], v[36:39], v[72:75], v[132:135]
    v_mfma_f32_16x16x32_bf16 v[160:163], v[40:43], v[72:75], v[160:163]
    s_waitcnt vmcnt(20) lgkmcnt(0)
    s_barrier
    v_mfma_f32_16x16x32_bf16 v[108:111], v[32:35], v[60:63], v[108:111]
    ds_read_b64_tr_b16 v[20:21], v15 offset:0
    ds_read_b64_tr_b16 v[22:23], v15 offset:1536
    ds_read_b128 v[68:71], v18 offset:16384
    s_add_u32 m0, s81, 24576
    s_mul_i32 s69, s64, 0x60000
    s_add_u32 s69, s69, s65
    buffer_load_dwordx4 v44, s[44:47], s69 offen offset:0 lds
    v_mfma_f32_16x16x32_bf16 v[136:139], v[36:39], v[60:63], v[136:139]
    ds_read_b64_tr_b16 v[24:25], v16 offset:0
    ds_read_b64_tr_b16 v[26:27], v16 offset:1536
    ds_read_b64_tr_b16 v[28:29], v17 offset:0
    buffer_load_dwordx4 v45, s[44:47], s69 offen offset:1024 lds
    v_mfma_f32_16x16x32_bf16 v[164:167], v[40:43], v[60:63], v[164:167]
    ds_read_b64_tr_b16 v[30:31], v17 offset:1536
    ds_read_b128 v[72:75], v18 offset:18432
    buffer_load_dwordx4 v46, s[44:47], s69 offen offset:2048 lds
    v_mfma_f32_16x16x32_bf16 v[112:115], v[32:35], v[64:67], v[112:115]
    s_add_u32 m0, s81, 36864
    s_add_u32 s69, s69, 384
    s_add_u32 s64, s64, 1
    s_cmp_eq_u32 s64, 20
    s_cselect_b32 s64, 0, s64
    buffer_load_dwordx4 v44, s[44:47], s69 offen offset:0 lds
    v_mfma_f32_16x16x32_bf16 v[140:143], v[36:39], v[64:67], v[140:143]
    buffer_load_dwordx4 v45, s[44:47], s69 offen offset:1024 lds
    v_mfma_f32_16x16x32_bf16 v[168:171], v[40:43], v[64:67], v[168:171]
    buffer_load_dwordx4 v46, s[44:47], s69 offen offset:2048 lds
    ds_read_b128 v[60:63], v18 offset:20480
    s_waitcnt lgkmcnt(4)
    v_mfma_f32_16x16x32_bf16 v[88:91], v[20:23], v[68:71], v[88:91]
    v_mfma_f32_16x16x32_bf16 v[116:119], v[24:27], v[68:71], v[116:119]
    s_waitcnt lgkmcnt(1)
    v_mfma_f32_16x16x32_bf16 v[144:147], v[28:31], v[68:71], v[144:147]
    ds_read_b128 v[64:67], v18 offset:22528
    v_mfma_f32_16x16x32_bf16 v[92:95], v[20:23], v[72:75], v[92:95]
    v_mfma_f32_16x16x32_bf16 v[120:123], v[24:27], v[72:75], v[120:123]
    v_mfma_f32_16x16x32_bf16 v[148:151], v[28:31], v[72:75], v[148:151]
    ds_read_b128 v[68:71], v18 offset:24576
    s_waitcnt lgkmcnt(1)
    v_mfma_f32_16x16x32_bf16 v[96:99], v[20:23], v[60:63], v[96:99]
    v_mfma_f32_16x16x32_bf16 v[124:127], v[24:27], v[60:63], v[124:127]
    v_mfma_f32_16x16x32_bf16 v[152:155], v[28:31], v[60:63], v[152:155]
    ds_read_b128 v[72:75], v18 offset:26624
    v_mfma_f32_16x16x32_bf16 v[100:103], v[20:23], v[64:67], v[100:103]
    v_mfma_f32_16x16x32_bf16 v[128:131], v[24:27], v[64:67], v[128:131]
    v_mfma_f32_16x16x32_bf16 v[156:159], v[28:31], v[64:67], v[156:159]
    ds_read_b128 v[60:63], v18 offset:28672
    s_waitcnt lgkmcnt(2)
    v_mfma_f32_16x16x32_bf16 v[104:107], v[20:23], v[68:71], v[104:107]
    v_mfma_f32_16x16x32_bf16 v[132:135], v[24:27], v[68:71], v[132:135]
    v_mfma_f32_16x16x32_bf16 v[160:163], v[28:31], v[68:71], v[160:163]
    s_waitcnt vmcnt(16) lgkmcnt(0)
    s_barrier
    v_mfma_f32_16x16x32_bf16 v[108:111], v[20:23], v[72:75], v[108:111]
    ds_read_b64_tr_b16 v[32:33], v15 offset:24576
    ds_read_b64_tr_b16 v[34:35], v15 offset:26112
    ds_read_b128 v[64:67], v19 offset:16384
    s_add_u32 m0, s81, 49152
    s_mul_i32 s69, s64, 0x60000
    s_add_u32 s69, s69, s65
    buffer_load_dwordx4 v44, s[44:47], s69 offen offset:0 lds
    v_mfma_f32_16x16x32_bf16 v[136:139], v[24:27], v[72:75], v[136:139]
    ds_read_b64_tr_b16 v[36:37], v16 offset:24576
    ds_read_b64_tr_b16 v[38:39], v16 offset:26112
    ds_read_b64_tr_b16 v[40:41], v17 offset:24576
    buffer_load_dwordx4 v45, s[44:47], s69 offen offset:1024 lds
    v_mfma_f32_16x16x32_bf16 v[164:167], v[28:31], v[72:75], v[164:167]
    ds_read_b64_tr_b16 v[42:43], v17 offset:26112
    ds_read_b128 v[68:71], v19 offset:18432
    buffer_load_dwordx4 v46, s[44:47], s69 offen offset:2048 lds
    v_mfma_f32_16x16x32_bf16 v[112:115], v[20:23], v[60:63], v[112:115]
    s_add_u32 m0, s81, 61440
    s_add_u32 s69, s69, 384
    s_add_u32 s64, s64, 1
    s_cmp_eq_u32 s64, 20
    s_cselect_b32 s64, 0, s64
    buffer_load_dwordx4 v44, s[44:47], s69 offen offset:0 lds
    v_mfma_f32_16x16x32_bf16 v[140:143], v[24:27], v[60:63], v[140:143]
    buffer_load_dwordx4 v45, s[44:47], s69 offen offset:1024 lds
    v_mfma_f32_16x16x32_bf16 v[168:171], v[28:31], v[60:63], v[168:171]
    buffer_load_dwordx4 v46, s[44:47], s69 offen offset:2048 lds
    ds_read_b128 v[72:75], v19 offset:20480
    s_waitcnt lgkmcnt(4)
    v_mfma_f32_16x16x32_bf16 v[88:91], v[32:35], v[64:67], v[88:91]
    s_add_u32 m0, s78, 98304
    s_add_u32 s73, s70, s89
    s_add_u32 s70, s70, 128
    s_cmp_eq_u32 s70, 1280
    s_cselect_b32 s70, 0, s70
    buffer_load_dwordx4 v56, s[48:51], s73 offen offset:0 lds
    v_mfma_f32_16x16x32_bf16 v[116:119], v[36:39], v[64:67], v[116:119]
    buffer_load_dwordx4 v57, s[48:51], s73 offen offset:1024 lds
    s_waitcnt lgkmcnt(1)
    v_mfma_f32_16x16x32_bf16 v[144:147], v[40:43], v[64:67], v[144:147]
    buffer_load_dwordx4 v58, s[48:51], s73 offen offset:2048 lds
    ds_read_b128 v[60:63], v19 offset:22528
    v_mfma_f32_16x16x32_bf16 v[92:95], v[32:35], v[68:71], v[92:95]
    buffer_load_dwordx4 v59, s[48:51], s73 offen offset:3072 lds
    v_mfma_f32_16x16x32_bf16 v[120:123], v[36:39], v[68:71], v[120:123]
    v_mfma_f32_16x16x32_bf16 v[148:151], v[40:43], v[68:71], v[148:151]
    ds_read_b128 v[64:67], v19 offset:24576
    s_waitcnt lgkmcnt(1)
    v_mfma_f32_16x16x32_bf16 v[96:99], v[32:35], v[72:75], v[96:99]
    v_mfma_f32_16x16x32_bf16 v[124:127], v[36:39], v[72:75], v[124:127]
    v_mfma_f32_16x16x32_bf16 v[152:155], v[40:43], v[72:75], v[152:155]
    ds_read_b128 v[68:71], v19 offset:26624
    v_mfma_f32_16x16x32_bf16 v[100:103], v[32:35], v[60:63], v[100:103]
    v_mfma_f32_16x16x32_bf16 v[128:131], v[36:39], v[60:63], v[128:131]
    v_mfma_f32_16x16x32_bf16 v[156:159], v[40:43], v[60:63], v[156:159]
    ds_read_b128 v[72:75], v19 offset:28672
    s_waitcnt lgkmcnt(2)
    v_mfma_f32_16x16x32_bf16 v[104:107], v[32:35], v[64:67], v[104:107]
    v_mfma_f32_16x16x32_bf16 v[132:135], v[36:39], v[64:67], v[132:135]
    v_mfma_f32_16x16x32_bf16 v[160:163], v[40:43], v[64:67], v[160:163]
    s_waitcnt vmcnt(20) lgkmcnt(0)
    s_barrier
    v_mfma_f32_16x16x32_bf16 v[108:111], v[32:35], v[68:71], v[108:111]
    ds_read_b64_tr_b16 v[20:21], v12 offset:0
    ds_read_b64_tr_b16 v[22:23], v12 offset:1536
    ds_read_b128 v[60:63], v18 offset:32768
    s_add_u32 m0, s81, 73728
    s_mul_i32 s69, s64, 0x60000
    s_add_u32 s69, s69, s65
    buffer_load_dwordx4 v44, s[44:47], s69 offen offset:0 lds
    v_mfma_f32_16x16x32_bf16 v[136:139], v[36:39], v[68:71], v[136:139]
    ds_read_b64_tr_b16 v[24:25], v13 offset:0
    ds_read_b64_tr_b16 v[26:27], v13 offset:1536
    ds_read_b64_tr_b16 v[28:29], v14 offset:0
    buffer_load_dwordx4 v45, s[44:47], s69 offen offset:1024 lds
    v_mfma_f32_16x16x32_bf16 v[164:167], v[40:43], v[68:71], v[164:167]
    ds_read_b64_tr_b16 v[30:31], v14 offset:1536
    ds_read_b128 v[64:67], v18 offset:34816
    buffer_load_dwordx4 v46, s[44:47], s69 offen offset:2048 lds
    v_mfma_f32_16x16x32_bf16 v[112:115], v[32:35], v[72:75], v[112:115]
    s_add_u32 m0, s81, 86016
    s_add_u32 s69, s69, 384
    s_add_u32 s64, s64, 1
    s_cmp_eq_u32 s64, 20
    s_cselect_b32 s64, 0, s64
    buffer_load_dwordx4 v44, s[44:47], s69 offen offset:0 lds
    v_mfma_f32_16x16x32_bf16 v[140:143], v[36:39], v[72:75], v[140:143]
    buffer_load_dwordx4 v45, s[44:47], s69 offen offset:1024 lds
    v_mfma_f32_16x16x32_bf16 v[168:171], v[40:43], v[72:75], v[168:171]
    buffer_load_dwordx4 v46, s[44:47], s69 offen offset:2048 lds
    ds_read_b128 v[68:71], v18 offset:36864
    s_waitcnt lgkmcnt(4)
    v_mfma_f32_16x16x32_bf16 v[88:91], v[20:23], v[60:63], v[88:91]
    v_mfma_f32_16x16x32_bf16 v[116:119], v[24:27], v[60:63], v[116:119]
    s_waitcnt lgkmcnt(1)
    v_mfma_f32_16x16x32_bf16 v[144:147], v[28:31], v[60:63], v[144:147]
    ds_read_b128 v[72:75], v18 offset:38912
    v_mfma_f32_16x16x32_bf16 v[92:95], v[20:23], v[64:67], v[92:95]
    v_mfma_f32_16x16x32_bf16 v[120:123], v[24:27], v[64:67], v[120:123]
    v_mfma_f32_16x16x32_bf16 v[148:151], v[28:31], v[64:67], v[148:151]
    ds_read_b128 v[60:63], v18 offset:40960
    s_waitcnt lgkmcnt(1)
    v_mfma_f32_16x16x32_bf16 v[96:99], v[20:23], v[68:71], v[96:99]
    v_mfma_f32_16x16x32_bf16 v[124:127], v[24:27], v[68:71], v[124:127]
    v_mfma_f32_16x16x32_bf16 v[152:155], v[28:31], v[68:71], v[152:155]
    ds_read_b128 v[64:67], v18 offset:43008
    v_mfma_f32_16x16x32_bf16 v[100:103], v[20:23], v[72:75], v[100:103]
    v_mfma_f32_16x16x32_bf16 v[128:131], v[24:27], v[72:75], v[128:131]
    v_mfma_f32_16x16x32_bf16 v[156:159], v[28:31], v[72:75], v[156:159]
    ds_read_b128 v[68:71], v18 offset:45056
    s_waitcnt lgkmcnt(2)
    v_mfma_f32_16x16x32_bf16 v[104:107], v[20:23], v[60:63], v[104:107]
    v_mfma_f32_16x16x32_bf16 v[132:135], v[24:27], v[60:63], v[132:135]
    v_mfma_f32_16x16x32_bf16 v[160:163], v[28:31], v[60:63], v[160:163]
    s_waitcnt vmcnt(16) lgkmcnt(0)
    s_barrier
    v_mfma_f32_16x16x32_bf16 v[108:111], v[20:23], v[64:67], v[108:111]
    ds_read_b64_tr_b16 v[32:33], v12 offset:24576
    ds_read_b64_tr_b16 v[34:35], v12 offset:26112
    ds_read_b128 v[72:75], v19 offset:32768
    s_add_u32 m0, s81, 0
    s_mul_i32 s69, s64, 0x60000
    s_add_u32 s69, s69, s65
    buffer_load_dwordx4 v44, s[44:47], s69 offen offset:0 lds
    v_mfma_f32_16x16x32_bf16 v[136:139], v[24:27], v[64:67], v[136:139]
    ds_read_b64_tr_b16 v[36:37], v13 offset:24576
    ds_read_b64_tr_b16 v[38:39], v13 offset:26112
    ds_read_b64_tr_b16 v[40:41], v14 offset:24576
    buffer_load_dwordx4 v45, s[44:47], s69 offen offset:1024 lds
    v_mfma_f32_16x16x32_bf16 v[164:167], v[28:31], v[64:67], v[164:167]
    ds_read_b64_tr_b16 v[42:43], v14 offset:26112
    ds_read_b128 v[60:63], v19 offset:34816
    buffer_load_dwordx4 v46, s[44:47], s69 offen offset:2048 lds
    v_mfma_f32_16x16x32_bf16 v[112:115], v[20:23], v[68:71], v[112:115]
    s_add_u32 m0, s81, 12288
    s_add_u32 s69, s69, 384
    s_add_u32 s64, s64, 1
    s_cmp_eq_u32 s64, 20
    s_cselect_b32 s64, 0, s64
    buffer_load_dwordx4 v44, s[44:47], s69 offen offset:0 lds
    v_mfma_f32_16x16x32_bf16 v[140:143], v[24:27], v[68:71], v[140:143]
    buffer_load_dwordx4 v45, s[44:47], s69 offen offset:1024 lds
    v_mfma_f32_16x16x32_bf16 v[168:171], v[28:31], v[68:71], v[168:171]
    buffer_load_dwordx4 v46, s[44:47], s69 offen offset:2048 lds
    ds_read_b128 v[64:67], v19 offset:36864
    s_waitcnt lgkmcnt(4)
    v_mfma_f32_16x16x32_bf16 v[88:91], v[32:35], v[72:75], v[88:91]
    s_add_u32 m0, s78, 114688
    s_add_u32 s73, s70, s89
    s_add_u32 s70, s70, 128
    s_cmp_eq_u32 s70, 1280
    s_cselect_b32 s70, 0, s70
    buffer_load_dwordx4 v56, s[48:51], s73 offen offset:0 lds
    v_mfma_f32_16x16x32_bf16 v[116:119], v[36:39], v[72:75], v[116:119]
    buffer_load_dwordx4 v57, s[48:51], s73 offen offset:1024 lds
    s_waitcnt lgkmcnt(1)
    v_mfma_f32_16x16x32_bf16 v[144:147], v[40:43], v[72:75], v[144:147]
    buffer_load_dwordx4 v58, s[48:51], s73 offen offset:2048 lds
    ds_read_b128 v[68:71], v19 offset:38912
    v_mfma_f32_16x16x32_bf16 v[92:95], v[32:35], v[60:63], v[92:95]
    buffer_load_dwordx4 v59, s[48:51], s73 offen offset:3072 lds
    v_mfma_f32_16x16x32_bf16 v[120:123], v[36:39], v[60:63], v[120:123]
    v_mfma_f32_16x16x32_bf16 v[148:151], v[40:43], v[60:63], v[148:151]
    ds_read_b128 v[72:75], v19 offset:40960
    s_waitcnt lgkmcnt(1)
    v_mfma_f32_16x16x32_bf16 v[96:99], v[32:35], v[64:67], v[96:99]
    v_mfma_f32_16x16x32_bf16 v[124:127], v[36:39], v[64:67], v[124:127]
    v_mfma_f32_16x16x32_bf16 v[152:155], v[40:43], v[64:67], v[152:155]
    ds_read_b128 v[60:63], v19 offset:43008
    v_mfma_f32_16x16x32_bf16 v[100:103], v[32:35], v[68:71], v[100:103]
    v_mfma_f32_16x16x32_bf16 v[128:131], v[36:39], v[68:71], v[128:131]
    v_mfma_f32_16x16x32_bf16 v[156:159], v[40:43], v[68:71], v[156:159]
    ds_read_b128 v[64:67], v19 offset:45056
    s_waitcnt lgkmcnt(2)
    v_mfma_f32_16x16x32_bf16 v[104:107], v[32:35], v[72:75], v[104:107]
    v_mfma_f32_16x16x32_bf16 v[132:135], v[36:39], v[72:75], v[132:135]
    v_mfma_f32_16x16x32_bf16 v[160:163], v[40:43], v[72:75], v[160:163]
    s_waitcnt vmcnt(20) lgkmcnt(0)
    s_barrier
    v_mfma_f32_16x16x32_bf16 v[108:111], v[32:35], v[60:63], v[108:111]
    ds_read_b64_tr_b16 v[20:21], v15 offset:0
    ds_read_b64_tr_b16 v[22:23], v15 offset:1536
    ds_read_b128 v[68:71], v18 offset:49152
    s_add_u32 m0, s81, 24576
    s_mul_i32 s69, s64, 0x60000
    s_add_u32 s69, s69, s65
    buffer_load_dwordx4 v44, s[44:47], s69 offen offset:0 lds
    v_mfma_f32_16x16x32_bf16 v[136:139], v[36:39], v[60:63], v[136:139]
    ds_read_b64_tr_b16 v[24:25], v16 offset:0
    ds_read_b64_tr_b16 v[26:27], v16 offset:1536
    ds_read_b64_tr_b16 v[28:29], v17 offset:0
    buffer_load_dwordx4 v45, s[44:47], s69 offen offset:1024 lds
    v_mfma_f32_16x16x32_bf16 v[164:167], v[40:43], v[60:63], v[164:167]
    ds_read_b64_tr_b16 v[30:31], v17 offset:1536
    ds_read_b128 v[72:75], v18 offset:51200
    buffer_load_dwordx4 v46, s[44:47], s69 offen offset:2048 lds
    v_mfma_f32_16x16x32_bf16 v[112:115], v[32:35], v[64:67], v[112:115]
    s_add_u32 m0, s81, 36864
    s_add_u32 s69, s69, 384
    s_add_u32 s64, s64, 1
    s_cmp_eq_u32 s64, 20
    s_cselect_b32 s64, 0, s64
    buffer_load_dwordx4 v44, s[44:47], s69 offen offset:0 lds
    v_mfma_f32_16x16x32_bf16 v[140:143], v[36:39], v[64:67], v[140:143]
    buffer_load_dwordx4 v45, s[44:47], s69 offen offset:1024 lds
    v_mfma_f32_16x16x32_bf16 v[168:171], v[40:43], v[64:67], v[168:171]
    buffer_load_dwordx4 v46, s[44:47], s69 offen offset:2048 lds
    ds_read_b128 v[60:63], v18 offset:53248
    s_waitcnt lgkmcnt(4)
    v_mfma_f32_16x16x32_bf16 v[88:91], v[20:23], v[68:71], v[88:91]
    v_mfma_f32_16x16x32_bf16 v[116:119], v[24:27], v[68:71], v[116:119]
    s_waitcnt lgkmcnt(1)
    v_mfma_f32_16x16x32_bf16 v[144:147], v[28:31], v[68:71], v[144:147]
    ds_read_b128 v[64:67], v18 offset:55296
    v_mfma_f32_16x16x32_bf16 v[92:95], v[20:23], v[72:75], v[92:95]
    v_mfma_f32_16x16x32_bf16 v[120:123], v[24:27], v[72:75], v[120:123]
    v_mfma_f32_16x16x32_bf16 v[148:151], v[28:31], v[72:75], v[148:151]
    ds_read_b128 v[68:71], v18 offset:57344
    s_waitcnt lgkmcnt(1)
    v_mfma_f32_16x16x32_bf16 v[96:99], v[20:23], v[60:63], v[96:99]
    v_mfma_f32_16x16x32_bf16 v[124:127], v[24:27], v[60:63], v[124:127]
    v_mfma_f32_16x16x32_bf16 v[152:155], v[28:31], v[60:63], v[152:155]
    ds_read_b128 v[72:75], v18 offset:59392
    v_mfma_f32_16x16x32_bf16 v[100:103], v[20:23], v[64:67], v[100:103]
    v_mfma_f32_16x16x32_bf16 v[128:131], v[24:27], v[64:67], v[128:131]
    v_mfma_f32_16x16x32_bf16 v[156:159], v[28:31], v[64:67], v[156:159]
    ds_read_b128 v[60:63], v18 offset:61440
    s_waitcnt lgkmcnt(2)
    v_mfma_f32_16x16x32_bf16 v[104:107], v[20:23], v[68:71], v[104:107]
    v_mfma_f32_16x16x32_bf16 v[132:135], v[24:27], v[68:71], v[132:135]
    v_mfma_f32_16x16x32_bf16 v[160:163], v[28:31], v[68:71], v[160:163]
    s_waitcnt vmcnt(16) lgkmcnt(0)
    s_barrier
    v_mfma_f32_16x16x32_bf16 v[108:111], v[20:23], v[72:75], v[108:111]
    ds_read_b64_tr_b16 v[32:33], v15 offset:24576
    ds_read_b64_tr_b16 v[34:35], v15 offset:26112
    ds_read_b128 v[64:67], v19 offset:49152
    s_add_u32 m0, s81, 49152
    s_mul_i32 s69, s64, 0x60000
    s_add_u32 s69, s69, s65
    buffer_load_dwordx4 v44, s[44:47], s69 offen offset:0 lds
    v_mfma_f32_16x16x32_bf16 v[136:139], v[24:27], v[72:75], v[136:139]
    ds_read_b64_tr_b16 v[36:37], v16 offset:24576
    ds_read_b64_tr_b16 v[38:39], v16 offset:26112
    ds_read_b64_tr_b16 v[40:41], v17 offset:24576
    buffer_load_dwordx4 v45, s[44:47], s69 offen offset:1024 lds
    v_mfma_f32_16x16x32_bf16 v[164:167], v[28:31], v[72:75], v[164:167]
    ds_read_b64_tr_b16 v[42:43], v17 offset:26112
    ds_read_b128 v[68:71], v19 offset:51200
    buffer_load_dwordx4 v46, s[44:47], s69 offen offset:2048 lds
    v_mfma_f32_16x16x32_bf16 v[112:115], v[20:23], v[60:63], v[112:115]
    s_add_u32 m0, s81, 61440
    s_add_u32 s69, s69, 384
    s_add_u32 s64, s64, 1
    s_cmp_eq_u32 s64, 20
    s_cselect_b32 s64, 0, s64
    buffer_load_dwordx4 v44, s[44:47], s69 offen offset:0 lds
    v_mfma_f32_16x16x32_bf16 v[140:143], v[24:27], v[60:63], v[140:143]
    buffer_load_dwordx4 v45, s[44:47], s69 offen offset:1024 lds
    v_mfma_f32_16x16x32_bf16 v[168:171], v[28:31], v[60:63], v[168:171]
    buffer_load_dwordx4 v46, s[44:47], s69 offen offset:2048 lds
    ds_read_b128 v[72:75], v19 offset:53248
    s_waitcnt lgkmcnt(4)
    v_mfma_f32_16x16x32_bf16 v[88:91], v[32:35], v[64:67], v[88:91]
    s_add_u32 m0, s78, 131072
    s_add_u32 s73, s70, s89
    s_add_u32 s70, s70, 128
    s_cmp_eq_u32 s70, 1280
    s_cselect_b32 s70, 0, s70
    buffer_load_dwordx4 v56, s[48:51], s73 offen offset:0 lds
    v_mfma_f32_16x16x32_bf16 v[116:119], v[36:39], v[64:67], v[116:119]
    buffer_load_dwordx4 v57, s[48:51], s73 offen offset:1024 lds
    s_waitcnt lgkmcnt(1)
    v_mfma_f32_16x16x32_bf16 v[144:147], v[40:43], v[64:67], v[144:147]
    buffer_load_dwordx4 v58, s[48:51], s73 offen offset:2048 lds
    ds_read_b128 v[60:63], v19 offset:55296
    v_mfma_f32_16x16x32_bf16 v[92:95], v[32:35], v[68:71], v[92:95]
    buffer_load_dwordx4 v59, s[48:51], s73 offen offset:3072 lds
    v_mfma_f32_16x16x32_bf16 v[120:123], v[36:39], v[68:71], v[120:123]
    v_mfma_f32_16x16x32_bf16 v[148:151], v[40:43], v[68:71], v[148:151]
    ds_read_b128 v[64:67], v19 offset:57344
    s_waitcnt lgkmcnt(1)
    v_mfma_f32_16x16x32_bf16 v[96:99], v[32:35], v[72:75], v[96:99]
    v_mfma_f32_16x16x32_bf16 v[124:127], v[36:39], v[72:75], v[124:127]
    v_mfma_f32_16x16x32_bf16 v[152:155], v[40:43], v[72:75], v[152:155]
    ds_read_b128 v[68:71], v19 offset:59392
    v_mfma_f32_16x16x32_bf16 v[100:103], v[32:35], v[60:63], v[100:103]
    v_mfma_f32_16x16x32_bf16 v[128:131], v[36:39], v[60:63], v[128:131]
    v_mfma_f32_16x16x32_bf16 v[156:159], v[40:43], v[60:63], v[156:159]
    ds_read_b128 v[72:75], v19 offset:61440
    s_waitcnt lgkmcnt(2)
    v_mfma_f32_16x16x32_bf16 v[104:107], v[32:35], v[64:67], v[104:107]
    v_mfma_f32_16x16x32_bf16 v[132:135], v[36:39], v[64:67], v[132:135]
    v_mfma_f32_16x16x32_bf16 v[160:163], v[40:43], v[64:67], v[160:163]
    s_waitcnt vmcnt(20) lgkmcnt(0)
    s_barrier
    v_mfma_f32_16x16x32_bf16 v[108:111], v[32:35], v[68:71], v[108:111]
    ds_read_b64_tr_b16 v[20:21], v12 offset:0
    ds_read_b64_tr_b16 v[22:23], v12 offset:1536
    ds_read_b128 v[60:63], v18 offset:0
    s_add_u32 m0, s81, 73728
    s_mul_i32 s69, s64, 0x60000
    s_add_u32 s69, s69, s65
    buffer_load_dwordx4 v44, s[44:47], s69 offen offset:0 lds
    v_mfma_f32_16x16x32_bf16 v[136:139], v[36:39], v[68:71], v[136:139]
    ds_read_b64_tr_b16 v[24:25], v13 offset:0
    ds_read_b64_tr_b16 v[26:27], v13 offset:1536
    ds_read_b64_tr_b16 v[28:29], v14 offset:0
    buffer_load_dwordx4 v45, s[44:47], s69 offen offset:1024 lds
    v_mfma_f32_16x16x32_bf16 v[164:167], v[40:43], v[68:71], v[164:167]
    ds_read_b64_tr_b16 v[30:31], v14 offset:1536
    ds_read_b128 v[64:67], v18 offset:2048
    buffer_load_dwordx4 v46, s[44:47], s69 offen offset:2048 lds
    v_mfma_f32_16x16x32_bf16 v[112:115], v[32:35], v[72:75], v[112:115]
    s_add_u32 m0, s81, 86016
    s_add_u32 s69, s69, 384
    s_add_u32 s64, s64, 1
    s_cmp_eq_u32 s64, 20
    s_cselect_b32 s64, 0, s64
    buffer_load_dwordx4 v44, s[44:47], s69 offen offset:0 lds
    v_mfma_f32_16x16x32_bf16 v[140:143], v[36:39], v[72:75], v[140:143]
    buffer_load_dwordx4 v45, s[44:47], s69 offen offset:1024 lds
    v_mfma_f32_16x16x32_bf16 v[168:171], v[40:43], v[72:75], v[168:171]
    buffer_load_dwordx4 v46, s[44:47], s69 offen offset:2048 lds
    ds_read_b128 v[68:71], v18 offset:4096
    s_waitcnt lgkmcnt(4)
    v_mfma_f32_16x16x32_bf16 v[88:91], v[20:23], v[60:63], v[88:91]
    v_mfma_f32_16x16x32_bf16 v[116:119], v[24:27], v[60:63], v[116:119]
    s_waitcnt lgkmcnt(1)
    v_mfma_f32_16x16x32_bf16 v[144:147], v[28:31], v[60:63], v[144:147]
    ds_read_b128 v[72:75], v18 offset:6144
    v_mfma_f32_16x16x32_bf16 v[92:95], v[20:23], v[64:67], v[92:95]
    v_mfma_f32_16x16x32_bf16 v[120:123], v[24:27], v[64:67], v[120:123]
    v_mfma_f32_16x16x32_bf16 v[148:151], v[28:31], v[64:67], v[148:151]
    ds_read_b128 v[60:63], v18 offset:8192
    s_waitcnt lgkmcnt(1)
    v_mfma_f32_16x16x32_bf16 v[96:99], v[20:23], v[68:71], v[96:99]
    v_mfma_f32_16x16x32_bf16 v[124:127], v[24:27], v[68:71], v[124:127]
    v_mfma_f32_16x16x32_bf16 v[152:155], v[28:31], v[68:71], v[152:155]
    ds_read_b128 v[64:67], v18 offset:10240
    v_mfma_f32_16x16x32_bf16 v[100:103], v[20:23], v[72:75], v[100:103]
    v_mfma_f32_16x16x32_bf16 v[128:131], v[24:27], v[72:75], v[128:131]
    v_mfma_f32_16x16x32_bf16 v[156:159], v[28:31], v[72:75], v[156:159]
    ds_read_b128 v[68:71], v18 offset:12288
    s_waitcnt lgkmcnt(2)
    v_mfma_f32_16x16x32_bf16 v[104:107], v[20:23], v[60:63], v[104:107]
    v_mfma_f32_16x16x32_bf16 v[132:135], v[24:27], v[60:63], v[132:135]
    v_mfma_f32_16x16x32_bf16 v[160:163], v[28:31], v[60:63], v[160:163]
    s_waitcnt vmcnt(16) lgkmcnt(0)
    s_barrier
    v_mfma_f32_16x16x32_bf16 v[108:111], v[20:23], v[64:67], v[108:111]
    ds_read_b64_tr_b16 v[32:33], v12 offset:24576
    ds_read_b64_tr_b16 v[34:35], v12 offset:26112
    ds_read_b128 v[72:75], v19 offset:0
    s_add_u32 m0, s81, 0
    s_mul_i32 s69, s64, 0x60000
    s_add_u32 s69, s69, s65
    buffer_load_dwordx4 v44, s[44:47], s69 offen offset:0 lds
    v_mfma_f32_16x16x32_bf16 v[136:139], v[24:27], v[64:67], v[136:139]
    ds_read_b64_tr_b16 v[36:37], v13 offset:24576
    ds_read_b64_tr_b16 v[38:39], v13 offset:26112
    ds_read_b64_tr_b16 v[40:41], v14 offset:24576
    buffer_load_dwordx4 v45, s[44:47], s69 offen offset:1024 lds
    v_mfma_f32_16x16x32_bf16 v[164:167], v[28:31], v[64:67], v[164:167]
    ds_read_b64_tr_b16 v[42:43], v14 offset:26112
    ds_read_b128 v[60:63], v19 offset:2048
    buffer_load_dwordx4 v46, s[44:47], s69 offen offset:2048 lds
    v_mfma_f32_16x16x32_bf16 v[112:115], v[20:23], v[68:71], v[112:115]
    s_add_u32 m0, s81, 12288
    s_add_u32 s69, s69, 384
    s_add_u32 s64, s64, 1
    s_cmp_eq_u32 s64, 20
    s_cselect_b32 s64, 0, s64
    buffer_load_dwordx4 v44, s[44:47], s69 offen offset:0 lds
    v_mfma_f32_16x16x32_bf16 v[140:143], v[24:27], v[68:71], v[140:143]
    buffer_load_dwordx4 v45, s[44:47], s69 offen offset:1024 lds
    v_mfma_f32_16x16x32_bf16 v[168:171], v[28:31], v[68:71], v[168:171]
    buffer_load_dwordx4 v46, s[44:47], s69 offen offset:2048 lds
    ds_read_b128 v[64:67], v19 offset:4096
    s_waitcnt lgkmcnt(4)
    v_mfma_f32_16x16x32_bf16 v[88:91], v[32:35], v[72:75], v[88:91]
    s_add_u32 m0, s78, 147456
    s_add_u32 s73, s70, s89
    s_add_u32 s70, s70, 128
    s_cmp_eq_u32 s70, 1280
    s_cselect_b32 s70, 0, s70
    buffer_load_dwordx4 v56, s[48:51], s73 offen offset:0 lds
    v_mfma_f32_16x16x32_bf16 v[116:119], v[36:39], v[72:75], v[116:119]
    buffer_load_dwordx4 v57, s[48:51], s73 offen offset:1024 lds
    s_waitcnt lgkmcnt(1)
    v_mfma_f32_16x16x32_bf16 v[144:147], v[40:43], v[72:75], v[144:147]
    buffer_load_dwordx4 v58, s[48:51], s73 offen offset:2048 lds
    ds_read_b128 v[68:71], v19 offset:6144
    v_mfma_f32_16x16x32_bf16 v[92:95], v[32:35], v[60:63], v[92:95]
    buffer_load_dwordx4 v59, s[48:51], s73 offen offset:3072 lds
    v_mfma_f32_16x16x32_bf16 v[120:123], v[36:39], v[60:63], v[120:123]
    v_mfma_f32_16x16x32_bf16 v[148:151], v[40:43], v[60:63], v[148:151]
    ds_read_b128 v[72:75], v19 offset:8192
    s_waitcnt lgkmcnt(1)
    v_mfma_f32_16x16x32_bf16 v[96:99], v[32:35], v[64:67], v[96:99]
    v_mfma_f32_16x16x32_bf16 v[124:127], v[36:39], v[64:67], v[124:127]
    v_mfma_f32_16x16x32_bf16 v[152:155], v[40:43], v[64:67], v[152:155]
    ds_read_b128 v[60:63], v19 offset:10240
    v_mfma_f32_16x16x32_bf16 v[100:103], v[32:35], v[68:71], v[100:103]
    v_mfma_f32_16x16x32_bf16 v[128:131], v[36:39], v[68:71], v[128:131]
    v_mfma_f32_16x16x32_bf16 v[156:159], v[40:43], v[68:71], v[156:159]
    ds_read_b128 v[64:67], v19 offset:12288
    s_waitcnt lgkmcnt(2)
    v_mfma_f32_16x16x32_bf16 v[104:107], v[32:35], v[72:75], v[104:107]
    v_mfma_f32_16x16x32_bf16 v[132:135], v[36:39], v[72:75], v[132:135]
    v_mfma_f32_16x16x32_bf16 v[160:163], v[40:43], v[72:75], v[160:163]
    s_waitcnt vmcnt(20) lgkmcnt(0)
    s_barrier
    v_mfma_f32_16x16x32_bf16 v[108:111], v[32:35], v[60:63], v[108:111]
    ds_read_b64_tr_b16 v[20:21], v15 offset:0
    ds_read_b64_tr_b16 v[22:23], v15 offset:1536
    ds_read_b128 v[68:71], v18 offset:16384
    s_add_u32 m0, s81, 24576
    s_mul_i32 s69, s64, 0x60000
    s_add_u32 s69, s69, s65
    buffer_load_dwordx4 v44, s[44:47], s69 offen offset:0 lds
    v_mfma_f32_16x16x32_bf16 v[136:139], v[36:39], v[60:63], v[136:139]
    ds_read_b64_tr_b16 v[24:25], v16 offset:0
    ds_read_b64_tr_b16 v[26:27], v16 offset:1536
    ds_read_b64_tr_b16 v[28:29], v17 offset:0
    buffer_load_dwordx4 v45, s[44:47], s69 offen offset:1024 lds
    v_mfma_f32_16x16x32_bf16 v[164:167], v[40:43], v[60:63], v[164:167]
    ds_read_b64_tr_b16 v[30:31], v17 offset:1536
    ds_read_b128 v[72:75], v18 offset:18432
    buffer_load_dwordx4 v46, s[44:47], s69 offen offset:2048 lds
    v_mfma_f32_16x16x32_bf16 v[112:115], v[32:35], v[64:67], v[112:115]
    s_add_u32 m0, s81, 36864
    s_add_u32 s69, s69, 384
    s_add_u32 s64, s64, 1
    s_cmp_eq_u32 s64, 20
    s_cselect_b32 s64, 0, s64
    buffer_load_dwordx4 v44, s[44:47], s69 offen offset:0 lds
    v_mfma_f32_16x16x32_bf16 v[140:143], v[36:39], v[64:67], v[140:143]
    buffer_load_dwordx4 v45, s[44:47], s69 offen offset:1024 lds
    v_mfma_f32_16x16x32_bf16 v[168:171], v[40:43], v[64:67], v[168:171]
    buffer_load_dwordx4 v46, s[44:47], s69 offen offset:2048 lds
    ds_read_b128 v[60:63], v18 offset:20480
    s_waitcnt lgkmcnt(4)
    v_mfma_f32_16x16x32_bf16 v[88:91], v[20:23], v[68:71], v[88:91]
    buffer_load_dwordx4 v[184:187], v52, s[52:55], s79 offen offset:0 nt
    buffer_load_dwordx4 v[188:191], v53, s[52:55], s79 offen offset:1024 nt
    buffer_load_dwordx4 v[192:195], v54, s[52:55], s79 offen offset:2048 nt
    s_add_u32 s79, s79, 12288
    s_cmp_eq_u32 s79, s88
    s_cselect_b32 s12, 196608, 0
    s_sub_u32 s79, s79, s12
    v_mfma_f32_16x16x32_bf16 v[116:119], v[24:27], v[68:71], v[116:119]
    s_waitcnt lgkmcnt(1)
    v_mfma_f32_16x16x32_bf16 v[144:147], v[28:31], v[68:71], v[144:147]
    ds_read_b128 v[64:67], v18 offset:22528
    v_mfma_f32_16x16x32_bf16 v[92:95], v[20:23], v[72:75], v[92:95]
    v_mfma_f32_16x16x32_bf16 v[120:123], v[24:27], v[72:75], v[120:123]
    v_mfma_f32_16x16x32_bf16 v[148:151], v[28:31], v[72:75], v[148:151]
    ds_read_b128 v[68:71], v18 offset:24576
    s_waitcnt lgkmcnt(1)
    v_mfma_f32_16x16x32_bf16 v[96:99], v[20:23], v[60:63], v[96:99]
    v_mfma_f32_16x16x32_bf16 v[124:127], v[24:27], v[60:63], v[124:127]
    v_mfma_f32_16x16x32_bf16 v[152:155], v[28:31], v[60:63], v[152:155]
    ds_read_b128 v[72:75], v18 offset:26624
    v_mfma_f32_16x16x32_bf16 v[100:103], v[20:23], v[64:67], v[100:103]
    v_mfma_f32_16x16x32_bf16 v[128:131], v[24:27], v[64:67], v[128:131]
    v_mfma_f32_16x16x32_bf16 v[156:159], v[28:31], v[64:67], v[156:159]
    ds_read_b128 v[60:63], v18 offset:28672
    s_waitcnt lgkmcnt(2)
    v_mfma_f32_16x16x32_bf16 v[104:107], v[20:23], v[68:71], v[104:107]
    v_mfma_f32_16x16x32_bf16 v[132:135], v[24:27], v[68:71], v[132:135]
    v_mfma_f32_16x16x32_bf16 v[160:163], v[28:31], v[68:71], v[160:163]
    s_waitcnt vmcnt(19) lgkmcnt(0)
    s_barrier
    v_mfma_f32_16x16x32_bf16 v[108:111], v[20:23], v[72:75], v[108:111]
    ds_read_b64_tr_b16 v[32:33], v15 offset:24576
    ds_read_b64_tr_b16 v[34:35], v15 offset:26112
    ds_read_b128 v[64:67], v19 offset:16384
    s_add_u32 m0, s81, 49152
    s_mul_i32 s69, s64, 0x60000
    s_add_u32 s69, s69, s65
    buffer_load_dwordx4 v44, s[44:47], s69 offen offset:0 lds
    v_mfma_f32_16x16x32_bf16 v[136:139], v[24:27], v[72:75], v[136:139]
    ds_read_b64_tr_b16 v[36:37], v16 offset:24576
    ds_read_b64_tr_b16 v[38:39], v16 offset:26112
    ds_read_b64_tr_b16 v[40:41], v17 offset:24576
    buffer_load_dwordx4 v45, s[44:47], s69 offen offset:1024 lds
    v_mfma_f32_16x16x32_bf16 v[164:167], v[28:31], v[72:75], v[164:167]
    ds_read_b64_tr_b16 v[42:43], v17 offset:26112
    ds_read_b128 v[68:71], v19 offset:18432
    buffer_load_dwordx4 v46, s[44:47], s69 offen offset:2048 lds
    v_mfma_f32_16x16x32_bf16 v[112:115], v[20:23], v[60:63], v[112:115]
    s_add_u32 m0, s81, 61440
    s_add_u32 s69, s69, 384
    s_add_u32 s64, s64, 1
    s_cmp_eq_u32 s64, 20
    s_cselect_b32 s64, 0, s64
    buffer_load_dwordx4 v44, s[44:47], s69 offen offset:0 lds
    v_mfma_f32_16x16x32_bf16 v[140:143], v[24:27], v[60:63], v[140:143]
    buffer_load_dwordx4 v45, s[44:47], s69 offen offset:1024 lds
    v_mfma_f32_16x16x32_bf16 v[168:171], v[28:31], v[60:63], v[168:171]
    buffer_load_dwordx4 v46, s[44:47], s69 offen offset:2048 lds
    ds_read_b128 v[72:75], v19 offset:20480
    s_waitcnt lgkmcnt(4)
    v_mfma_f32_16x16x32_bf16 v[88:91], v[32:35], v[64:67], v[88:91]
    v_mfma_f32_16x16x32_bf16 v[116:119], v[36:39], v[64:67], v[116:119]
    s_waitcnt lgkmcnt(1)
    v_mfma_f32_16x16x32_bf16 v[144:147], v[40:43], v[64:67], v[144:147]
    ds_read_b128 v[60:63], v19 offset:22528
    v_mfma_f32_16x16x32_bf16 v[92:95], v[32:35], v[68:71], v[92:95]
    v_mfma_f32_16x16x32_bf16 v[120:123], v[36:39], v[68:71], v[120:123]
    v_mfma_f32_16x16x32_bf16 v[148:151], v[40:43], v[68:71], v[148:151]
    ds_read_b128 v[64:67], v19 offset:24576
    s_waitcnt lgkmcnt(1)
    v_mfma_f32_16x16x32_bf16 v[96:99], v[32:35], v[72:75], v[96:99]
    v_mfma_f32_16x16x32_bf16 v[124:127], v[36:39], v[72:75], v[124:127]
    v_mfma_f32_16x16x32_bf16 v[152:155], v[40:43], v[72:75], v[152:155]
    ds_read_b128 v[68:71], v19 offset:26624
    v_mfma_f32_16x16x32_bf16 v[100:103], v[32:35], v[60:63], v[100:103]
    v_mfma_f32_16x16x32_bf16 v[128:131], v[36:39], v[60:63], v[128:131]
    v_mfma_f32_16x16x32_bf16 v[156:159], v[40:43], v[60:63], v[156:159]
    ds_read_b128 v[72:75], v19 offset:28672
    s_waitcnt lgkmcnt(2)
    v_mfma_f32_16x16x32_bf16 v[104:107], v[32:35], v[64:67], v[104:107]
    v_mfma_f32_16x16x32_bf16 v[132:135], v[36:39], v[64:67], v[132:135]
    v_mfma_f32_16x16x32_bf16 v[160:163], v[40:43], v[64:67], v[160:163]
    s_waitcnt vmcnt(19) lgkmcnt(0)
    s_barrier
    v_mfma_f32_16x16x32_bf16 v[108:111], v[32:35], v[68:71], v[108:111]
    ds_read_b64_tr_b16 v[20:21], v12 offset:0
    ds_read_b64_tr_b16 v[22:23], v12 offset:1536
    ds_read_b128 v[60:63], v18 offset:32768
    s_add_u32 m0, s81, 73728
    s_mul_i32 s69, s64, 0x60000
    s_add_u32 s69, s69, s65
    buffer_load_dwordx4 v44, s[44:47], s69 offen offset:0 lds
    v_mfma_f32_16x16x32_bf16 v[136:139], v[36:39], v[68:71], v[136:139]
    ds_read_b64_tr_b16 v[24:25], v13 offset:0
    ds_read_b64_tr_b16 v[26:27], v13 offset:1536
    ds_read_b64_tr_b16 v[28:29], v14 offset:0
    buffer_load_dwordx4 v45, s[44:47], s69 offen offset:1024 lds
    v_mfma_f32_16x16x32_bf16 v[164:167], v[40:43], v[68:71], v[164:167]
    ds_read_b64_tr_b16 v[30:31], v14 offset:1536
    ds_read_b128 v[64:67], v18 offset:34816
    buffer_load_dwordx4 v46, s[44:47], s69 offen offset:2048 lds
    v_mfma_f32_16x16x32_bf16 v[112:115], v[32:35], v[72:75], v[112:115]
    s_add_u32 m0, s81, 86016
    s_add_u32 s69, s69, 384
    s_add_u32 s64, s64, 1
    s_cmp_eq_u32 s64, 20
    s_cselect_b32 s64, 0, s64
    buffer_load_dwordx4 v44, s[44:47], s69 offen offset:0 lds
    v_mfma_f32_16x16x32_bf16 v[140:143], v[36:39], v[72:75], v[140:143]
    buffer_load_dwordx4 v45, s[44:47], s69 offen offset:1024 lds
    v_mfma_f32_16x16x32_bf16 v[168:171], v[40:43], v[72:75], v[168:171]
    buffer_load_dwordx4 v46, s[44:47], s69 offen offset:2048 lds
    ds_read_b128 v[68:71], v18 offset:36864
    s_waitcnt lgkmcnt(4)
    v_mfma_f32_16x16x32_bf16 v[88:91], v[20:23], v[60:63], v[88:91]
    buffer_load_dwordx4 v[196:199], v52, s[52:55], s79 offen offset:0 nt
    buffer_load_dwordx4 v[200:203], v53, s[52:55], s79 offen offset:1024 nt
    buffer_load_dwordx4 v[204:207], v54, s[52:55], s79 offen offset:2048 nt
    s_add_u32 s79, s79, 12288
    s_cmp_eq_u32 s79, s88
    s_cselect_b32 s12, 196608, 0
    s_sub_u32 s79, s79, s12
    v_mfma_f32_16x16x32_bf16 v[116:119], v[24:27], v[60:63], v[116:119]
    buffer_load_dwordx4 v[208:211], v52, s[52:55], s79 offen offset:0 nt
    buffer_load_dwordx4 v[212:215], v53, s[52:55], s79 offen offset:1024 nt
    buffer_load_dwordx4 v[216:219], v54, s[52:55], s79 offen offset:2048 nt
    s_add_u32 s79, s79, 12288
    s_cmp_eq_u32 s79, s88
    s_cselect_b32 s12, 196608, 0
    s_sub_u32 s79, s79, s12
    s_waitcnt lgkmcnt(1)
    v_mfma_f32_16x16x32_bf16 v[144:147], v[28:31], v[60:63], v[144:147]
    ds_read_b128 v[72:75], v18 offset:38912
    v_mfma_f32_16x16x32_bf16 v[92:95], v[20:23], v[64:67], v[92:95]
    v_mfma_f32_16x16x32_bf16 v[120:123], v[24:27], v[64:67], v[120:123]
    v_mfma_f32_16x16x32_bf16 v[148:151], v[28:31], v[64:67], v[148:151]
    ds_read_b128 v[60:63], v18 offset:40960
    s_waitcnt lgkmcnt(1)
    v_mfma_f32_16x16x32_bf16 v[96:99], v[20:23], v[68:71], v[96:99]
    v_mfma_f32_16x16x32_bf16 v[124:127], v[24:27], v[68:71], v[124:127]
    v_mfma_f32_16x16x32_bf16 v[152:155], v[28:31], v[68:71], v[152:155]
    ds_read_b128 v[64:67], v18 offset:43008
    v_mfma_f32_16x16x32_bf16 v[100:103], v[20:23], v[72:75], v[100:103]
    v_mfma_f32_16x16x32_bf16 v[128:131], v[24:27], v[72:75], v[128:131]
    v_mfma_f32_16x16x32_bf16 v[156:159], v[28:31], v[72:75], v[156:159]
    ds_read_b128 v[68:71], v18 offset:45056
    s_waitcnt lgkmcnt(2)
    v_mfma_f32_16x16x32_bf16 v[104:107], v[20:23], v[60:63], v[104:107]
    v_mfma_f32_16x16x32_bf16 v[132:135], v[24:27], v[60:63], v[132:135]
    v_mfma_f32_16x16x32_bf16 v[160:163], v[28:31], v[60:63], v[160:163]
    s_waitcnt vmcnt(21) lgkmcnt(0)
    s_barrier
    v_mfma_f32_16x16x32_bf16 v[108:111], v[20:23], v[64:67], v[108:111]
    ds_read_b64_tr_b16 v[32:33], v12 offset:24576
    ds_read_b64_tr_b16 v[34:35], v12 offset:26112
    ds_read_b128 v[72:75], v19 offset:32768
    buffer_load_dwordx4 v[172:175], v52, s[56:59], s80 offen offset:0 nt
    buffer_load_dwordx4 v[176:179], v53, s[56:59], s80 offen offset:1024 nt
    buffer_load_dwordx4 v[180:183], v54, s[56:59], s80 offen offset:2048 nt
    s_add_u32 s80, s80, 12288
    s_cmp_eq_u32 s80, s9
    s_cselect_b32 s12, 196608, 0
    s_sub_u32 s80, s80, s12
    v_mfma_f32_16x16x32_bf16 v[136:139], v[24:27], v[64:67], v[136:139]
    ds_read_b64_tr_b16 v[36:37], v13 offset:24576
    ds_read_b64_tr_b16 v[38:39], v13 offset:26112
    ds_read_b64_tr_b16 v[40:41], v14 offset:24576
    buffer_load_dwordx4 v[220:223], v52, s[52:55], s79 offen offset:0 nt
    buffer_load_dwordx4 v[224:227], v53, s[52:55], s79 offen offset:1024 nt
    buffer_load_dwordx4 v[228:231], v54, s[52:55], s79 offen offset:2048 nt
    s_add_u32 s79, s79, 12288
    s_cmp_eq_u32 s79, s88
    s_cselect_b32 s12, 196608, 0
    s_sub_u32 s79, s79, s12
    v_mfma_f32_16x16x32_bf16 v[164:167], v[28:31], v[64:67], v[164:167]
    ds_read_b64_tr_b16 v[42:43], v14 offset:26112
    ds_read_b128 v[60:63], v19 offset:34816
    v_mfma_f32_16x16x32_bf16 v[112:115], v[20:23], v[68:71], v[112:115]
    v_mfma_f32_16x16x32_bf16 v[140:143], v[24:27], v[68:71], v[140:143]
    v_mfma_f32_16x16x32_bf16 v[168:171], v[28:31], v[68:71], v[168:171]
    ds_read_b128 v[64:67], v19 offset:36864
    s_waitcnt lgkmcnt(4)
    v_mfma_f32_16x16x32_bf16 v[88:91], v[32:35], v[72:75], v[88:91]
    v_mfma_f32_16x16x32_bf16 v[116:119], v[36:39], v[72:75], v[116:119]
    s_waitcnt lgkmcnt(1)
    v_mfma_f32_16x16x32_bf16 v[144:147], v[40:43], v[72:75], v[144:147]
    ds_read_b128 v[68:71], v19 offset:38912
    v_mfma_f32_16x16x32_bf16 v[92:95], v[32:35], v[60:63], v[92:95]
    v_mfma_f32_16x16x32_bf16 v[120:123], v[36:39], v[60:63], v[120:123]
    v_mfma_f32_16x16x32_bf16 v[148:151], v[40:43], v[60:63], v[148:151]
    ds_read_b128 v[72:75], v19 offset:40960
    s_waitcnt lgkmcnt(1)
    v_mfma_f32_16x16x32_bf16 v[96:99], v[32:35], v[64:67], v[96:99]
    v_mfma_f32_16x16x32_bf16 v[124:127], v[36:39], v[64:67], v[124:127]
    v_mfma_f32_16x16x32_bf16 v[152:155], v[40:43], v[64:67], v[152:155]
    ds_read_b128 v[60:63], v19 offset:43008
    v_mfma_f32_16x16x32_bf16 v[100:103], v[32:35], v[68:71], v[100:103]
    v_mfma_f32_16x16x32_bf16 v[128:131], v[36:39], v[68:71], v[128:131]
    v_mfma_f32_16x16x32_bf16 v[156:159], v[40:43], v[68:71], v[156:159]
    ds_read_b128 v[64:67], v19 offset:45056
    s_waitcnt lgkmcnt(2)
    v_mfma_f32_16x16x32_bf16 v[104:107], v[32:35], v[72:75], v[104:107]
    v_mfma_f32_16x16x32_bf16 v[132:135], v[36:39], v[72:75], v[132:135]
    v_mfma_f32_16x16x32_bf16 v[160:163], v[40:43], v[72:75], v[160:163]
    s_waitcnt vmcnt(18) lgkmcnt(0)
    s_barrier
    v_mfma_f32_16x16x32_bf16 v[108:111], v[32:35], v[60:63], v[108:111]
    ds_read_b64_tr_b16 v[20:21], v15 offset:0
    ds_read_b64_tr_b16 v[22:23], v15 offset:1536
    ds_read_b128 v[68:71], v18 offset:49152
    buffer_load_dwordx4 v[76:79], v52, s[56:59], s80 offen offset:0 nt
    buffer_load_dwordx4 v[80:83], v53, s[56:59], s80 offen offset:1024 nt
    buffer_load_dwordx4 v[84:87], v54, s[56:59], s80 offen offset:2048 nt
    s_add_u32 s80, s80, 12288
    s_cmp_eq_u32 s80, s9
    s_cselect_b32 s12, 196608, 0
    s_sub_u32 s80, s80, s12
    v_mfma_f32_16x16x32_bf16 v[136:139], v[36:39], v[60:63], v[136:139]
    ds_read_b64_tr_b16 v[24:25], v16 offset:0
    ds_read_b64_tr_b16 v[26:27], v16 offset:1536
    ds_read_b64_tr_b16 v[28:29], v17 offset:0
    buffer_load_dwordx4 v[232:235], v52, s[52:55], s79 offen offset:0 nt
    buffer_load_dwordx4 v[236:239], v53, s[52:55], s79 offen offset:1024 nt
    buffer_load_dwordx4 v[240:243], v54, s[52:55], s79 offen offset:2048 nt
    s_add_u32 s79, s79, 12288
    s_cmp_eq_u32 s79, s88
    s_cselect_b32 s12, 196608, 0
    s_sub_u32 s79, s79, s12
    v_mfma_f32_16x16x32_bf16 v[164:167], v[40:43], v[60:63], v[164:167]
    ds_read_b64_tr_b16 v[30:31], v17 offset:1536
    ds_read_b128 v[72:75], v18 offset:51200
    v_mfma_f32_16x16x32_bf16 v[112:115], v[32:35], v[64:67], v[112:115]
    v_mfma_f32_16x16x32_bf16 v[140:143], v[36:39], v[64:67], v[140:143]
    v_mfma_f32_16x16x32_bf16 v[168:171], v[40:43], v[64:67], v[168:171]
    ds_read_b128 v[60:63], v18 offset:53248
    s_waitcnt lgkmcnt(4)
    v_mfma_f32_16x16x32_bf16 v[88:91], v[20:23], v[68:71], v[88:91]
    v_mfma_f32_16x16x32_bf16 v[116:119], v[24:27], v[68:71], v[116:119]
    s_waitcnt lgkmcnt(1)
    v_mfma_f32_16x16x32_bf16 v[144:147], v[28:31], v[68:71], v[144:147]
    ds_read_b128 v[64:67], v18 offset:55296
    v_mfma_f32_16x16x32_bf16 v[92:95], v[20:23], v[72:75], v[92:95]
    v_mfma_f32_16x16x32_bf16 v[120:123], v[24:27], v[72:75], v[120:123]
    v_mfma_f32_16x16x32_bf16 v[148:151], v[28:31], v[72:75], v[148:151]
    ds_read_b128 v[68:71], v18 offset:57344
    s_waitcnt lgkmcnt(1)
    v_mfma_f32_16x16x32_bf16 v[96:99], v[20:23], v[60:63], v[96:99]
    v_mfma_f32_16x16x32_bf16 v[124:127], v[24:27], v[60:63], v[124:127]
    v_mfma_f32_16x16x32_bf16 v[152:155], v[28:31], v[60:63], v[152:155]
    ds_read_b128 v[72:75], v18 offset:59392
    v_mfma_f32_16x16x32_bf16 v[100:103], v[20:23], v[64:67], v[100:103]
    v_mfma_f32_16x16x32_bf16 v[128:131], v[24:27], v[64:67], v[128:131]
    v_mfma_f32_16x16x32_bf16 v[156:159], v[28:31], v[64:67], v[156:159]
    ds_read_b128 v[60:63], v18 offset:61440
    s_waitcnt lgkmcnt(2)
    v_mfma_f32_16x16x32_bf16 v[104:107], v[20:23], v[68:71], v[104:107]
    v_mfma_f32_16x16x32_bf16 v[132:135], v[24:27], v[68:71], v[132:135]
    v_mfma_f32_16x16x32_bf16 v[160:163], v[28:31], v[68:71], v[160:163]
    s_waitcnt vmcnt(18) lgkmcnt(0)
    s_barrier
    v_mfma_f32_16x16x32_bf16 v[108:111], v[20:23], v[72:75], v[108:111]
    ds_read_b64_tr_b16 v[32:33], v15 offset:24576
    ds_read_b64_tr_b16 v[34:35], v15 offset:26112
    ds_read_b128 v[64:67], v19 offset:49152
    buffer_load_dwordx4 v[244:247], v52, s[56:59], s80 offen offset:0 nt
    buffer_load_dwordx4 v[248:251], v53, s[56:59], s80 offen offset:1024 nt
    buffer_load_dwordx4 v[252:255], v54, s[56:59], s80 offen offset:2048 nt
    s_add_u32 s80, s80, 12288
    s_cmp_eq_u32 s80, s9
    s_cselect_b32 s12, 196608, 0
    s_sub_u32 s80, s80, s12
    v_mfma_f32_16x16x32_bf16 v[136:139], v[24:27], v[72:75], v[136:139]
    ds_read_b64_tr_b16 v[36:37], v16 offset:24576
    ds_read_b64_tr_b16 v[38:39], v16 offset:26112
    ds_read_b64_tr_b16 v[40:41], v17 offset:24576
    v_mfma_f32_16x16x32_bf16 v[164:167], v[28:31], v[72:75], v[164:167]
    ds_read_b64_tr_b16 v[42:43], v17 offset:26112
    ds_read_b128 v[68:71], v19 offset:51200
    v_mfma_f32_16x16x32_bf16 v[112:115], v[20:23], v[60:63], v[112:115]
    v_mfma_f32_16x16x32_bf16 v[140:143], v[24:27], v[60:63], v[140:143]
    v_mfma_f32_16x16x32_bf16 v[168:171], v[28:31], v[60:63], v[168:171]
    ds_read_b128 v[72:75], v19 offset:53248
    s_waitcnt lgkmcnt(4)
    v_mfma_f32_16x16x32_bf16 v[88:91], v[32:35], v[64:67], v[88:91]
    v_mfma_f32_16x16x32_bf16 v[116:119], v[36:39], v[64:67], v[116:119]
    s_waitcnt lgkmcnt(1)
    v_mfma_f32_16x16x32_bf16 v[144:147], v[40:43], v[64:67], v[144:147]
    ds_read_b128 v[60:63], v19 offset:55296
    v_mfma_f32_16x16x32_bf16 v[92:95], v[32:35], v[68:71], v[92:95]
    v_mfma_f32_16x16x32_bf16 v[120:123], v[36:39], v[68:71], v[120:123]
    v_mfma_f32_16x16x32_bf16 v[148:151], v[40:43], v[68:71], v[148:151]
    ds_read_b128 v[64:67], v19 offset:57344
    s_waitcnt lgkmcnt(1)
    v_mfma_f32_16x16x32_bf16 v[96:99], v[32:35], v[72:75], v[96:99]
    v_mfma_f32_16x16x32_bf16 v[124:127], v[36:39], v[72:75], v[124:127]
    v_mfma_f32_16x16x32_bf16 v[152:155], v[40:43], v[72:75], v[152:155]
    ds_read_b128 v[68:71], v19 offset:59392
    v_mfma_f32_16x16x32_bf16 v[100:103], v[32:35], v[60:63], v[100:103]
    v_mfma_f32_16x16x32_bf16 v[128:131], v[36:39], v[60:63], v[128:131]
    v_mfma_f32_16x16x32_bf16 v[156:159], v[40:43], v[60:63], v[156:159]
    ds_read_b128 v[72:75], v19 offset:61440
    s_waitcnt lgkmcnt(2)
    v_mfma_f32_16x16x32_bf16 v[104:107], v[32:35], v[64:67], v[104:107]
    v_mfma_f32_16x16x32_bf16 v[132:135], v[36:39], v[64:67], v[132:135]
    v_mfma_f32_16x16x32_bf16 v[160:163], v[40:43], v[64:67], v[160:163]
    s_waitcnt lgkmcnt(0)
    s_barrier
    v_mfma_f32_16x16x32_bf16 v[108:111], v[32:35], v[68:71], v[108:111]
    v_mfma_f32_16x16x32_bf16 v[136:139], v[36:39], v[68:71], v[136:139]
    v_mfma_f32_16x16x32_bf16 v[164:167], v[40:43], v[68:71], v[164:167]
    v_mfma_f32_16x16x32_bf16 v[112:115], v[32:35], v[72:75], v[112:115]
    v_mfma_f32_16x16x32_bf16 v[140:143], v[36:39], v[72:75], v[140:143]
    v_mfma_f32_16x16x32_bf16 v[168:171], v[40:43], v[72:75], v[168:171]
    s_mov_b32 s84, s38
    s_and_b32 s85, s39, 0xffff
    s_mov_b32 s86, 0x100
    s_mov_b32 s87, 0x20000
    s_buffer_load_dword s83, s[84:87], 0
    v_and_b32 v7, 3, v0
    s_lshr_b32 s73, s78, 10
    s_add_u32 s73, s73, 159808
    v_lshl_add_u32 v7, v7, 4, s73
    v_mov_b32 v3, 5
    v_mov_b32 v4, 0
    v_and_b32 v47, 3, v0
    s_lshr_b32 s73, s78, 8
    s_add_u32 s73, s73, 159936
    v_lshl_add_u32 v47, v47, 2, s73
    ds_write_b32 v7, v3 offset:64
    ds_write_b32 v47, v4
    s_waitcnt lgkmcnt(0)
    s_barrier
    s_setprio 2
    s_sub_u32 s32, s32, 2000
    s_lshl_b32 s32, s32, 4
    s_sub_u32 s32, s83, s32
    s_cmp_lt_u32 s32, 1600000
    s_cselect_b32 s83, s83, 0
    s_cmp_lg_u32 s83, 0
    s_cbranch_scc1 K1_tgd
    s_mov_b32 s74, 0
    v_mov_b32 v1, 0
K1_tgl:
    buffer_load_dword v2, v1, s[84:87], 0 offen sc1
    s_waitcnt vmcnt(0)
    v_readfirstlane_b32 s83, v2
    s_add_u32 s74, s74, 1
    s_cmp_lg_u32 s83, 0
    s_cbranch_scc1 K1_tgd
    s_sleep 4
    s_cmp_lt_u32 s74, 0x400000
    s_cbranch_scc1 K1_tgl
K1_tgd:
    v_mov_b32 v1, 159748
    v_mov_b32 v2, s83
    ds_write_b32 v1, v2
    s_mov_b32 s44, s24
    s_and_b32 s45, s25, 0xffff
    s_mov_b32 s46, 0x780000
    s_mov_b32 s47, 0x20000
    s_mov_b32 s7, s82
    s_and_b32 s8, s75, 1
    s_mul_i32 s8, s8, 3
    s_mov_b32 s15, s8
    s_mov_b32 s6, 0
    s_memrealtime s[4:5]
    s_waitcnt vmcnt(6) lgkmcnt(0)
    s_lshl_b32 s4, s4, 4
    s_sub_u32 s4, s4, s83
    s_cmp_gt_i32 s4, 12000
    s_cbranch_scc1 K1_th62
    s_waitcnt vmcnt(3)
K1_th62:
    buffer_load_dwordx4 v[60:63], v52, s[52:55], s79 offen offset:0 nt
    buffer_load_dwordx4 v[64:67], v53, s[52:55], s79 offen offset:1024 nt
    buffer_load_dwordx4 v[68:71], v54, s[52:55], s79 offen offset:2048 nt
    s_add_u32 s79, s79, 12288
    s_cmp_eq_u32 s79, s88
    s_cselect_b32 s12, 196608, 0
    s_sub_u32 s79, s79, s12
    s_memrealtime s[4:5]
    s_waitcnt vmcnt(6) lgkmcnt(0)
    s_lshl_b32 s4, s4, 4
    s_sub_u32 s4, s4, s83
    s_cmp_gt_i32 s4, 12704
    s_cbranch_scc1 K1_th63
    s_waitcnt vmcnt(3)
K1_th63:
    buffer_load_dwordx4 v[20:23], v52, s[56:59], s80 offen offset:0 nt
    buffer_load_dwordx4 v[24:27], v53, s[56:59], s80 offen offset:1024 nt
    buffer_load_dwordx4 v[28:31], v54, s[56:59], s80 offen offset:2048 nt
    s_add_u32 s80, s80, 12288
    s_cmp_eq_u32 s80, s9
    s_cselect_b32 s12, 196608, 0
    s_sub_u32 s80, s80, s12
    s_memrealtime s[4:5]
    s_waitcnt vmcnt(6) lgkmcnt(0)
    s_lshl_b32 s4, s4, 4
    s_sub_u32 s4, s4, s83
    s_cmp_gt_i32 s4, 13408
    s_cbranch_scc1 K1_th64
    s_waitcnt vmcnt(3)
K1_th64:
    buffer_load_dwordx4 v[32:35], v52, s[52:55], s79 offen offset:0 nt
    buffer_load_dwordx4 v[36:39], v53, s[52:55], s79 offen offset:1024 nt
    buffer_load_dwordx4 v[40:43], v54, s[52:55], s79 offen offset:2048 nt
    s_add_u32 s79, s79, 12288
    s_cmp_eq_u32 s79, s88
    s_cselect_b32 s12, 196608, 0
    s_sub_u32 s79, s79, s12
    ds_read_b32 v1, v7
    s_waitcnt lgkmcnt(0)
    s_mov_b32 s71, 1
    v_cmp_gt_i32 vcc, s71, v1
    s_cbranch_vccnz K1_gs65
K1_gs65b:
    s_waitcnt vmcnt(42)
    ds_write_b128 v8, v[184:187] offset:0
    ds_write_b128 v8, v[188:191] offset:1024
    ds_write_b128 v8, v[192:195] offset:2048
    v_mov_b32 v3, 7
    ds_write_b32 v7, v3 offset:64
    s_memrealtime s[4:5]
    s_waitcnt vmcnt(6) lgkmcnt(0)
    s_lshl_b32 s4, s4, 4
    s_sub_u32 s4, s4, s83
    s_cmp_gt_i32 s4, 14112
    s_cbranch_scc1 K1_th66
    s_waitcnt vmcnt(3)
K1_th66:
    buffer_load_dwordx4 v[184:187], v52, s[56:59], s80 offen offset:0 nt
    buffer_load_dwordx4 v[188:191], v53, s[56:59], s80 offen offset:1024 nt
    buffer_load_dwordx4 v[192:195], v54, s[56:59], s80 offen offset:2048 nt
    s_add_u32 s80, s80, 12288
    s_cmp_eq_u32 s80, s9
    s_cselect_b32 s12, 196608, 0
    s_sub_u32 s80, s80, s12
    s_lshl_b32 s73, s81, 2
    s_add_u32 s73, s73, 98304
    v_lshlrev_b32 v10, 4, v0
    v_add_u32 v10, s73, v10
    v_and_b32 v4, 15, v0
    v_lshlrev_b32 v4, 4, v4
    v_lshrrev_b32 v5, 5, v0
    v_lshl_add_u32 v4, v5, 9, v4
    v_bfe_u32 v5, v0, 4, 1
    v_lshl_add_u32 v4, v5, 3, v4
    s_and_b32 s73, s3, 3
    s_mul_i32 s73, s73, 3
    s_add_u32 s73, s73, 0
    s_and_b32 s74, s73, 1
    s_lshr_b32 s73, s73, 1
    s_lshl_b32 s73, s73, 3
    s_add_u32 s73, s73, s74
    s_lshl_b32 s73, s73, 8
    s_add_u32 s73, s73, 98304
    v_add_u32 v4, s73, v4
    v_mul_f32 v88, s94, v88
    v_mul_f32 v89, s94, v89
    v_mul_f32 v90, s94, v90
    v_mul_f32 v91, s94, v91
    v_cvt_pk_bf16_f32 v88, v88, v89
    v_cvt_pk_bf16_f32 v89, v90, v91
    ds_write_b64 v4, v[88:89] offset:0
    v_mul_f32 v92, s94, v92
    v_mul_f32 v93, s94, v93
    v_mul_f32 v94, s94, v94
    v_mul_f32 v95, s94, v95
    v_cvt_pk_bf16_f32 v92, v92, v93
    v_cvt_pk_bf16_f32 v93, v94, v95
    ds_write_b64 v4, v[92:93] offset:1024
    v_mul_f32 v96, s94, v96
    v_mul_f32 v97, s94, v97
    v_mul_f32 v98, s94, v98
    v_mul_f32 v99, s94, v99
    v_cvt_pk_bf16_f32 v96, v96, v97
    v_cvt_pk_bf16_f32 v97, v98, v99
    ds_write_b64 v4, v[96:97] offset:12288
    v_mul_f32 v100, s94, v100
    v_mul_f32 v101, s94, v101
    v_mul_f32 v102, s94, v102
    v_mul_f32 v103, s94, v103
    v_cvt_pk_bf16_f32 v100, v100, v101
    v_cvt_pk_bf16_f32 v101, v102, v103
    ds_write_b64 v4, v[100:101] offset:13312
    v_mul_f32 v104, s94, v104
    v_mul_f32 v105, s94, v105
    v_mul_f32 v106, s94, v106
    v_mul_f32 v107, s94, v107
    v_cvt_pk_bf16_f32 v104, v104, v105
    v_cvt_pk_bf16_f32 v105, v106, v107
    ds_write_b64 v4, v[104:105] offset:24576
    v_mul_f32 v108, s94, v108
    v_mul_f32 v109, s94, v109
    v_mul_f32 v110, s94, v110
    v_mul_f32 v111, s94, v111
    v_cvt_pk_bf16_f32 v108, v108, v109
    v_cvt_pk_bf16_f32 v109, v110, v111
    ds_write_b64 v4, v[108:109] offset:25600
    v_mul_f32 v112, s94, v112
    v_mul_f32 v113, s94, v113
    v_mul_f32 v114, s94, v114
    v_mul_f32 v115, s94, v115
    v_cvt_pk_bf16_f32 v112, v112, v113
    v_cvt_pk_bf16_f32 v113, v114, v115
    ds_write_b64 v4, v[112:113] offset:36864
    ds_read_b32 v1, v7
    s_waitcnt lgkmcnt(0)
    s_mov_b32 s71, 2
    v_cmp_gt_i32 vcc, s71, v1
    s_cbranch_vccnz K1_gs67
K1_gs67b:
    s_waitcnt vmcnt(30)
    ds_write_b128 v8, v[196:199] offset:12288
    ds_write_b128 v8, v[200:203] offset:13312
    ds_write_b128 v8, v[204:207] offset:14336
    v_mov_b32 v3, 9
    ds_write_b32 v7, v3 offset:64
    s_memrealtime s[4:5]
    s_waitcnt vmcnt(6) lgkmcnt(0)
    s_lshl_b32 s4, s4, 4
    s_sub_u32 s4, s4, s83
    s_cmp_gt_i32 s4, 14816
    s_cbranch_scc1 K1_th68
    s_waitcnt vmcnt(3)
K1_th68:
    buffer_load_dwordx4 v[196:199], v52, s[52:55], s79 offen offset:0 nt
    buffer_load_dwordx4 v[200:203], v53, s[52:55], s79 offen offset:1024 nt
    buffer_load_dwordx4 v[204:207], v54, s[52:55], s79 offen offset:2048 nt
    s_add_u32 s79, s79, 12288
    s_cmp_eq_u32 s79, s88
    s_cselect_b32 s12, 196608, 0
    s_sub_u32 s79, s79, s12
    v_and_b32 v4, 15, v0
    v_lshlrev_b32 v4, 4, v4
    v_lshrrev_b32 v5, 5, v0
    v_lshl_add_u32 v4, v5, 9, v4
    v_bfe_u32 v5, v0, 4, 1
    v_lshl_add_u32 v4, v5, 3, v4
    s_and_b32 s73, s3, 3
    s_mul_i32 s73, s73, 3
    s_add_u32 s73, s73, 1
    s_and_b32 s74, s73, 1
    s_lshr_b32 s73, s73, 1
    s_lshl_b32 s73, s73, 3
    s_add_u32 s73, s73, s74
    s_lshl_b32 s73, s73, 8
    s_add_u32 s73, s73, 98304
    v_add_u32 v4, s73, v4
    v_mul_f32 v116, s94, v116
    v_mul_f32 v117, s94, v117
    v_mul_f32 v118, s94, v118
    v_mul_f32 v119, s94, v119
    v_cvt_pk_bf16_f32 v116, v116, v117
    v_cvt_pk_bf16_f32 v117, v118, v119
    ds_write_b64 v4, v[116:117] offset:0
    v_mul_f32 v120, s94, v120
    v_mul_f32 v121, s94, v121
    v_mul_f32 v122, s94, v122
    v_mul_f32 v123, s94, v123
    v_cvt_pk_bf16_f32 v120, v120, v121
    v_cvt_pk_bf16_f32 v121, v122, v123
    ds_write_b64 v4, v[120:121] offset:1024
    v_mul_f32 v124, s94, v124
    v_mul_f32 v125, s94, v125
    v_mul_f32 v126, s94, v126
    v_mul_f32 v127, s94, v127
    v_cvt_pk_bf16_f32 v124, v124, v125
    v_cvt_pk_bf16_f32 v125, v126, v127
    ds_write_b64 v4, v[124:125] offset:12288
    v_mul_f32 v128, s94, v128
    v_mul_f32 v129, s94, v129
    v_mul_f32 v130, s94, v130
    v_mul_f32 v131, s94, v131
    v_cvt_pk_bf16_f32 v128, v128, v129
    v_cvt_pk_bf16_f32 v129, v130, v131
    ds_write_b64 v4, v[128:129] offset:13312
    v_mul_f32 v132, s94, v132
    v_mul_f32 v133, s94, v133
    v_mul_f32 v134, s94, v134
    v_mul_f32 v135, s94, v135
    v_cvt_pk_bf16_f32 v132, v132, v133
    v_cvt_pk_bf16_f32 v133, v134, v135
    ds_write_b64 v4, v[132:133] offset:24576
    v_mul_f32 v136, s94, v136
    v_mul_f32 v137, s94, v137
    v_mul_f32 v138, s94, v138
    v_mul_f32 v139, s94, v139
    v_cvt_pk_bf16_f32 v136, v136, v137
    v_cvt_pk_bf16_f32 v137, v138, v139
    ds_write_b64 v4, v[136:137] offset:25600
    v_mul_f32 v140, s94, v140
    v_mul_f32 v141, s94, v141
    v_mul_f32 v142, s94, v142
    v_mul_f32 v143, s94, v143
    v_cvt_pk_bf16_f32 v140, v140, v141
    v_cvt_pk_bf16_f32 v141, v142, v143
    ds_write_b64 v4, v[140:141] offset:36864
    ds_read_b32 v1, v7
    s_waitcnt lgkmcnt(0)
    s_mov_b32 s71, 3
    v_cmp_gt_i32 vcc, s71, v1
    s_cbranch_vccnz K1_gs69
K1_gs69b:
    s_waitcnt vmcnt(30)
    ds_write_b128 v8, v[208:211] offset:24576
    ds_write_b128 v8, v[212:215] offset:25600
    ds_write_b128 v8, v[216:219] offset:26624
    v_mov_b32 v3, 10
    ds_write_b32 v7, v3 offset:64
    s_memrealtime s[4:5]
    s_waitcnt vmcnt(6) lgkmcnt(0)
    s_lshl_b32 s4, s4, 4
    s_sub_u32 s4, s4, s83
    s_cmp_gt_i32 s4, 15520
    s_cbranch_scc1 K1_th70
    s_waitcnt vmcnt(3)
K1_th70:
    buffer_load_dwordx4 v[208:211], v52, s[56:59], s80 offen offset:0 nt
    buffer_load_dwordx4 v[212:215], v53, s[56:59], s80 offen offset:1024 nt
    buffer_load_dwordx4 v[216:219], v54, s[56:59], s80 offen offset:2048 nt
    s_add_u32 s80, s80, 12288
    s_cmp_eq_u32 s80, s9
    s_cselect_b32 s12, 196608, 0
    s_sub_u32 s80, s80, s12
    v_and_b32 v4, 15, v0
    v_lshlrev_b32 v4, 4, v4
    v_lshrrev_b32 v5, 5, v0
    v_lshl_add_u32 v4, v5, 9, v4
    v_bfe_u32 v5, v0, 4, 1
    v_lshl_add_u32 v4, v5, 3, v4
    s_and_b32 s73, s3, 3
    s_mul_i32 s73, s73, 3
    s_add_u32 s73, s73, 2
    s_and_b32 s74, s73, 1
    s_lshr_b32 s73, s73, 1
    s_lshl_b32 s73, s73, 3
    s_add_u32 s73, s73, s74
    s_lshl_b32 s73, s73, 8
    s_add_u32 s73, s73, 98304
    v_add_u32 v4, s73, v4
    v_mul_f32 v144, s94, v144
    v_mul_f32 v145, s94, v145
    v_mul_f32 v146, s94, v146
    v_mul_f32 v147, s94, v147
    v_cvt_pk_bf16_f32 v144, v144, v145
    v_cvt_pk_bf16_f32 v145, v146, v147
    ds_write_b64 v4, v[144:145] offset:0
    v_mul_f32 v148, s94, v148
    v_mul_f32 v149, s94, v149
    v_mul_f32 v150, s94, v150
    v_mul_f32 v151, s94, v151
    v_cvt_pk_bf16_f32 v148, v148, v149
    v_cvt_pk_bf16_f32 v149, v150, v151
    ds_write_b64 v4, v[148:149] offset:1024
    v_mul_f32 v152, s94, v152
    v_mul_f32 v153, s94, v153
    v_mul_f32 v154, s94, v154
    v_mul_f32 v155, s94, v155
    v_cvt_pk_bf16_f32 v152, v152, v153
    v_cvt_pk_bf16_f32 v153, v154, v155
    ds_write_b64 v4, v[152:153] offset:12288
    v_mul_f32 v156, s94, v156
    v_mul_f32 v157, s94, v157
    v_mul_f32 v158, s94, v158
    v_mul_f32 v159, s94, v159
    v_cvt_pk_bf16_f32 v156, v156, v157
    v_cvt_pk_bf16_f32 v157, v158, v159
    ds_write_b64 v4, v[156:157] offset:13312
    v_mul_f32 v160, s94, v160
    v_mul_f32 v161, s94, v161
    v_mul_f32 v162, s94, v162
    v_mul_f32 v163, s94, v163
    v_cvt_pk_bf16_f32 v160, v160, v161
    v_cvt_pk_bf16_f32 v161, v162, v163
    ds_write_b64 v4, v[160:161] offset:24576
    v_mul_f32 v164, s94, v164
    v_mul_f32 v165, s94, v165
    v_mul_f32 v166, s94, v166
    v_mul_f32 v167, s94, v167
    v_cvt_pk_bf16_f32 v164, v164, v165
    v_cvt_pk_bf16_f32 v165, v166, v167
    ds_write_b64 v4, v[164:165] offset:25600
    v_mul_f32 v168, s94, v168
    v_mul_f32 v169, s94, v169
    v_mul_f32 v170, s94, v170
    v_mul_f32 v171, s94, v171
    v_cvt_pk_bf16_f32 v168, v168, v169
    v_cvt_pk_bf16_f32 v169, v170, v171
    ds_write_b64 v4, v[168:169] offset:36864
    ds_read_b32 v1, v7
    s_waitcnt lgkmcnt(0)
    s_mov_b32 s71, 4
    v_cmp_gt_i32 vcc, s71, v1
    s_cbranch_vccnz K1_gs71
K1_gs71b:
    s_waitcnt vmcnt(30)
    ds_write_b128 v8, v[172:175] offset:49152
    ds_write_b128 v8, v[176:179] offset:50176
    ds_write_b128 v8, v[180:183] offset:51200
    v_mov_b32 v3, 11
    ds_write_b32 v7, v3 offset:64
    s_memrealtime s[4:5]
    s_waitcnt vmcnt(6) lgkmcnt(0)
    s_lshl_b32 s4, s4, 4
    s_sub_u32 s4, s4, s83
    s_cmp_gt_i32 s4, 16224
    s_cbranch_scc1 K1_th72
    s_waitcnt vmcnt(3)
K1_th72:
    buffer_load_dwordx4 v[172:175], v52, s[52:55], s79 offen offset:0 nt
    buffer_load_dwordx4 v[176:179], v53, s[52:55], s79 offen offset:1024 nt
    buffer_load_dwordx4 v[180:183], v54, s[52:55], s79 offen offset:2048 nt
    s_add_u32 s79, s79, 12288
    s_cmp_eq_u32 s79, s88
    s_cselect_b32 s12, 196608, 0
    s_sub_u32 s79, s79, s12
    s_memrealtime s[4:5]
    s_waitcnt vmcnt(6) lgkmcnt(0)
    s_lshl_b32 s4, s4, 4
    s_sub_u32 s4, s4, s83
    s_cmp_gt_i32 s4, 16928
    s_cbranch_scc1 K1_th73
    s_waitcnt vmcnt(3)
K1_th73:
    buffer_load_dwordx4 v[160:163], v52, s[56:59], s80 offen offset:0 nt
    buffer_load_dwordx4 v[164:167], v53, s[56:59], s80 offen offset:1024 nt
    buffer_load_dwordx4 v[168:171], v54, s[56:59], s80 offen offset:2048 nt
    s_add_u32 s80, s80, 12288
    s_cmp_eq_u32 s80, s9
    s_cselect_b32 s12, 196608, 0
    s_sub_u32 s80, s80, s12
    s_memrealtime s[4:5]
    s_waitcnt vmcnt(6) lgkmcnt(0)
    s_lshl_b32 s4, s4, 4
    s_sub_u32 s4, s4, s83
    s_cmp_gt_i32 s4, 17632
    s_cbranch_scc1 K1_th74
    s_waitcnt vmcnt(3)
K1_th74:
    buffer_load_dwordx4 v[136:139], v52, s[52:55], s79 offen offset:0 nt
    buffer_load_dwordx4 v[140:143], v53, s[52:55], s79 offen offset:1024 nt
    buffer_load_dwordx4 v[144:147], v54, s[52:55], s79 offen offset:2048 nt
    s_add_u32 s79, s79, 12288
    s_cmp_eq_u32 s79, s88
    s_cselect_b32 s12, 196608, 0
    s_sub_u32 s79, s79, s12
    ds_read_b32 v1, v7
    s_waitcnt lgkmcnt(0)
    s_mov_b32 s71, 5
    v_cmp_gt_i32 vcc, s71, v1
    s_cbranch_vccnz K1_gs75
K1_gs75b:
    s_waitcnt vmcnt(36)
    ds_write_b128 v8, v[220:223] offset:36864
    ds_write_b128 v8, v[224:227] offset:37888
    ds_write_b128 v8, v[228:231] offset:38912
    v_mov_b32 v3, 12
    ds_write_b32 v7, v3 offset:64
    s_getreg_b32 s43, hwreg(HW_REG_XCC_ID, 0, 3)
    s_add_u32 s43, s43, s83
    s_cmp_eq_u32 s3, 4
    s_cbranch_scc0 K1_w76
    s_lshl_b32 s73, s91, 7
    s_add_u32 s73, s73, 0x3e00040
    v_mov_b32 v4, 0
    v_mov_b32 v5, s43
    s_mov_b64 exec, 1
    buffer_store_dword v5, v4, s[60:63], s73 offen offset:0 sc1
    s_mov_b64 exec, -1
K1_w76:
    ds_read_b32 v1, v7
    s_waitcnt lgkmcnt(0)
    s_mov_b32 s71, 6
    v_cmp_gt_i32 vcc, s71, v1
    s_cbranch_vccnz K1_gs77
K1_gs77b:
    s_waitcnt vmcnt(33)
    ds_write_b128 v9, v[76:79] offset:0
    ds_write_b128 v9, v[80:83] offset:1024
    ds_write_b128 v9, v[84:87] offset:2048
    v_mov_b32 v3, 13
    ds_write_b32 v7, v3 offset:64
    s_memrealtime s[4:5]
    s_waitcnt vmcnt(6) lgkmcnt(0)
    s_lshl_b32 s4, s4, 4
    s_sub_u32 s4, s4, s83
    s_cmp_gt_i32 s4, 18336
    s_cbranch_scc1 K1_th78
    s_waitcnt vmcnt(3)
K1_th78:
    buffer_load_dwordx4 v[220:223], v52, s[56:59], s80 offen offset:0 nt
    buffer_load_dwordx4 v[224:227], v53, s[56:59], s80 offen offset:1024 nt
    buffer_load_dwordx4 v[228:231], v54, s[56:59], s80 offen offset:2048 nt
    s_add_u32 s80, s80, 12288
    s_cmp_eq_u32 s80, s9
    s_cselect_b32 s12, 196608, 0
    s_sub_u32 s80, s80, s12
    ds_read_b32 v1, v7
    s_waitcnt lgkmcnt(0)
    s_mov_b32 s71, 7
    v_cmp_gt_i32 vcc, s71, v1
    s_cbranch_vccnz K1_gs79
K1_gs79b:
    s_waitcnt vmcnt(33)
    ds_write_b128 v8, v[232:235] offset:0
    ds_write_b128 v8, v[236:239] offset:1024
    ds_write_b128 v8, v[240:243] offset:2048
    v_mov_b32 v3, 14
    ds_write_b32 v7, v3 offset:64
    s_memrealtime s[4:5]
    s_waitcnt vmcnt(6) lgkmcnt(0)
    s_lshl_b32 s4, s4, 4
    s_sub_u32 s4, s4, s83
    s_cmp_gt_i32 s4, 19040
    s_cbranch_scc1 K1_th80
    s_waitcnt vmcnt(3)
K1_th80:
    buffer_load_dwordx4 v[76:79], v52, s[52:55], s79 offen offset:0 nt
    buffer_load_dwordx4 v[80:83], v53, s[52:55], s79 offen offset:1024 nt
    buffer_load_dwordx4 v[84:87], v54, s[52:55], s79 offen offset:2048 nt
    s_add_u32 s79, s79, 12288
    s_cmp_eq_u32 s79, s88
    s_cselect_b32 s12, 196608, 0
    s_sub_u32 s79, s79, s12
    ds_read_b32 v1, v7
    s_waitcnt lgkmcnt(0)
    s_mov_b32 s71, 8
    v_cmp_gt_i32 vcc, s71, v1
    s_cbranch_vccnz K1_gs81
K1_gs81b:
    s_waitcnt vmcnt(33)
    ds_write_b128 v9, v[244:247] offset:12288
    ds_write_b128 v9, v[248:251] offset:13312
    ds_write_b128 v9, v[252:255] offset:14336
    v_mov_b32 v3, 15
    ds_write_b32 v7, v3 offset:64
    s_memrealtime s[4:5]
    s_waitcnt vmcnt(6) lgkmcnt(0)
    s_lshl_b32 s4, s4, 4
    s_sub_u32 s4, s4, s83
    s_cmp_gt_i32 s4, 19744
    s_cbranch_scc1 K1_th82
    s_waitcnt vmcnt(3)
K1_th82:
    buffer_load_dwordx4 v[232:235], v52, s[56:59], s80 offen offset:0 nt
    buffer_load_dwordx4 v[236:239], v53, s[56:59], s80 offen offset:1024 nt
    buffer_load_dwordx4 v[240:243], v54, s[56:59], s80 offen offset:2048 nt
    s_add_u32 s80, s80, 12288
    s_cmp_eq_u32 s80, s9
    s_cselect_b32 s12, 196608, 0
    s_sub_u32 s80, s80, s12
    ds_read_b32 v1, v7
    s_waitcnt lgkmcnt(0)
    s_mov_b32 s71, 9
    v_cmp_gt_i32 vcc, s71, v1
    s_cbranch_vccnz K1_gs83
K1_gs83b:
    s_waitcnt vmcnt(33)
    ds_write_b128 v8, v[60:63] offset:12288
    ds_write_b128 v8, v[64:67] offset:13312
    ds_write_b128 v8, v[68:71] offset:14336
    v_mov_b32 v3, 16
    ds_write_b32 v7, v3 offset:64
    s_memrealtime s[4:5]
    s_waitcnt vmcnt(6) lgkmcnt(0)
    s_lshl_b32 s4, s4, 4
    s_sub_u32 s4, s4, s83
    s_cmp_gt_i32 s4, 20448
    s_cbranch_scc1 K1_th84
    s_waitcnt vmcnt(3)
K1_th84:
    buffer_load_dwordx4 v[60:63], v52, s[52:55], s79 offen offset:0 nt
    buffer_load_dwordx4 v[64:67], v53, s[52:55], s79 offen offset:1024 nt
    buffer_load_dwordx4 v[68:71], v54, s[52:55], s79 offen offset:2048 nt
    s_add_u32 s79, s79, 12288
    s_cmp_eq_u32 s79, s88
    s_cselect_b32 s12, 196608, 0
    s_sub_u32 s79, s79, s12
    ds_read_b32 v1, v7
    s_waitcnt lgkmcnt(0)
    s_mov_b32 s71, 10
    v_cmp_gt_i32 vcc, s71, v1
    s_cbranch_vccnz K1_gs85
K1_gs85b:
    s_waitcnt vmcnt(33)
    ds_write_b128 v9, v[20:23] offset:24576
    ds_write_b128 v9, v[24:27] offset:25600
    ds_write_b128 v9, v[28:31] offset:26624
    v_mov_b32 v3, 17
    ds_write_b32 v7, v3 offset:64
    s_memrealtime s[4:5]
    s_waitcnt vmcnt(6) lgkmcnt(0)
    s_lshl_b32 s4, s4, 4
    s_sub_u32 s4, s4, s83
    s_cmp_gt_i32 s4, 21152
    s_cbranch_scc1 K1_th86
    s_waitcnt vmcnt(3)
K1_th86:
    buffer_load_dwordx4 v[244:247], v52, s[56:59], s80 offen offset:0 nt
    buffer_load_dwordx4 v[248:251], v53, s[56:59], s80 offen offset:1024 nt
    buffer_load_dwordx4 v[252:255], v54, s[56:59], s80 offen offset:2048 nt
    s_add_u32 s80, s80, 12288
    s_cmp_eq_u32 s80, s9
    s_cselect_b32 s12, 196608, 0
    s_sub_u32 s80, s80, s12
    s_lshr_b32 s73, s81, 4
    s_mov_b32 s74, 2731
    v_add_u32 v3, s73, v0
    v_mul_lo_u32 v4, v3, s74
    v_lshrrev_b32 v4, 16, v4
    v_and_b32 v5, 2, v4
    v_lshlrev_b32 v5, 1, v5
    v_bfe_u32 v6, v4, 2, 2
    v_or_b32 v5, v5, v6
    v_and_b32 v5, 6, v4
    v_mul_u32_u24 v6, 24, v4
    v_sub_u32 v6, v3, v6
    v_xor_b32 v6, v6, v5
    v_add_u32 v3, 12, v6
    v_and_b32 v3, 32, v3
    v_lshl_or_b32 v6, v3, 21, v6
    v_lshlrev_b32 v6, 4, v6
    v_mul_u32_u24 v5, 0x500, v4
    v_add_u32 v56, v5, v6
    v_add_u32 v3, s73, v0
    v_add_u32 v3, 64, v3
    v_mul_lo_u32 v4, v3, s74
    v_lshrrev_b32 v4, 16, v4
    v_and_b32 v5, 2, v4
    v_lshlrev_b32 v5, 1, v5
    v_bfe_u32 v6, v4, 2, 2
    v_or_b32 v5, v5, v6
    v_and_b32 v5, 6, v4
    v_mul_u32_u24 v6, 24, v4
    v_sub_u32 v6, v3, v6
    v_xor_b32 v6, v6, v5
    v_add_u32 v3, 12, v6
    v_and_b32 v3, 32, v3
    v_lshl_or_b32 v6, v3, 21, v6
    v_lshlrev_b32 v6, 4, v6
    v_subrev_u32 v6, 1024, v6
    v_mul_u32_u24 v5, 0x500, v4
    v_add_u32 v57, v5, v6
    v_add_u32 v3, s73, v0
    v_add_u32 v3, 128, v3
    v_mul_lo_u32 v4, v3, s74
    v_lshrrev_b32 v4, 16, v4
    v_and_b32 v5, 2, v4
    v_lshlrev_b32 v5, 1, v5
    v_bfe_u32 v6, v4, 2, 2
    v_or_b32 v5, v5, v6
    v_and_b32 v5, 6, v4
    v_mul_u32_u24 v6, 24, v4
    v_sub_u32 v6, v3, v6
    v_xor_b32 v6, v6, v5
    v_add_u32 v3, 12, v6
    v_and_b32 v3, 32, v3
    v_lshl_or_b32 v6, v3, 21, v6
    v_lshlrev_b32 v6, 4, v6
    v_subrev_u32 v6, 2048, v6
    v_mul_u32_u24 v5, 0x500, v4
    v_add_u32 v58, v5, v6
    v_lshrrev_b32 v2, 2, v0
    v_mul_u32_u24 v3, 0x180, v2
    v_and_b32 v2, 6, v2
    v_and_b32 v4, 3, v0
    v_lshl_add_u32 v2, v2, 1, v4
    v_lshl_add_u32 v3, v2, 3, v3
    v_add_u32 v16, 0xf000, v3
    v_xor_b32 v17, 32, v16
    v_xor_b32 v18, 64, v16
    v_xor_b32 v19, 96, v16
    v_add_u32 v12, 0x9000, v16
    v_add_u32 v13, 0x9000, v17
    v_add_u32 v14, 0x9000, v18
    v_add_u32 v15, 0x9000, v19
    s_lshr_b32 s73, s78, 2
    v_lshlrev_b32 v46, 4, v0
    v_add_u32 v46, s73, v46
    ds_read_b32 v1, v7
    s_waitcnt lgkmcnt(0)
    s_mov_b32 s71, 11
    v_cmp_gt_i32 vcc, s71, v1
    s_cbranch_vccnz K1_gs87
K1_gs87b:
    s_waitcnt vmcnt(33)
    ds_write_b128 v8, v[32:35] offset:24576
    ds_write_b128 v8, v[36:39] offset:25600
    ds_write_b128 v8, v[40:43] offset:26624
    v_mov_b32 v3, 18
    ds_write_b32 v7, v3 offset:64
    s_memrealtime s[4:5]
    s_waitcnt vmcnt(6) lgkmcnt(0)
    s_lshl_b32 s4, s4, 4
    s_sub_u32 s4, s4, s83
    s_cmp_gt_i32 s4, 21856
    s_cbranch_scc1 K1_th88
    s_waitcnt vmcnt(3)
K1_th88:
    buffer_load_dwordx4 v[20:23], v52, s[56:59], s80 offen offset:0 nt
    buffer_load_dwordx4 v[24:27], v53, s[56:59], s80 offen offset:1024 nt
    buffer_load_dwordx4 v[28:31], v54, s[56:59], s80 offen offset:2048 nt
    s_add_u32 s80, s80, 12288
    s_cmp_eq_u32 s80, s9
    s_cselect_b32 s12, 196608, 0
    s_sub_u32 s80, s80, s12
    ds_read_b32 v1, v7
    s_waitcnt lgkmcnt(0)
    s_mov_b32 s71, 12
    v_cmp_gt_i32 vcc, s71, v1
    s_cbranch_vccnz K1_gs89
K1_gs89b:
    s_waitcnt vmcnt(33)
    ds_write_b128 v8, v[184:187] offset:49152
    ds_write_b128 v8, v[188:191] offset:50176
    ds_write_b128 v8, v[192:195] offset:51200
    v_mov_b32 v3, 19
    ds_write_b32 v7, v3 offset:64
    s_memrealtime s[4:5]
    s_waitcnt vmcnt(6) lgkmcnt(0)
    s_lshl_b32 s4, s4, 4
    s_sub_u32 s4, s4, s83
    s_cmp_gt_i32 s4, 22560
    s_cbranch_scc1 K1_th90
    s_waitcnt vmcnt(3)
K1_th90:
    buffer_load_dwordx4 v[184:187], v52, s[56:59], s80 offen offset:0 nt
    buffer_load_dwordx4 v[188:191], v53, s[56:59], s80 offen offset:1024 nt
    buffer_load_dwordx4 v[192:195], v54, s[56:59], s80 offen offset:2048 nt
    s_add_u32 s80, s80, 12288
    s_cmp_eq_u32 s80, s9
    s_cselect_b32 s12, 196608, 0
    s_sub_u32 s80, s80, s12
    ds_read_b32 v1, v7
    s_waitcnt lgkmcnt(0)
    s_mov_b32 s71, 13
    v_cmp_gt_i32 vcc, s71, v1
    s_cbranch_vccnz K1_gs91
K1_gs91b:
    s_waitcnt vmcnt(33)
    ds_write_b128 v8, v[196:199] offset:36864
    ds_write_b128 v8, v[200:203] offset:37888
    ds_write_b128 v8, v[204:207] offset:38912
    v_mov_b32 v3, 20
    ds_write_b32 v7, v3 offset:64
    ds_read_b32 v1, v7
    s_waitcnt lgkmcnt(0)
    s_mov_b32 s71, 14
    v_cmp_gt_i32 vcc, s71, v1
    s_cbranch_vccnz K1_gs92
K1_gs92b:
    s_waitcnt vmcnt(30)
    ds_write_b128 v9, v[208:211] offset:0
    ds_write_b128 v9, v[212:215] offset:1024
    ds_write_b128 v9, v[216:219] offset:2048
    v_mov_b32 v3, 21
    ds_write_b32 v7, v3 offset:64
    s_memrealtime s[4:5]
    s_waitcnt vmcnt(6) lgkmcnt(0)
    s_lshl_b32 s4, s4, 4
    s_sub_u32 s4, s4, s83
    s_cmp_gt_i32 s4, 23264
    s_cbranch_scc1 K1_th93
    s_waitcnt vmcnt(3)
K1_th93:
    s_add_u32 s79, s79, 196608
    s_add_u32 s88, s88, 196608
    buffer_load_dwordx4 v[196:199], v52, s[52:55], s79 offen offset:0 nt
    buffer_load_dwordx4 v[200:203], v53, s[52:55], s79 offen offset:1024 nt
    buffer_load_dwordx4 v[204:207], v54, s[52:55], s79 offen offset:2048 nt
    s_add_u32 s79, s79, 12288
    s_cmp_eq_u32 s79, s88
    s_cselect_b32 s12, 196608, 0
    s_sub_u32 s79, s79, s12
    ds_read_b32 v1, v7
    s_waitcnt lgkmcnt(0)
    s_mov_b32 s71, 15
    v_cmp_gt_i32 vcc, s71, v1
    s_cbranch_vccnz K1_gs94
K1_gs94b:
    s_waitcnt vmcnt(30)
    ds_write_b128 v8, v[172:175] offset:0
    ds_write_b128 v8, v[176:179] offset:1024
    ds_write_b128 v8, v[180:183] offset:2048
    v_mov_b32 v3, 22
    ds_write_b32 v7, v3 offset:64
    s_memrealtime s[4:5]
    s_waitcnt vmcnt(6) lgkmcnt(0)
    s_lshl_b32 s4, s4, 4
    s_sub_u32 s4, s4, s83
    s_cmp_gt_i32 s4, 23968
    s_cbranch_scc1 K1_th95
    s_waitcnt vmcnt(3)
K1_th95:
    buffer_load_dwordx4 v[208:211], v52, s[52:55], s79 offen offset:0 nt
    buffer_load_dwordx4 v[212:215], v53, s[52:55], s79 offen offset:1024 nt
    buffer_load_dwordx4 v[216:219], v54, s[52:55], s79 offen offset:2048 nt
    s_add_u32 s79, s79, 12288
    s_cmp_eq_u32 s79, s88
    s_cselect_b32 s12, 196608, 0
    s_sub_u32 s79, s79, s12
    ds_read_b32 v1, v7
    s_waitcnt lgkmcnt(0)
    s_mov_b32 s71, 16
    v_cmp_gt_i32 vcc, s71, v1
    s_cbranch_vccnz K1_gs96
K1_gs96b:
    s_waitcnt vmcnt(30)
    ds_write_b128 v9, v[160:163] offset:12288
    ds_write_b128 v9, v[164:167] offset:13312
    ds_write_b128 v9, v[168:171] offset:14336
    v_mov_b32 v3, 23
    ds_write_b32 v7, v3 offset:64
    s_memrealtime s[4:5]
    s_waitcnt vmcnt(6) lgkmcnt(0)
    s_lshl_b32 s4, s4, 4
    s_sub_u32 s4, s4, s83
    s_cmp_gt_i32 s4, 24672
    s_cbranch_scc1 K1_th97
    s_waitcnt vmcnt(3)
K1_th97:
    buffer_load_dwordx4 v[172:175], v52, s[52:55], s79 offen offset:0 nt
    buffer_load_dwordx4 v[176:179], v53, s[52:55], s79 offen offset:1024 nt
    buffer_load_dwordx4 v[180:183], v54, s[52:55], s79 offen offset:2048 nt
    s_add_u32 s79, s79, 12288
    s_cmp_eq_u32 s79, s88
    s_cselect_b32 s12, 196608, 0
    s_sub_u32 s79, s79, s12
    ds_read_b32 v1, v7
    s_waitcnt lgkmcnt(0)
    s_mov_b32 s71, 17
    v_cmp_gt_i32 vcc, s71, v1
    s_cbranch_vccnz K1_gs98
K1_gs98b:
    s_waitcnt vmcnt(30)
    ds_write_b128 v8, v[136:139] offset:12288
    ds_write_b128 v8, v[140:143] offset:13312
    ds_write_b128 v8, v[144:147] offset:14336
    v_mov_b32 v3, 24
    ds_write_b32 v7, v3 offset:64
    s_memrealtime s[4:5]
    s_waitcnt vmcnt(6) lgkmcnt(0)
    s_lshl_b32 s4, s4, 4
    s_sub_u32 s4, s4, s83
    s_cmp_gt_i32 s4, 25376
    s_cbranch_scc1 K1_th99
    s_waitcnt vmcnt(3)
K1_th99:
    s_add_u32 s80, s80, 196608
    s_add_u32 s9, s9, 196608
    buffer_load_dwordx4 v[160:163], v52, s[56:59], s80 offen offset:0 nt
    buffer_load_dwordx4 v[164:167], v53, s[56:59], s80 offen offset:1024 nt
    buffer_load_dwordx4 v[168:171], v54, s[56:59], s80 offen offset:2048 nt
    s_add_u32 s80, s80, 12288
    s_cmp_eq_u32 s80, s9
    s_cselect_b32 s12, 196608, 0
    s_sub_u32 s80, s80, s12
    ds_read_b32 v1, v7
    s_waitcnt lgkmcnt(0)
    s_mov_b32 s71, 18
    v_cmp_gt_i32 vcc, s71, v1
    s_cbranch_vccnz K1_gs100
K1_gs100b:
    s_waitcnt vmcnt(30)
    ds_write_b128 v9, v[220:223] offset:24576
    ds_write_b128 v9, v[224:227] offset:25600
    ds_write_b128 v9, v[228:231] offset:26624
    v_mov_b32 v3, 25
    ds_write_b32 v7, v3 offset:64
    s_memrealtime s[4:5]
    s_waitcnt vmcnt(6) lgkmcnt(0)
    s_lshl_b32 s4, s4, 4
    s_sub_u32 s4, s4, s83
    s_cmp_gt_i32 s4, 26080
    s_cbranch_scc1 K1_th101
    s_waitcnt vmcnt(3)
K1_th101:
    buffer_load_dwordx4 v[220:223], v52, s[52:55], s79 offen offset:0 nt
    buffer_load_dwordx4 v[224:227], v53, s[52:55], s79 offen offset:1024 nt
    buffer_load_dwordx4 v[228:231], v54, s[52:55], s79 offen offset:2048 nt
    s_add_u32 s79, s79, 12288
    s_cmp_eq_u32 s79, s88
    s_cselect_b32 s12, 196608, 0
    s_sub_u32 s79, s79, s12
    ds_read_b32 v1, v7
    s_waitcnt lgkmcnt(0)
    s_mov_b32 s71, 19
    v_cmp_gt_i32 vcc, s71, v1
    s_cbranch_vccnz K1_gs102
K1_gs102b:
    s_waitcnt vmcnt(30)
    ds_write_b128 v8, v[76:79] offset:24576
    ds_write_b128 v8, v[80:83] offset:25600
    ds_write_b128 v8, v[84:87] offset:26624
    v_mov_b32 v3, 26
    ds_write_b32 v7, v3 offset:64
    s_memrealtime s[4:5]
    s_waitcnt vmcnt(6) lgkmcnt(0)
    s_lshl_b32 s4, s4, 4
    s_sub_u32 s4, s4, s83
    s_cmp_gt_i32 s4, 26784
    s_cbranch_scc1 K1_th103
    s_waitcnt vmcnt(3)
K1_th103:
    buffer_load_dwordx4 v[76:79], v52, s[56:59], s80 offen offset:0 nt
    buffer_load_dwordx4 v[80:83], v53, s[56:59], s80 offen offset:1024 nt
    buffer_load_dwordx4 v[84:87], v54, s[56:59], s80 offen offset:2048 nt
    s_add_u32 s80, s80, 12288
    s_cmp_eq_u32 s80, s9
    s_cselect_b32 s12, 196608, 0
    s_sub_u32 s80, s80, s12
    ds_read_b32 v1, v7
    s_waitcnt lgkmcnt(0)
    s_mov_b32 s71, 20
    v_cmp_gt_i32 vcc, s71, v1
    s_cbranch_vccnz K1_gs104
K1_gs104b:
    s_waitcnt vmcnt(30)
    ds_write_b128 v8, v[232:235] offset:49152
    ds_write_b128 v8, v[236:239] offset:50176
    ds_write_b128 v8, v[240:243] offset:51200
    v_mov_b32 v3, 27
    ds_write_b32 v7, v3 offset:64
    s_memrealtime s[4:5]
    s_waitcnt vmcnt(6) lgkmcnt(0)
    s_lshl_b32 s4, s4, 4
    s_sub_u32 s4, s4, s83
    s_cmp_gt_i32 s4, 27488
    s_cbranch_scc1 K1_th105
    s_waitcnt vmcnt(3)
K1_th105:
    buffer_load_dwordx4 v[232:235], v52, s[52:55], s79 offen offset:0 nt
    buffer_load_dwordx4 v[236:239], v53, s[52:55], s79 offen offset:1024 nt
    buffer_load_dwordx4 v[240:243], v54, s[52:55], s79 offen offset:2048 nt
    s_add_u32 s79, s79, 12288
    s_cmp_eq_u32 s79, s88
    s_cselect_b32 s12, 196608, 0
    s_sub_u32 s79, s79, s12
    ds_read_b32 v1, v7
    s_waitcnt lgkmcnt(0)
    s_mov_b32 s71, 21
    v_cmp_gt_i32 vcc, s71, v1
    s_cbranch_vccnz K1_gs106
K1_gs106b:
    s_waitcnt vmcnt(30)
    ds_write_b128 v8, v[60:63] offset:36864
    ds_write_b128 v8, v[64:67] offset:37888
    ds_write_b128 v8, v[68:71] offset:38912
    v_mov_b32 v3, 28
    ds_write_b32 v7, v3 offset:64
    s_memrealtime s[4:5]
    s_waitcnt vmcnt(6) lgkmcnt(0)
    s_lshl_b32 s4, s4, 4
    s_sub_u32 s4, s4, s83
    s_cmp_gt_i32 s4, 28192
    s_cbranch_scc1 K1_th107
    s_waitcnt vmcnt(3)
K1_th107:
    buffer_load_dwordx4 v[60:63], v52, s[56:59], s80 offen offset:0 nt
    buffer_load_dwordx4 v[64:67], v53, s[56:59], s80 offen offset:1024 nt
    buffer_load_dwordx4 v[68:71], v54, s[56:59], s80 offen offset:2048 nt
    s_add_u32 s80, s80, 12288
    s_cmp_eq_u32 s80, s9
    s_cselect_b32 s12, 196608, 0
    s_sub_u32 s80, s80, s12
    ds_read_b32 v1, v7
    s_waitcnt lgkmcnt(0)
    s_mov_b32 s71, 22
    v_cmp_gt_i32 vcc, s71, v1
    s_cbranch_vccnz K1_gs108
K1_gs108b:
    s_waitcnt vmcnt(30)
    ds_write_b128 v9, v[244:247] offset:0
    ds_write_b128 v9, v[248:251] offset:1024
    ds_write_b128 v9, v[252:255] offset:2048
    v_mov_b32 v3, 29
    ds_write_b32 v7, v3 offset:64
    ds_read_b32 v1, v7
    s_waitcnt lgkmcnt(0)
    s_mov_b32 s71, 24
    v_cmp_gt_i32 vcc, s71, v1
    s_cbranch_vccnz K1_gs109
K1_gs109b:
    s_waitcnt vmcnt(27)
    ds_write_b128 v9, v[20:23] offset:12288
    ds_write_b128 v9, v[24:27] offset:13312
    ds_write_b128 v9, v[28:31] offset:14336
    v_mov_b32 v3, 30
    ds_write_b32 v7, v3 offset:64
    s_memrealtime s[4:5]
    s_waitcnt vmcnt(6) lgkmcnt(0)
    s_lshl_b32 s4, s4, 4
    s_sub_u32 s4, s4, s83
    s_cmp_gt_i32 s4, 28896
    s_cbranch_scc1 K1_th110
    s_waitcnt vmcnt(3)
K1_th110:
    buffer_load_dwordx4 v[244:247], v52, s[52:55], s79 offen offset:0 nt
    buffer_load_dwordx4 v[248:251], v53, s[52:55], s79 offen offset:1024 nt
    buffer_load_dwordx4 v[252:255], v54, s[52:55], s79 offen offset:2048 nt
    s_add_u32 s79, s79, 12288
    s_cmp_eq_u32 s79, s88
    s_cselect_b32 s12, 196608, 0
    s_sub_u32 s79, s79, s12
    ds_read_b32 v1, v7
    s_waitcnt lgkmcnt(0)
    s_mov_b32 s71, 26
    v_cmp_gt_i32 vcc, s71, v1
    s_cbranch_vccnz K1_gs111
K1_gs111b:
    s_waitcnt vmcnt(27)
    ds_write_b128 v9, v[184:187] offset:24576
    ds_write_b128 v9, v[188:191] offset:25600
    ds_write_b128 v9, v[192:195] offset:26624
    v_mov_b32 v3, 31
    ds_write_b32 v7, v3 offset:64
    s_memrealtime s[4:5]
    s_waitcnt vmcnt(6) lgkmcnt(0)
    s_lshl_b32 s4, s4, 4
    s_sub_u32 s4, s4, s83
    s_cmp_gt_i32 s4, 29600
    s_cbranch_scc1 K1_th112
    s_waitcnt vmcnt(3)
K1_th112:
    buffer_load_dwordx4 v[20:23], v52, s[56:59], s80 offen offset:0 nt
    buffer_load_dwordx4 v[24:27], v53, s[56:59], s80 offen offset:1024 nt
    buffer_load_dwordx4 v[28:31], v54, s[56:59], s80 offen offset:2048 nt
    s_add_u32 s80, s80, 12288
    s_cmp_eq_u32 s80, s9
    s_cselect_b32 s12, 196608, 0
    s_sub_u32 s80, s80, s12
    s_waitcnt vmcnt(27)
    ds_write_b128 v8, v[196:199] offset:0
    ds_write_b128 v8, v[200:203] offset:1024
    ds_write_b128 v8, v[204:207] offset:2048
    v_mov_b32 v3, 32
    ds_write_b32 v7, v3 offset:64
    s_memrealtime s[4:5]
    s_waitcnt vmcnt(6) lgkmcnt(0)
    s_lshl_b32 s4, s4, 4
    s_sub_u32 s4, s4, s83
    s_cmp_gt_i32 s4, 30304
    s_cbranch_scc1 K1_th113
    s_waitcnt vmcnt(3)
K1_th113:
    buffer_load_dwordx4 v[32:35], v52, s[52:55], s79 offen offset:0 nt
    buffer_load_dwordx4 v[36:39], v53, s[52:55], s79 offen offset:1024 nt
    buffer_load_dwordx4 v[40:43], v54, s[52:55], s79 offen offset:2048 nt
    s_add_u32 s79, s79, 12288
    s_cmp_eq_u32 s79, s88
    s_cselect_b32 s12, 196608, 0
    s_sub_u32 s79, s79, s12
K1_G_r2:
    s_waitcnt vmcnt(27)
    ds_write_b128 v8, v[208:211] offset:12288
    ds_write_b128 v8, v[212:215] offset:13312
    ds_write_b128 v8, v[216:219] offset:14336
    v_mov_b32 v3, 33
    ds_write_b32 v7, v3 offset:64
    s_memrealtime s[4:5]
    s_waitcnt vmcnt(6) lgkmcnt(0)
    s_lshl_b32 s4, s4, 4
    s_sub_u32 s4, s4, s83
    s_cmp_gt_i32 s4, 31008
    s_cbranch_scc1 K1_th114
    s_waitcnt vmcnt(3)
K1_th114:
    buffer_load_dwordx4 v[136:139], v52, s[56:59], s80 offen offset:0 nt
    buffer_load_dwordx4 v[140:143], v53, s[56:59], s80 offen offset:1024 nt
    buffer_load_dwordx4 v[144:147], v54, s[56:59], s80 offen offset:2048 nt
    s_add_u32 s80, s80, 12288
    s_cmp_eq_u32 s80, s9
    s_cselect_b32 s12, 196608, 0
    s_sub_u32 s80, s80, s12
    ds_read_b32 v1, v7
    s_waitcnt lgkmcnt(0)
    s_mov_b32 s71, 27
    v_cmp_gt_i32 vcc, s71, v1
    s_cbranch_vccnz K1_gs115
K1_gs115b:
    s_waitcnt vmcnt(27)
    ds_write_b128 v8, v[172:175] offset:24576
    ds_write_b128 v8, v[176:179] offset:25600
    ds_write_b128 v8, v[180:183] offset:26624
    v_mov_b32 v3, 34
    ds_write_b32 v7, v3 offset:64
    s_memrealtime s[4:5]
    s_waitcnt vmcnt(6) lgkmcnt(0)
    s_lshl_b32 s4, s4, 4
    s_sub_u32 s4, s4, s83
    s_cmp_gt_i32 s4, 31712
    s_cbranch_scc1 K1_th116
    s_waitcnt vmcnt(3)
K1_th116:
    buffer_load_dwordx4 v[148:151], v52, s[52:55], s79 offen offset:0 nt
    buffer_load_dwordx4 v[152:155], v53, s[52:55], s79 offen offset:1024 nt
    buffer_load_dwordx4 v[156:159], v54, s[52:55], s79 offen offset:2048 nt
    s_add_u32 s79, s79, 12288
    s_cmp_eq_u32 s79, s88
    s_cselect_b32 s12, 196608, 0
    s_sub_u32 s79, s79, s12
    ds_read_b32 v1, v7
    s_waitcnt lgkmcnt(0)
    s_mov_b32 s71, 28
    v_cmp_gt_i32 vcc, s71, v1
    s_cbranch_vccnz K1_gs117
K1_gs117b:
    s_waitcnt vmcnt(27)
    ds_write_b128 v8, v[160:163] offset:49152
    ds_write_b128 v8, v[164:167] offset:50176
    ds_write_b128 v8, v[168:171] offset:51200
    v_mov_b32 v3, 35
    ds_write_b32 v7, v3 offset:64
    s_memrealtime s[4:5]
    s_waitcnt vmcnt(6) lgkmcnt(0)
    s_lshl_b32 s4, s4, 4
    s_sub_u32 s4, s4, s83
    s_cmp_gt_i32 s4, 32416
    s_cbranch_scc1 K1_th118
    s_waitcnt vmcnt(3)
K1_th118:
    buffer_load_dwordx4 v[88:91], v52, s[56:59], s80 offen offset:0 nt
    buffer_load_dwordx4 v[92:95], v53, s[56:59], s80 offen offset:1024 nt
    buffer_load_dwordx4 v[96:99], v54, s[56:59], s80 offen offset:2048 nt
    s_add_u32 s80, s80, 12288
    s_cmp_eq_u32 s80, s9
    s_cselect_b32 s12, 196608, 0
    s_sub_u32 s80, s80, s12
    ds_read_b32 v1, v7
    s_waitcnt lgkmcnt(0)
    s_mov_b32 s71, 29
    v_cmp_gt_i32 vcc, s71, v1
    s_cbranch_vccnz K1_gs119
K1_gs119b:
    s_waitcnt vmcnt(27)
    ds_write_b128 v8, v[220:223] offset:36864
    ds_write_b128 v8, v[224:227] offset:37888
    ds_write_b128 v8, v[228:231] offset:38912
    v_mov_b32 v3, 36
    ds_write_b32 v7, v3 offset:64
    s_memrealtime s[4:5]
    s_waitcnt vmcnt(6) lgkmcnt(0)
    s_lshl_b32 s4, s4, 4
    s_sub_u32 s4, s4, s83
    s_cmp_gt_i32 s4, 33120
    s_cbranch_scc1 K1_th120
    s_waitcnt vmcnt(3)
K1_th120:
    buffer_load_dwordx4 v[220:223], v52, s[52:55], s79 offen offset:0 nt
    buffer_load_dwordx4 v[224:227], v53, s[52:55], s79 offen offset:1024 nt
    buffer_load_dwordx4 v[228:231], v54, s[52:55], s79 offen offset:2048 nt
    s_add_u32 s79, s79, 12288
    s_cmp_eq_u32 s79, s88
    s_cselect_b32 s12, 196608, 0
    s_sub_u32 s79, s79, s12
    ds_read_b32 v1, v7
    s_waitcnt lgkmcnt(0)
    s_mov_b32 s71, 30
    v_cmp_gt_i32 vcc, s71, v1
    s_cbranch_vccnz K1_gs121
K1_gs121b:
    s_waitcnt vmcnt(27)
    ds_write_b128 v9, v[76:79] offset:0
    ds_write_b128 v9, v[80:83] offset:1024
    ds_write_b128 v9, v[84:87] offset:2048
    v_mov_b32 v3, 37
    ds_write_b32 v7, v3 offset:64
    s_memrealtime s[4:5]
    s_waitcnt vmcnt(6) lgkmcnt(0)
    s_lshl_b32 s4, s4, 4
    s_sub_u32 s4, s4, s83
    s_cmp_gt_i32 s4, 33824
    s_cbranch_scc1 K1_th122
    s_waitcnt vmcnt(3)
K1_th122:
    buffer_load_dwordx4 v[76:79], v52, s[56:59], s80 offen offset:0 nt
    buffer_load_dwordx4 v[80:83], v53, s[56:59], s80 offen offset:1024 nt
    buffer_load_dwordx4 v[84:87], v54, s[56:59], s80 offen offset:2048 nt
    s_add_u32 s80, s80, 12288
    s_cmp_eq_u32 s80, s9
    s_cselect_b32 s12, 196608, 0
    s_sub_u32 s80, s80, s12
    ds_read_b32 v1, v7
    s_waitcnt lgkmcnt(0)
    s_mov_b32 s71, 33
    v_cmp_gt_i32 vcc, s71, v1
    s_cbranch_vccnz K1_gs123
K1_gs123b:
    s_waitcnt vmcnt(27)
    ds_write_b128 v8, v[232:235] offset:0
    ds_write_b128 v8, v[236:239] offset:1024
    ds_write_b128 v8, v[240:243] offset:2048
    v_mov_b32 v3, 38
    ds_write_b32 v7, v3 offset:64
    s_waitcnt vmcnt(24)
    ds_write_b128 v9, v[60:63] offset:12288
    ds_write_b128 v9, v[64:67] offset:13312
    ds_write_b128 v9, v[68:71] offset:14336
    v_mov_b32 v3, 39
    ds_write_b32 v7, v3 offset:64
    s_memrealtime s[4:5]
    s_waitcnt vmcnt(6) lgkmcnt(0)
    s_lshl_b32 s4, s4, 4
    s_sub_u32 s4, s4, s83
    s_cmp_gt_i32 s4, 34528
    s_cbranch_scc1 K1_th124
    s_waitcnt vmcnt(3)
K1_th124:
    buffer_load_dwordx4 v[232:235], v52, s[52:55], s79 offen offset:0 nt
    buffer_load_dwordx4 v[236:239], v53, s[52:55], s79 offen offset:1024 nt
    buffer_load_dwordx4 v[240:243], v54, s[52:55], s79 offen offset:2048 nt
    s_add_u32 s79, s79, 12288
    s_cmp_eq_u32 s79, s88
    s_cselect_b32 s12, 196608, 0
    s_sub_u32 s79, s79, s12
    ds_read_b32 v1, v7
    s_waitcnt lgkmcnt(0)
    s_mov_b32 s71, 34
    v_cmp_gt_i32 vcc, s71, v1
    s_cbranch_vccnz K1_gs125
K1_gs125b:
    s_waitcnt vmcnt(24)
    ds_write_b128 v8, v[244:247] offset:12288
    ds_write_b128 v8, v[248:251] offset:13312
    ds_write_b128 v8, v[252:255] offset:14336
    v_mov_b32 v3, 40
    ds_write_b32 v7, v3 offset:64
    s_memrealtime s[4:5]
    s_waitcnt vmcnt(6) lgkmcnt(0)
    s_lshl_b32 s4, s4, 4
    s_sub_u32 s4, s4, s83
    s_cmp_gt_i32 s4, 35232
    s_cbranch_scc1 K1_th126
    s_waitcnt vmcnt(3)
K1_th126:
    buffer_load_dwordx4 v[244:247], v52, s[56:59], s80 offen offset:0 nt
    buffer_load_dwordx4 v[248:251], v53, s[56:59], s80 offen offset:1024 nt
    buffer_load_dwordx4 v[252:255], v54, s[56:59], s80 offen offset:2048 nt
    s_add_u32 s80, s80, 12288
    s_cmp_eq_u32 s80, s9
    s_cselect_b32 s12, 196608, 0
    s_sub_u32 s80, s80, s12
    s_lshl_b32 s73, s15, 11
    s_sub_u32 s74, 6144, s73
    v_add_u32 v4, s73, v10
    v_add_u32 v5, s74, v10
    ds_read_b128 v[168:171], v4 offset:0
    ds_read_b128 v[172:175], v4 offset:1024
    ds_read_b128 v[176:179], v4 offset:2048
    ds_read_b128 v[180:183], v4 offset:3072
    ds_read_b128 v[184:187], v4 offset:4096
    ds_read_b128 v[188:191], v4 offset:5120
    ds_read_b128 v[192:195], v5 offset:0
    ds_read_b128 v[196:199], v5 offset:1024
    ds_read_b128 v[200:203], v5 offset:2048
    ds_read_b128 v[204:207], v5 offset:3072
    ds_read_b128 v[208:211], v5 offset:4096
    ds_read_b128 v[212:215], v5 offset:5120
    s_waitcnt lgkmcnt(0)
    s_waitcnt vmcnt(24)
    ds_write_b128 v9, v[20:23] offset:24576
    ds_write_b128 v9, v[24:27] offset:25600
    ds_write_b128 v9, v[28:31] offset:26624
    v_mov_b32 v3, 41
    ds_write_b32 v7, v3 offset:64
    s_memrealtime s[4:5]
    s_waitcnt vmcnt(6) lgkmcnt(0)
    s_lshl_b32 s4, s4, 4
    s_sub_u32 s4, s4, s83
    s_cmp_gt_i32 s4, 35936
    s_cbranch_scc1 K1_th127
    s_waitcnt vmcnt(3)
K1_th127:
    buffer_load_dwordx4 v[20:23], v52, s[52:55], s79 offen offset:0 nt
    buffer_load_dwordx4 v[24:27], v53, s[52:55], s79 offen offset:1024 nt
    buffer_load_dwordx4 v[28:31], v54, s[52:55], s79 offen offset:2048 nt
    s_add_u32 s79, s79, 12288
    s_cmp_eq_u32 s79, s88
    s_cselect_b32 s12, 196608, 0
    s_sub_u32 s79, s79, s12
    ds_read_b32 v1, v7
    s_waitcnt lgkmcnt(0)
    s_mov_b32 s71, 35
    v_cmp_gt_i32 vcc, s71, v1
    s_cbranch_vccnz K1_gs128
K1_gs128b:
    s_waitcnt vmcnt(24)
    ds_write_b128 v8, v[32:35] offset:24576
    ds_write_b128 v8, v[36:39] offset:25600
    ds_write_b128 v8, v[40:43] offset:26624
    v_mov_b32 v3, 42
    ds_write_b32 v7, v3 offset:64
    s_memrealtime s[4:5]
    s_waitcnt vmcnt(6) lgkmcnt(0)
    s_lshl_b32 s4, s4, 4
    s_sub_u32 s4, s4, s83
    s_cmp_gt_i32 s4, 36640
    s_cbranch_scc1 K1_th129
    s_waitcnt vmcnt(3)
K1_th129:
    buffer_load_dwordx4 v[32:35], v52, s[56:59], s80 offen offset:0 nt
    buffer_load_dwordx4 v[36:39], v53, s[56:59], s80 offen offset:1024 nt
    buffer_load_dwordx4 v[40:43], v54, s[56:59], s80 offen offset:2048 nt
    s_add_u32 s80, s80, 12288
    s_cmp_eq_u32 s80, s9
    s_cselect_b32 s12, 196608, 0
    s_sub_u32 s80, s80, s12
    ds_read_b32 v1, v7
    s_waitcnt lgkmcnt(0)
    s_mov_b32 s71, 36
    v_cmp_gt_i32 vcc, s71, v1
    s_cbranch_vccnz K1_gs130
K1_gs130b:
    s_waitcnt vmcnt(24)
    ds_write_b128 v8, v[136:139] offset:49152
    ds_write_b128 v8, v[140:143] offset:50176
    ds_write_b128 v8, v[144:147] offset:51200
    v_mov_b32 v3, 43
    ds_write_b32 v7, v3 offset:64
    s_memrealtime s[4:5]
    s_waitcnt vmcnt(6) lgkmcnt(0)
    s_lshl_b32 s4, s4, 4
    s_sub_u32 s4, s4, s83
    s_cmp_gt_i32 s4, 37344
    s_cbranch_scc1 K1_th131
    s_waitcnt vmcnt(3)
K1_th131:
    buffer_load_dwordx4 v[136:139], v52, s[52:55], s79 offen offset:0 nt
    buffer_load_dwordx4 v[140:143], v53, s[52:55], s79 offen offset:1024 nt
    buffer_load_dwordx4 v[144:147], v54, s[52:55], s79 offen offset:2048 nt
    s_add_u32 s79, s79, 12288
    s_cmp_eq_u32 s79, s88
    s_cselect_b32 s12, 196608, 0
    s_sub_u32 s79, s79, s12
    ds_read_b32 v1, v7
    s_waitcnt lgkmcnt(0)
    s_mov_b32 s71, 37
    v_cmp_gt_i32 vcc, s71, v1
    s_cbranch_vccnz K1_gs132
K1_gs132b:
    s_waitcnt vmcnt(24)
    ds_write_b128 v8, v[148:151] offset:36864
    ds_write_b128 v8, v[152:155] offset:37888
    ds_write_b128 v8, v[156:159] offset:38912
    v_mov_b32 v3, 44
    ds_write_b32 v7, v3 offset:64
    s_memrealtime s[4:5]
    s_waitcnt vmcnt(6) lgkmcnt(0)
    s_lshl_b32 s4, s4, 4
    s_sub_u32 s4, s4, s83
    s_cmp_gt_i32 s4, 38048
    s_cbranch_scc1 K1_th133
    s_waitcnt vmcnt(3)
K1_th133:
    buffer_load_dwordx4 v[148:151], v52, s[56:59], s80 offen offset:0 nt
    buffer_load_dwordx4 v[152:155], v53, s[56:59], s80 offen offset:1024 nt
    buffer_load_dwordx4 v[156:159], v54, s[56:59], s80 offen offset:2048 nt
    s_add_u32 s80, s80, 12288
    s_cmp_eq_u32 s80, s9
    s_cselect_b32 s12, 196608, 0
    s_sub_u32 s80, s80, s12
    ds_read_b32 v1, v7
    s_waitcnt lgkmcnt(0)
    s_mov_b32 s71, 38
    v_cmp_gt_i32 vcc, s71, v1
    s_cbranch_vccnz K1_gs134
K1_gs134b:
    s_waitcnt vmcnt(24)
    ds_write_b128 v9, v[88:91] offset:0
    ds_write_b128 v9, v[92:95] offset:1024
    ds_write_b128 v9, v[96:99] offset:2048
    v_mov_b32 v3, 45
    ds_write_b32 v7, v3 offset:64
    s_memrealtime s[4:5]
    s_waitcnt vmcnt(6) lgkmcnt(0)
    s_lshl_b32 s4, s4, 4
    s_sub_u32 s4, s4, s83
    s_cmp_gt_i32 s4, 38752
    s_cbranch_scc1 K1_th135
    s_waitcnt vmcnt(3)
K1_th135:
    buffer_load_dwordx4 v[88:91], v52, s[52:55], s79 offen offset:0 nt
    buffer_load_dwordx4 v[92:95], v53, s[52:55], s79 offen offset:1024 nt
    buffer_load_dwordx4 v[96:99], v54, s[52:55], s79 offen offset:2048 nt
    s_add_u32 s79, s79, 12288
    s_cmp_eq_u32 s79, s88
    s_cselect_b32 s12, 196608, 0
    s_sub_u32 s79, s79, s12
    s_sub_u32 s73, s91, s82
    v_min_u32 v48, 3, v0
    v_add_u32 v48, s73, v48
    v_lshlrev_b32 v48, 7, v48
    v_add_u32 v48, 0x3e00000, v48
    v_add_u32 v48, 64, v48
    buffer_load_dword v49, v48, s[60:63], 0 offen sc1
    ds_read_b32 v1, v7
    s_waitcnt lgkmcnt(0)
    s_mov_b32 s71, 39
    v_cmp_gt_i32 vcc, s71, v1
    s_cbranch_vccnz K1_gs136
K1_gs136b:
    s_waitcnt vmcnt(25)
    ds_write_b128 v8, v[220:223] offset:0
    ds_write_b128 v8, v[224:227] offset:1024
    ds_write_b128 v8, v[228:231] offset:2048
    v_mov_b32 v3, 46
    ds_write_b32 v7, v3 offset:64
    s_memrealtime s[4:5]
    s_waitcnt vmcnt(7) lgkmcnt(0)
    s_lshl_b32 s4, s4, 4
    s_sub_u32 s4, s4, s83
    s_cmp_gt_i32 s4, 39456
    s_cbranch_scc1 K1_th137
    s_waitcnt vmcnt(4)
K1_th137:
    buffer_load_dwordx4 v[220:223], v52, s[56:59], s80 offen offset:0 nt
    buffer_load_dwordx4 v[224:227], v53, s[56:59], s80 offen offset:1024 nt
    buffer_load_dwordx4 v[228:231], v54, s[56:59], s80 offen offset:2048 nt
    s_add_u32 s80, s80, 12288
    s_cmp_eq_u32 s80, s9
    s_cselect_b32 s12, 196608, 0
    s_sub_u32 s80, s80, s12
    ds_read_b32 v1, v7
    s_waitcnt lgkmcnt(0)
    s_mov_b32 s71, 40
    v_cmp_gt_i32 vcc, s71, v1
    s_cbranch_vccnz K1_gs138
K1_gs138b:
    s_waitcnt vmcnt(25)
    ds_write_b128 v9, v[76:79] offset:12288
    ds_write_b128 v9, v[80:83] offset:13312
    ds_write_b128 v9, v[84:87] offset:14336
    v_mov_b32 v3, 47
    ds_write_b32 v7, v3 offset:64
    ds_read_b32 v1, v7
    s_waitcnt lgkmcnt(0)
    s_mov_b32 s71, 41
    v_cmp_gt_i32 vcc, s71, v1
    s_cbranch_vccnz K1_gs139
K1_gs139b:
    s_waitcnt vmcnt(22)
    ds_write_b128 v8, v[232:235] offset:12288
    ds_write_b128 v8, v[236:239] offset:13312
    ds_write_b128 v8, v[240:243] offset:14336
    v_mov_b32 v3, 48
    ds_write_b32 v7, v3 offset:64
    s_memrealtime s[4:5]
    s_waitcnt vmcnt(7) lgkmcnt(0)
    s_lshl_b32 s4, s4, 4
    s_sub_u32 s4, s4, s83
    s_cmp_gt_i32 s4, 40160
    s_cbranch_scc1 K1_th140
    s_waitcnt vmcnt(4)
K1_th140:
    buffer_load_dwordx4 v[76:79], v52, s[52:55], s79 offen offset:0 nt
    buffer_load_dwordx4 v[80:83], v53, s[52:55], s79 offen offset:1024 nt
    buffer_load_dwordx4 v[84:87], v54, s[52:55], s79 offen offset:2048 nt
    s_add_u32 s79, s79, 12288
    s_cmp_eq_u32 s79, s88
    s_cselect_b32 s12, 196608, 0
    s_sub_u32 s79, s79, s12
    ds_read_b32 v1, v7
    s_waitcnt lgkmcnt(0)
    s_mov_b32 s71, 42
    v_cmp_gt_i32 vcc, s71, v1
    s_cbranch_vccnz K1_gs141
K1_gs141b:
    s_waitcnt vmcnt(22)
    ds_write_b128 v9, v[244:247] offset:24576
    ds_write_b128 v9, v[248:251] offset:25600
    ds_write_b128 v9, v[252:255] offset:26624
    v_mov_b32 v3, 49
    ds_write_b32 v7, v3 offset:64
    s_memrealtime s[4:5]
    s_waitcnt vmcnt(7) lgkmcnt(0)
    s_lshl_b32 s4, s4, 4
    s_sub_u32 s4, s4, s83
    s_cmp_gt_i32 s4, 40864
    s_cbranch_scc1 K1_th142
    s_waitcnt vmcnt(4)
K1_th142:
    buffer_load_dwordx4 v[232:235], v52, s[56:59], s80 offen offset:0 nt
    buffer_load_dwordx4 v[236:239], v53, s[56:59], s80 offen offset:1024 nt
    buffer_load_dwordx4 v[240:243], v54, s[56:59], s80 offen offset:2048 nt
    s_add_u32 s80, s80, 12288
    s_cmp_eq_u32 s80, s9
    s_cselect_b32 s12, 196608, 0
    s_sub_u32 s80, s80, s12
    ds_read_b32 v1, v7
    s_waitcnt lgkmcnt(0)
    s_mov_b32 s71, 43
    v_cmp_gt_i32 vcc, s71, v1
    s_cbranch_vccnz K1_gs143
K1_gs143b:
    s_waitcnt vmcnt(22)
    ds_write_b128 v8, v[20:23] offset:24576
    ds_write_b128 v8, v[24:27] offset:25600
    ds_write_b128 v8, v[28:31] offset:26624
    v_mov_b32 v3, 50
    ds_write_b32 v7, v3 offset:64
    s_memrealtime s[4:5]
    s_waitcnt vmcnt(6) lgkmcnt(0)
    s_lshl_b32 s4, s4, 4
    s_sub_u32 s4, s4, s83
    s_cmp_gt_i32 s4, 41568
    s_cbranch_scc1 K1_th144
    s_waitcnt vmcnt(3)
K1_th144:
    buffer_load_dwordx4 v[244:247], v52, s[52:55], s79 offen offset:0 nt
    buffer_load_dwordx4 v[248:251], v53, s[52:55], s79 offen offset:1024 nt
    buffer_load_dwordx4 v[252:255], v54, s[52:55], s79 offen offset:2048 nt
    s_add_u32 s79, s79, 12288
    s_cmp_eq_u32 s79, s88
    s_cselect_b32 s12, 196608, 0
    s_sub_u32 s79, s79, s12
    ds_read_b32 v1, v7
    s_waitcnt lgkmcnt(0)
    s_mov_b32 s71, 44
    v_cmp_gt_i32 vcc, s71, v1
    s_cbranch_vccnz K1_gs145
K1_gs145b:
    s_waitcnt vmcnt(22)
    ds_write_b128 v8, v[32:35] offset:49152
    ds_write_b128 v8, v[36:39] offset:50176
    ds_write_b128 v8, v[40:43] offset:51200
    v_mov_b32 v3, 51
    ds_write_b32 v7, v3 offset:64
    s_memrealtime s[4:5]
    s_waitcnt vmcnt(6) lgkmcnt(0)
    s_lshl_b32 s4, s4, 4
    s_sub_u32 s4, s4, s83
    s_cmp_gt_i32 s4, 42272
    s_cbranch_scc1 K1_th146
    s_waitcnt vmcnt(3)
K1_th146:
    buffer_load_dwordx4 v[20:23], v52, s[56:59], s80 offen offset:0 nt
    buffer_load_dwordx4 v[24:27], v53, s[56:59], s80 offen offset:1024 nt
    buffer_load_dwordx4 v[28:31], v54, s[56:59], s80 offen offset:2048 nt
    s_add_u32 s80, s80, 12288
    s_cmp_eq_u32 s80, s9
    s_cselect_b32 s12, 196608, 0
    s_sub_u32 s80, s80, s12
    ds_read_b32 v1, v7
    s_waitcnt lgkmcnt(0)
    s_mov_b32 s71, 45
    v_cmp_gt_i32 vcc, s71, v1
    s_cbranch_vccnz K1_gs147
K1_gs147b:
    s_waitcnt vmcnt(22)
    ds_write_b128 v8, v[136:139] offset:36864
    ds_write_b128 v8, v[140:143] offset:37888
    ds_write_b128 v8, v[144:147] offset:38912
    v_mov_b32 v3, 52
    ds_write_b32 v7, v3 offset:64
    s_memrealtime s[4:5]
    s_waitcnt vmcnt(6) lgkmcnt(0)
    s_lshl_b32 s4, s4, 4
    s_sub_u32 s4, s4, s83
    s_cmp_gt_i32 s4, 42976
    s_cbranch_scc1 K1_th148
    s_waitcnt vmcnt(3)
K1_th148:
    buffer_load_dwordx4 v[32:35], v52, s[52:55], s79 offen offset:0 nt
    buffer_load_dwordx4 v[36:39], v53, s[52:55], s79 offen offset:1024 nt
    buffer_load_dwordx4 v[40:43], v54, s[52:55], s79 offen offset:2048 nt
    s_add_u32 s79, s79, 12288
    s_cmp_eq_u32 s79, s88
    s_cselect_b32 s12, 196608, 0
    s_sub_u32 s79, s79, s12
    s_waitcnt vmcnt(18)
    v_cmp_ne_u32 vcc, s43, v49
    s_cbranch_vccnz K1_xc149
    s_mov_b32 s43, 0
K1_xc149:
    ds_read_b32 v1, v7
    s_waitcnt lgkmcnt(0)
    s_mov_b32 s71, 46
    v_cmp_gt_i32 vcc, s71, v1
    s_cbranch_vccnz K1_gs150
K1_gs150b:
    s_waitcnt vmcnt(22)
    ds_write_b128 v9, v[148:151] offset:0
    ds_write_b128 v9, v[152:155] offset:1024
    ds_write_b128 v9, v[156:159] offset:2048
    v_mov_b32 v3, 53
    ds_write_b32 v7, v3 offset:64
    s_memrealtime s[4:5]
    s_waitcnt vmcnt(6) lgkmcnt(0)
    s_lshl_b32 s4, s4, 4
    s_sub_u32 s4, s4, s83
    s_cmp_gt_i32 s4, 43680
    s_cbranch_scc1 K1_th151
    s_waitcnt vmcnt(3)
K1_th151:
    buffer_load_dwordx4 v[136:139], v52, s[56:59], s80 offen offset:0 nt
    buffer_load_dwordx4 v[140:143], v53, s[56:59], s80 offen offset:1024 nt
    buffer_load_dwordx4 v[144:147], v54, s[56:59], s80 offen offset:2048 nt
    s_add_u32 s80, s80, 12288
    s_cmp_eq_u32 s80, s9
    s_cselect_b32 s12, 196608, 0
    s_sub_u32 s80, s80, s12
    s_lshl_b32 s74, s15, 13
    s_mul_i32 s73, s77, 49152
    s_add_u32 s73, s73, s74
    s_add_u32 s73, s73, 0
    s_or_b32 s42, s73, s13
    s_cmp_eq_u32 s43, 0
    s_cbranch_scc1 K1_st152
    buffer_store_dwordx4 v[168:171], v11, s[60:63], s73 offen offset:0 sc1
    buffer_store_dwordx4 v[172:175], v11, s[60:63], s42 offen offset:1024 sc1
    s_branch K1_st152d
K1_st152:
    buffer_store_dwordx4 v[168:171], v11, s[60:63], s73 offen offset:0
    buffer_store_dwordx4 v[172:175], v11, s[60:63], s42 offen offset:1024
K1_st152d:
    s_lshl_b32 s74, s15, 13
    s_mul_i32 s73, s77, 49152
    s_add_u32 s73, s73, s74
    s_add_u32 s73, s73, 8192
    s_or_b32 s42, s73, s13
    s_cmp_eq_u32 s43, 0
    s_cbranch_scc1 K1_st153
    buffer_store_dwordx4 v[176:179], v11, s[60:63], s73 offen offset:0 sc1
    buffer_store_dwordx4 v[180:183], v11, s[60:63], s42 offen offset:1024 sc1
    s_branch K1_st153d
K1_st153:
    buffer_store_dwordx4 v[176:179], v11, s[60:63], s73 offen offset:0
    buffer_store_dwordx4 v[180:183], v11, s[60:63], s42 offen offset:1024
K1_st153d:
    s_lshl_b32 s74, s15, 13
    s_mul_i32 s73, s77, 49152
    s_add_u32 s73, s73, s74
    s_add_u32 s73, s73, 16384
    s_or_b32 s42, s73, s13
    s_cmp_eq_u32 s43, 0
    s_cbranch_scc1 K1_st154
    buffer_store_dwordx4 v[184:187], v11, s[60:63], s73 offen offset:0 sc1
    buffer_store_dwordx4 v[188:191], v11, s[60:63], s42 offen offset:1024 sc1
    s_branch K1_st154d
K1_st154:
    buffer_store_dwordx4 v[184:187], v11, s[60:63], s73 offen offset:0
    buffer_store_dwordx4 v[188:191], v11, s[60:63], s42 offen offset:1024
K1_st154d:
    s_lshl_b32 s74, s15, 13
    s_sub_u32 s74, 24576, s74
    s_mul_i32 s73, s77, 49152
    s_add_u32 s73, s73, s74
    s_add_u32 s73, s73, 0
    s_or_b32 s42, s73, s13
    s_cmp_eq_u32 s43, 0
    s_cbranch_scc1 K1_st155
    buffer_store_dwordx4 v[192:195], v11, s[60:63], s73 offen offset:0 sc1
    buffer_store_dwordx4 v[196:199], v11, s[60:63], s42 offen offset:1024 sc1
    s_branch K1_st155d
K1_st155:
    buffer_store_dwordx4 v[192:195], v11, s[60:63], s73 offen offset:0
    buffer_store_dwordx4 v[196:199], v11, s[60:63], s42 offen offset:1024
K1_st155d:
    s_lshl_b32 s74, s15, 13
    s_sub_u32 s74, 24576, s74
    s_mul_i32 s73, s77, 49152
    s_add_u32 s73, s73, s74
    s_add_u32 s73, s73, 8192
    s_or_b32 s42, s73, s13
    s_cmp_eq_u32 s43, 0
    s_cbranch_scc1 K1_st156
    buffer_store_dwordx4 v[200:203], v11, s[60:63], s73 offen offset:0 sc1
    buffer_store_dwordx4 v[204:207], v11, s[60:63], s42 offen offset:1024 sc1
    s_branch K1_st156d
K1_st156:
    buffer_store_dwordx4 v[200:203], v11, s[60:63], s73 offen offset:0
    buffer_store_dwordx4 v[204:207], v11, s[60:63], s42 offen offset:1024
K1_st156d:
    s_lshl_b32 s74, s15, 13
    s_sub_u32 s74, 24576, s74
    s_mul_i32 s73, s77, 49152
    s_add_u32 s73, s73, s74
    s_add_u32 s73, s73, 16384
    s_or_b32 s42, s73, s13
    s_cmp_eq_u32 s43, 0
    s_cbranch_scc1 K1_st157
    buffer_store_dwordx4 v[208:211], v11, s[60:63], s73 offen offset:0 sc1
    buffer_store_dwordx4 v[212:215], v11, s[60:63], s42 offen offset:1024 sc1
    s_branch K1_st157d
K1_st157:
    buffer_store_dwordx4 v[208:211], v11, s[60:63], s73 offen offset:0
    buffer_store_dwordx4 v[212:215], v11, s[60:63], s42 offen offset:1024
K1_st157d:
    ds_read_b32 v1, v7
    s_waitcnt lgkmcnt(0)
    s_mov_b32 s71, 47
    v_cmp_gt_i32 vcc, s71, v1
    s_cbranch_vccnz K1_gs158
K1_gs158b:
    s_waitcnt vmcnt(34)
    ds_write_b128 v8, v[88:91] offset:0
    ds_write_b128 v8, v[92:95] offset:1024
    ds_write_b128 v8, v[96:99] offset:2048
    v_mov_b32 v3, 54
    ds_write_b32 v7, v3 offset:64
    s_memrealtime s[4:5]
    s_waitcnt vmcnt(18) lgkmcnt(0)
    s_lshl_b32 s4, s4, 4
    s_sub_u32 s4, s4, s83
    s_cmp_gt_i32 s4, 44384
    s_cbranch_scc1 K1_th159
    s_waitcnt vmcnt(15)
K1_th159:
    buffer_load_dwordx4 v[148:151], v52, s[56:59], s80 offen offset:0 nt
    buffer_load_dwordx4 v[152:155], v53, s[56:59], s80 offen offset:1024 nt
    buffer_load_dwordx4 v[156:159], v54, s[56:59], s80 offen offset:2048 nt
    s_add_u32 s80, s80, 12288
    s_cmp_eq_u32 s80, s9
    s_cselect_b32 s12, 196608, 0
    s_sub_u32 s80, s80, s12
    ds_read_b32 v1, v7
    s_waitcnt lgkmcnt(0)
    s_mov_b32 s71, 48
    v_cmp_gt_i32 vcc, s71, v1
    s_cbranch_vccnz K1_gs160
K1_gs160b:
    s_waitcnt vmcnt(33)
    ds_write_b128 v9, v[220:223] offset:12288
    ds_write_b128 v9, v[224:227] offset:13312
    ds_write_b128 v9, v[228:231] offset:14336
    v_mov_b32 v3, 55
    ds_write_b32 v7, v3 offset:64
    s_memrealtime s[4:5]
    s_waitcnt vmcnt(18) lgkmcnt(0)
    s_lshl_b32 s4, s4, 4
    s_sub_u32 s4, s4, s83
    s_cmp_gt_i32 s4, 45088
    s_cbranch_scc1 K1_th161
    s_waitcnt vmcnt(15)
K1_th161:
    buffer_load_dwordx4 v[88:91], v52, s[56:59], s80 offen offset:0 nt
    buffer_load_dwordx4 v[92:95], v53, s[56:59], s80 offen offset:1024 nt
    buffer_load_dwordx4 v[96:99], v54, s[56:59], s80 offen offset:2048 nt
    s_add_u32 s80, s80, 12288
    s_cmp_eq_u32 s80, s9
    s_cselect_b32 s12, 196608, 0
    s_sub_u32 s80, s80, s12
    s_waitcnt vmcnt(6) lgkmcnt(0)
    v_mov_b32 v3, 55
    ds_write_b32 v47, v3
    ds_read_b32 v2, v7 offset:128
    ds_read_b32 v1, v7
    s_waitcnt lgkmcnt(0)
    s_mov_b32 s71, 49
    v_cmp_gt_i32 vcc, s71, v1
    s_cbranch_vccnz K1_gs162
K1_gs162b:
    s_mov_b32 s71, 55
    v_cmp_gt_i32 vcc, s71, v2
    s_cbranch_vccnz K1_gs163
K1_gs163b:
    s_waitcnt vmcnt(33)
    ds_write_b128 v8, v[76:79] offset:12288
    ds_write_b128 v8, v[80:83] offset:13312
    ds_write_b128 v8, v[84:87] offset:14336
    v_mov_b32 v3, 56
    ds_write_b32 v7, v3 offset:64
    s_cmp_eq_u32 s3, 4
    s_cbranch_scc0 K1_w164
    s_lshl_b32 s73, s91, 7
    s_add_u32 s73, s73, 0x3e00000
    s_add_u32 s74, s83, 3
    v_mov_b32 v4, 0
    v_mov_b32 v5, s74
    s_mov_b64 exec, 1
    buffer_store_dword v5, v4, s[60:63], s73 offen offset:0 sc1
    s_mov_b64 exec, -1
K1_w164:
    ds_read_b32 v1, v7
    s_waitcnt lgkmcnt(0)
    s_mov_b32 s71, 50
    v_cmp_gt_i32 vcc, s71, v1
    s_cbranch_vccnz K1_gs165
K1_gs165b:
    s_waitcnt vmcnt(30)
    ds_write_b128 v9, v[232:235] offset:24576
    ds_write_b128 v9, v[236:239] offset:25600
    ds_write_b128 v9, v[240:243] offset:26624
    v_mov_b32 v3, 57
    ds_write_b32 v7, v3 offset:64
    s_add_u32 m0, s81, 98304
    s_mul_i32 s69, s7, 491520
    s_mul_i32 s73, s8, 40960
    s_add_u32 s69, s69, s73
    s_add_u32 s69, s69, s67
    buffer_load_dwordx4 v56, s[44:47], s69 offen offset:0 lds
    buffer_load_dwordx4 v57, s[44:47], s69 offen offset:1024 lds
    buffer_load_dwordx4 v58, s[44:47], s69 offen offset:2048 lds
    s_add_u32 s6, s6, 1
    s_add_u32 s8, s8, 1
    s_cmp_eq_u32 s8, 6
    s_cselect_b32 s8, 0, s8
    s_cmp_eq_u32 s8, s15
    s_addc_u32 s7, s7, 0
    s_and_b32 s7, s7, 3
    ds_read_b32 v1, v7
    s_waitcnt lgkmcnt(0)
    s_mov_b32 s71, 51
    v_cmp_gt_i32 vcc, s71, v1
    s_cbranch_vccnz K1_gs166
K1_gs166b:
    s_waitcnt vmcnt(30)
    ds_write_b128 v8, v[244:247] offset:24576
    ds_write_b128 v8, v[248:251] offset:25600
    ds_write_b128 v8, v[252:255] offset:26624
    v_mov_b32 v3, 58
    ds_write_b32 v7, v3 offset:64
    s_add_u32 m0, s81, 110592
    s_mul_i32 s69, s7, 491520
    s_mul_i32 s73, s8, 40960
    s_add_u32 s69, s69, s73
    s_add_u32 s69, s69, s67
    buffer_load_dwordx4 v56, s[44:47], s69 offen offset:0 lds
    buffer_load_dwordx4 v57, s[44:47], s69 offen offset:1024 lds
    buffer_load_dwordx4 v58, s[44:47], s69 offen offset:2048 lds
    s_add_u32 s6, s6, 1
    s_add_u32 s8, s8, 1
    s_cmp_eq_u32 s8, 6
    s_cselect_b32 s8, 0, s8
    s_cmp_eq_u32 s8, s15
    s_addc_u32 s7, s7, 0
    s_and_b32 s7, s7, 3
    ds_read_b32 v1, v7
    s_waitcnt lgkmcnt(0)
    s_mov_b32 s71, 52
    v_cmp_gt_i32 vcc, s71, v1
    s_cbranch_vccnz K1_gs167
K1_gs167b:
    s_waitcnt vmcnt(30)
    ds_write_b128 v8, v[20:23] offset:49152
    ds_write_b128 v8, v[24:27] offset:50176
    ds_write_b128 v8, v[28:31] offset:51200
    v_mov_b32 v3, 59
    ds_write_b32 v7, v3 offset:64
    s_add_u32 m0, s81, 122880
    s_mul_i32 s69, s7, 491520
    s_mul_i32 s73, s8, 40960
    s_add_u32 s69, s69, s73
    s_add_u32 s69, s69, s67
    buffer_load_dwordx4 v56, s[44:47], s69 offen offset:0 lds
    buffer_load_dwordx4 v57, s[44:47], s69 offen offset:1024 lds
    buffer_load_dwordx4 v58, s[44:47], s69 offen offset:2048 lds
    s_add_u32 s6, s6, 1
    s_add_u32 s8, s8, 1
    s_cmp_eq_u32 s8, 6
    s_cselect_b32 s8, 0, s8
    s_cmp_eq_u32 s8, s15
    s_addc_u32 s7, s7, 0
    s_and_b32 s7, s7, 3
    ds_read_b32 v1, v7
    s_waitcnt lgkmcnt(0)
    s_mov_b32 s71, 53
    v_cmp_gt_i32 vcc, s71, v1
    s_cbranch_vccnz K1_gs168
K1_gs168b:
    s_waitcnt vmcnt(30)
    ds_write_b128 v8, v[32:35] offset:36864
    ds_write_b128 v8, v[36:39] offset:37888
    ds_write_b128 v8, v[40:43] offset:38912
    v_mov_b32 v3, 60
    ds_write_b32 v7, v3 offset:64
    s_add_u32 m0, s81, 135168
    s_mul_i32 s69, s7, 491520
    s_mul_i32 s73, s8, 40960
    s_add_u32 s69, s69, s73
    s_add_u32 s69, s69, s67
    buffer_load_dwordx4 v56, s[44:47], s69 offen offset:0 lds
    buffer_load_dwordx4 v57, s[44:47], s69 offen offset:1024 lds
    buffer_load_dwordx4 v58, s[44:47], s69 offen offset:2048 lds
    s_add_u32 s6, s6, 1
    s_add_u32 s8, s8, 1
    s_cmp_eq_u32 s8, 6
    s_cselect_b32 s8, 0, s8
    s_cmp_eq_u32 s8, s15
    s_addc_u32 s7, s7, 0
    s_and_b32 s7, s7, 3
    s_sub_u32 s73, s91, s82
    v_min_u32 v60, 3, v0
    v_add_u32 v60, s73, v60
    v_lshlrev_b32 v60, 7, v60
    v_add_u32 v60, 0x3e00000, v60
    buffer_load_dword v61, v60, s[60:63], 0 offen sc1
    ds_read_b32 v1, v7
    s_waitcnt lgkmcnt(0)
    s_mov_b32 s71, 54
    v_cmp_gt_i32 vcc, s71, v1
    s_cbranch_vccnz K1_gs169
K1_gs169b:
    s_waitcnt vmcnt(31)
    ds_write_b128 v9, v[136:139] offset:0
    ds_write_b128 v9, v[140:143] offset:1024
    ds_write_b128 v9, v[144:147] offset:2048
    v_mov_b32 v3, 61
    ds_write_b32 v7, v3 offset:64
    ds_read_b32 v1, v7
    s_waitcnt lgkmcnt(0)
    s_mov_b32 s71, 56
    v_cmp_gt_i32 vcc, s71, v1
    s_cbranch_vccnz K1_gs170
K1_gs170b:
    s_waitcnt vmcnt(16)
    ds_write_b128 v9, v[148:151] offset:12288
    ds_write_b128 v9, v[152:155] offset:13312
    ds_write_b128 v9, v[156:159] offset:14336
    v_mov_b32 v3, 62
    ds_write_b32 v7, v3 offset:64
    s_add_u32 m0, s81, 147456
    s_mul_i32 s69, s7, 491520
    s_mul_i32 s73, s8, 40960
    s_add_u32 s69, s69, s73
    s_add_u32 s69, s69, s67
    buffer_load_dwordx4 v56, s[44:47], s69 offen offset:0 lds
    buffer_load_dwordx4 v57, s[44:47], s69 offen offset:1024 lds
    buffer_load_dwordx4 v58, s[44:47], s69 offen offset:2048 lds
    s_add_u32 s6, s6, 1
    s_add_u32 s8, s8, 1
    s_cmp_eq_u32 s8, 6
    s_cselect_b32 s8, 0, s8
    s_cmp_eq_u32 s8, s15
    s_addc_u32 s7, s7, 0
    s_and_b32 s7, s7, 3
    ds_read_b32 v1, v7
    s_waitcnt lgkmcnt(0)
    s_mov_b32 s71, 58
    v_cmp_gt_i32 vcc, s71, v1
    s_cbranch_vccnz K1_gs171
K1_gs171b:
    s_waitcnt vmcnt(16)
    ds_write_b128 v9, v[88:91] offset:24576
    ds_write_b128 v9, v[92:95] offset:25600
    ds_write_b128 v9, v[96:99] offset:26624
    v_mov_b32 v3, 999
    ds_write_b32 v7, v3 offset:64
    s_waitcnt vmcnt(3)
    s_add_u32 s73, s83, 3
    v_subrev_u32 v61, s73, v61
    v_cmp_lt_u32 vcc, 4, v61
    s_cbranch_vccz K1_polld173
    s_mov_b32 s74, 0
K1_poll172:
    buffer_load_dword v61, v60, s[60:63], 0 offen sc1
    s_waitcnt vmcnt(0)
    s_add_u32 s73, s83, 3
    v_subrev_u32 v61, s73, v61
    v_cmp_lt_u32 vcc, 4, v61
    s_cbranch_vccz K1_polld173
    s_sleep 4
    s_add_u32 s74, s74, 1
    s_cmp_lt_u32 s74, 0x400000
    s_cbranch_scc1 K1_poll172
K1_polld173:
    s_add_u32 s73, s82, 1
    s_and_b32 s73, s73, 3
    s_mul_i32 s73, s73, 98304
    s_add_u32 s73, s73, s68
    s_lshr_b32 s74, s78, 1
    s_add_u32 s73, s73, s74
    s_or_b32 s42, s73, s13
    v_min_u32 v50, 47, v0
    v_lshrrev_b32 v51, 3, v50
    v_and_b32 v50, 7, v50
    v_lshlrev_b32 v50, 7, v50
    v_lshl_add_u32 v50, v51, 13, v50
    buffer_load_dword v51, v50, s[60:63], s73 offen offset:0
    buffer_load_dword v49, v50, s[60:63], s42 offen offset:1024
    ds_read_b32 v1, v7
    s_waitcnt lgkmcnt(0)
    s_mov_b32 s71, 62
    v_cmp_gt_i32 vcc, s71, v1
    s_cbranch_vccnz K1_gs174
K1_gs174b:
    v_mov_b64 v[88:89], 0
    v_mov_b64 v[90:91], 0
    v_mov_b64 v[92:93], 0
    v_mov_b64 v[94:95], 0
    v_mov_b64 v[96:97], 0
    v_mov_b64 v[98:99], 0
    v_mov_b64 v[100:101], 0
    v_mov_b64 v[102:103], 0
    v_mov_b64 v[104:105], 0
    v_mov_b64 v[106:107], 0
    v_mov_b64 v[108:109], 0
    v_mov_b64 v[110:111], 0
    v_mov_b64 v[112:113], 0
    v_mov_b64 v[114:115], 0
    v_mov_b64 v[116:117], 0
    v_mov_b64 v[118:119], 0
    v_mov_b64 v[120:121], 0
    v_mov_b64 v[122:123], 0
    v_mov_b64 v[124:125], 0
    v_mov_b64 v[126:127], 0
    v_mov_b64 v[128:129], 0
    v_mov_b64 v[130:131], 0
    v_mov_b64 v[132:133], 0
    v_mov_b64 v[134:135], 0
    v_mov_b64 v[136:137], 0
    v_mov_b64 v[138:139], 0
    v_mov_b64 v[140:141], 0
    v_mov_b64 v[142:143], 0
    v_mov_b64 v[144:145], 0
    v_mov_b64 v[146:147], 0
    v_mov_b64 v[148:149], 0
    v_mov_b64 v[150:151], 0
    v_mov_b64 v[152:153], 0
    v_mov_b64 v[154:155], 0
    v_mov_b64 v[156:157], 0
    v_mov_b64 v[158:159], 0
    v_mov_b64 v[160:161], 0
    v_mov_b64 v[162:163], 0
    v_mov_b64 v[164:165], 0
    v_mov_b64 v[166:167], 0
    s_add_u32 m0, s81, 61440
    s_mul_i32 s69, s7, 491520
    s_mul_i32 s73, s8, 40960
    s_add_u32 s69, s69, s73
    s_add_u32 s69, s69, s67
    buffer_load_dwordx4 v56, s[44:47], s69 offen offset:0 lds
    buffer_load_dwordx4 v57, s[44:47], s69 offen offset:1024 lds
    buffer_load_dwordx4 v58, s[44:47], s69 offen offset:2048 lds
    s_add_u32 s6, s6, 1
    s_add_u32 s8, s8, 1
    s_cmp_eq_u32 s8, 6
    s_cselect_b32 s8, 0, s8
    s_cmp_eq_u32 s8, s15
    s_addc_u32 s7, s7, 0
    s_and_b32 s7, s7, 3
    ds_read_b32 v1, v7
    s_waitcnt lgkmcnt(0)
    s_mov_b32 s71, 63
    v_cmp_gt_i32 vcc, s71, v1
    s_cbranch_vccnz K1_gs175
K1_gs175b:
    s_add_u32 m0, s81, 73728
    s_mul_i32 s69, s7, 491520
    s_mul_i32 s73, s8, 40960
    s_add_u32 s69, s69, s73
    s_add_u32 s69, s69, s67
    buffer_load_dwordx4 v56, s[44:47], s69 offen offset:0 lds
    buffer_load_dwordx4 v57, s[44:47], s69 offen offset:1024 lds
    buffer_load_dwordx4 v58, s[44:47], s69 offen offset:2048 lds
    s_waitcnt vmcnt(21) lgkmcnt(0)
    s_barrier
    ds_read_b64_tr_b16 v[20:21], v12 offset:0
    ds_read_b64_tr_b16 v[22:23], v12 offset:6144
    ds_read_b64_tr_b16 v[24:25], v13 offset:0
    ds_read_b64_tr_b16 v[26:27], v13 offset:6144
    ds_read_b64_tr_b16 v[28:29], v14 offset:0
    ds_read_b64_tr_b16 v[30:31], v14 offset:6144
    ds_read_b64_tr_b16 v[32:33], v15 offset:0
    ds_read_b64_tr_b16 v[34:35], v15 offset:6144
    s_mov_b32 s72, 0
    s_setprio 2
    s_mul_i32 s74, s7, 98304
    s_lshl_b32 s73, s8, 13
    s_add_u32 s74, s74, s73
    s_add_u32 s74, s74, s68
K1_G_tail:
    ds_read_b64_tr_b16 v[36:37], v12 offset:128
    s_waitcnt lgkmcnt(5)
    v_mfma_f32_16x16x32_bf16 v[88:91], v[20:23], v[168:171], v[88:91]
    ds_read_b64_tr_b16 v[38:39], v12 offset:6272
    s_cmp_ge_u32 s6, 48
    v_mfma_f32_16x16x32_bf16 v[96:99], v[20:23], v[172:175], v[96:99]
    s_cselect_b32 s74, 0x40000000, s74
    ds_read_b64_tr_b16 v[20:21], v13 offset:128
    v_mfma_f32_16x16x32_bf16 v[92:95], v[24:27], v[168:171], v[92:95]
    ds_read_b64_tr_b16 v[22:23], v13 offset:6272
    s_or_b32 s42, s74, s13
    v_mfma_f32_16x16x32_bf16 v[100:103], v[24:27], v[172:175], v[100:103]
    ds_read_b64_tr_b16 v[24:25], v14 offset:128
    s_waitcnt lgkmcnt(5)
    v_mfma_f32_16x16x32_bf16 v[104:107], v[28:31], v[168:171], v[104:107]
    ds_read_b64_tr_b16 v[26:27], v14 offset:6272
    v_mfma_f32_16x16x32_bf16 v[112:115], v[28:31], v[172:175], v[112:115]
    buffer_load_dwordx4 v[216:219], v11, s[60:63], s74 offen offset:0
    ds_read_b64_tr_b16 v[28:29], v15 offset:128
    v_mfma_f32_16x16x32_bf16 v[108:111], v[32:35], v[168:171], v[108:111]
    ds_read_b64_tr_b16 v[30:31], v15 offset:6272
    v_mfma_f32_16x16x32_bf16 v[116:119], v[32:35], v[172:175], v[116:119]
    buffer_load_dwordx4 v[220:223], v11, s[60:63], s42 offen offset:1024
    ds_read_b64_tr_b16 v[32:33], v12 offset:256
    s_waitcnt lgkmcnt(5)
    v_mfma_f32_16x16x32_bf16 v[120:123], v[36:39], v[168:171], v[120:123]
    ds_read_b64_tr_b16 v[34:35], v12 offset:6400
    s_add_u32 s6, s6, 1
    v_mfma_f32_16x16x32_bf16 v[128:131], v[36:39], v[172:175], v[128:131]
    s_add_u32 s8, s8, 1
    ds_read_b64_tr_b16 v[36:37], v13 offset:256
    s_waitcnt vmcnt(10)
    s_barrier
    v_mfma_f32_16x16x32_bf16 v[124:127], v[20:23], v[168:171], v[124:127]
    ds_read_b64_tr_b16 v[38:39], v13 offset:6400
    s_cmp_eq_u32 s8, 6
    v_mfma_f32_16x16x32_bf16 v[132:135], v[20:23], v[172:175], v[132:135]
    s_cselect_b32 s8, 0, s8
    ds_read_b64_tr_b16 v[20:21], v12 offset:12288
    s_waitcnt lgkmcnt(5)
    v_mfma_f32_16x16x32_bf16 v[136:139], v[24:27], v[168:171], v[136:139]
    ds_read_b64_tr_b16 v[22:23], v12 offset:18432
    s_cmp_eq_u32 s8, s15
    v_mfma_f32_16x16x32_bf16 v[144:147], v[24:27], v[172:175], v[144:147]
    s_addc_u32 s7, s7, 0
    ds_read_b64_tr_b16 v[24:25], v13 offset:12288
    v_mfma_f32_16x16x32_bf16 v[140:143], v[28:31], v[168:171], v[140:143]
    ds_read_b64_tr_b16 v[26:27], v13 offset:18432
    s_and_b32 s7, s7, 3
    v_mfma_f32_16x16x32_bf16 v[148:151], v[28:31], v[172:175], v[148:151]
    s_mul_i32 s74, s7, 98304
    ds_read_b64_tr_b16 v[28:29], v14 offset:12288
    s_waitcnt lgkmcnt(5)
    v_mfma_f32_16x16x32_bf16 v[152:155], v[32:35], v[168:171], v[152:155]
    ds_read_b64_tr_b16 v[30:31], v14 offset:18432
    s_lshl_b32 s73, s8, 13
    v_mfma_f32_16x16x32_bf16 v[160:163], v[32:35], v[172:175], v[160:163]
    s_add_u32 s74, s74, s73
    ds_read_b64_tr_b16 v[32:33], v15 offset:12288
    v_mfma_f32_16x16x32_bf16 v[156:159], v[36:39], v[168:171], v[156:159]
    ds_read_b64_tr_b16 v[34:35], v15 offset:18432
    s_add_u32 s74, s74, s68
    v_mfma_f32_16x16x32_bf16 v[164:167], v[36:39], v[172:175], v[164:167]
    ds_read_b64_tr_b16 v[36:37], v12 offset:12416
    s_waitcnt lgkmcnt(5)
    v_mfma_f32_16x16x32_bf16 v[88:91], v[20:23], v[176:179], v[88:91]
    ds_read_b64_tr_b16 v[38:39], v12 offset:18560
    s_cmp_ge_u32 s6, 48
    v_mfma_f32_16x16x32_bf16 v[96:99], v[20:23], v[180:183], v[96:99]
    s_cselect_b32 s74, 0x40000000, s74
    ds_read_b64_tr_b16 v[20:21], v13 offset:12416
    v_mfma_f32_16x16x32_bf16 v[92:95], v[24:27], v[176:179], v[92:95]
    ds_read_b64_tr_b16 v[22:23], v13 offset:18560
    s_or_b32 s42, s74, s13
    v_mfma_f32_16x16x32_bf16 v[100:103], v[24:27], v[180:183], v[100:103]
    s_cmp_eq_u32 s72, 2
    s_cbranch_scc0 K1_w176
    s_add_u32 s68, s68, 49152
K1_w176:
    ds_read_b64_tr_b16 v[24:25], v14 offset:12416
    s_waitcnt lgkmcnt(5)
    v_mfma_f32_16x16x32_bf16 v[104:107], v[28:31], v[176:179], v[104:107]
    ds_read_b64_tr_b16 v[26:27], v14 offset:18560
    v_mfma_f32_16x16x32_bf16 v[112:115], v[28:31], v[180:183], v[112:115]
    buffer_load_dwordx4 v[224:227], v11, s[60:63], s74 offen offset:0
    ds_read_b64_tr_b16 v[28:29], v15 offset:12416
    v_mfma_f32_16x16x32_bf16 v[108:111], v[32:35], v[176:179], v[108:111]
    ds_read_b64_tr_b16 v[30:31], v15 offset:18560
    v_mfma_f32_16x16x32_bf16 v[116:119], v[32:35], v[180:183], v[116:119]
    buffer_load_dwordx4 v[228:231], v11, s[60:63], s42 offen offset:1024
    ds_read_b64_tr_b16 v[32:33], v12 offset:12544
    s_waitcnt lgkmcnt(5)
    v_mfma_f32_16x16x32_bf16 v[120:123], v[36:39], v[176:179], v[120:123]
    ds_read_b64_tr_b16 v[34:35], v12 offset:18688
    s_add_u32 s6, s6, 1
    v_mfma_f32_16x16x32_bf16 v[128:131], v[36:39], v[180:183], v[128:131]
    s_add_u32 s8, s8, 1
    ds_read_b64_tr_b16 v[36:37], v13 offset:12544
    s_waitcnt vmcnt(10)
    s_barrier
    v_mfma_f32_16x16x32_bf16 v[124:127], v[20:23], v[176:179], v[124:127]
    ds_read_b64_tr_b16 v[38:39], v13 offset:18688
    s_cmp_eq_u32 s8, 6
    v_mfma_f32_16x16x32_bf16 v[132:135], v[20:23], v[180:183], v[132:135]
    s_cselect_b32 s8, 0, s8
    ds_read_b64_tr_b16 v[20:21], v12 offset:24576
    s_waitcnt lgkmcnt(5)
    v_mfma_f32_16x16x32_bf16 v[136:139], v[24:27], v[176:179], v[136:139]
    ds_read_b64_tr_b16 v[22:23], v12 offset:30720
    s_cmp_eq_u32 s8, s15
    v_mfma_f32_16x16x32_bf16 v[144:147], v[24:27], v[180:183], v[144:147]
    s_addc_u32 s7, s7, 0
    ds_read_b64_tr_b16 v[24:25], v13 offset:24576
    v_mfma_f32_16x16x32_bf16 v[140:143], v[28:31], v[176:179], v[140:143]
    ds_read_b64_tr_b16 v[26:27], v13 offset:30720
    s_and_b32 s7, s7, 3
    v_mfma_f32_16x16x32_bf16 v[148:151], v[28:31], v[180:183], v[148:151]
    s_mul_i32 s74, s7, 98304
    ds_read_b64_tr_b16 v[28:29], v14 offset:24576
    s_waitcnt lgkmcnt(5)
    v_mfma_f32_16x16x32_bf16 v[152:155], v[32:35], v[176:179], v[152:155]
    ds_read_b64_tr_b16 v[30:31], v14 offset:30720
    s_lshl_b32 s73, s8, 13
    v_mfma_f32_16x16x32_bf16 v[160:163], v[32:35], v[180:183], v[160:163]
    s_add_u32 s74, s74, s73
    ds_read_b64_tr_b16 v[32:33], v15 offset:24576
    v_mfma_f32_16x16x32_bf16 v[156:159], v[36:39], v[176:179], v[156:159]
    ds_read_b64_tr_b16 v[34:35], v15 offset:30720
    s_add_u32 s74, s74, s68
    v_mfma_f32_16x16x32_bf16 v[164:167], v[36:39], v[180:183], v[164:167]
    ds_read_b64_tr_b16 v[36:37], v12 offset:24704
    s_waitcnt lgkmcnt(5)
    v_mfma_f32_16x16x32_bf16 v[88:91], v[20:23], v[184:187], v[88:91]
    ds_read_b64_tr_b16 v[38:39], v12 offset:30848
    s_cmp_ge_u32 s6, 48
    v_mfma_f32_16x16x32_bf16 v[96:99], v[20:23], v[188:191], v[96:99]
    s_cselect_b32 s74, 0x40000000, s74
    ds_read_b64_tr_b16 v[20:21], v13 offset:24704
    v_mfma_f32_16x16x32_bf16 v[92:95], v[24:27], v[184:187], v[92:95]
    ds_read_b64_tr_b16 v[22:23], v13 offset:30848
    s_or_b32 s42, s74, s13
    v_mfma_f32_16x16x32_bf16 v[100:103], v[24:27], v[188:191], v[100:103]
    ds_read_b64_tr_b16 v[24:25], v14 offset:24704
    s_waitcnt lgkmcnt(5)
    v_mfma_f32_16x16x32_bf16 v[104:107], v[28:31], v[184:187], v[104:107]
    ds_read_b64_tr_b16 v[26:27], v14 offset:30848
    v_mfma_f32_16x16x32_bf16 v[112:115], v[28:31], v[188:191], v[112:115]
    buffer_load_dwordx4 v[168:171], v11, s[60:63], s74 offen offset:0
    ds_read_b64_tr_b16 v[28:29], v15 offset:24704
    v_mfma_f32_16x16x32_bf16 v[108:111], v[32:35], v[184:187], v[108:111]
    ds_read_b64_tr_b16 v[30:31], v15 offset:30848
    v_mfma_f32_16x16x32_bf16 v[116:119], v[32:35], v[188:191], v[116:119]
    buffer_load_dwordx4 v[172:175], v11, s[60:63], s42 offen offset:1024
    ds_read_b64_tr_b16 v[32:33], v12 offset:24832
    s_waitcnt lgkmcnt(5)
    v_mfma_f32_16x16x32_bf16 v[120:123], v[36:39], v[184:187], v[120:123]
    ds_read_b64_tr_b16 v[34:35], v12 offset:30976
    s_add_u32 s6, s6, 1
    v_mfma_f32_16x16x32_bf16 v[128:131], v[36:39], v[188:191], v[128:131]
    s_add_u32 s8, s8, 1
    ds_read_b64_tr_b16 v[36:37], v13 offset:24832
    s_waitcnt vmcnt(10)
    s_barrier
    v_mfma_f32_16x16x32_bf16 v[124:127], v[20:23], v[184:187], v[124:127]
    ds_read_b64_tr_b16 v[38:39], v13 offset:30976
    s_cmp_eq_u32 s8, 6
    v_mfma_f32_16x16x32_bf16 v[132:135], v[20:23], v[188:191], v[132:135]
    s_cselect_b32 s8, 0, s8
    ds_read_b64_tr_b16 v[20:21], v12 offset:36864
    s_waitcnt lgkmcnt(5)
    v_mfma_f32_16x16x32_bf16 v[136:139], v[24:27], v[184:187], v[136:139]
    ds_read_b64_tr_b16 v[22:23], v12 offset:43008
    s_cmp_eq_u32 s8, s15
    v_mfma_f32_16x16x32_bf16 v[144:147], v[24:27], v[188:191], v[144:147]
    s_addc_u32 s7, s7, 0
    ds_read_b64_tr_b16 v[24:25], v13 offset:36864
    v_mfma_f32_16x16x32_bf16 v[140:143], v[28:31], v[184:187], v[140:143]
    ds_read_b64_tr_b16 v[26:27], v13 offset:43008
    s_and_b32 s7, s7, 3
    v_mfma_f32_16x16x32_bf16 v[148:151], v[28:31], v[188:191], v[148:151]
    s_mul_i32 s74, s7, 98304
    ds_read_b64_tr_b16 v[28:29], v14 offset:36864
    s_waitcnt lgkmcnt(5)
    v_mfma_f32_16x16x32_bf16 v[152:155], v[32:35], v[184:187], v[152:155]
    ds_read_b64_tr_b16 v[30:31], v14 offset:43008
    s_lshl_b32 s73, s8, 13
    v_mfma_f32_16x16x32_bf16 v[160:163], v[32:35], v[188:191], v[160:163]
    s_add_u32 s74, s74, s73
    ds_read_b64_tr_b16 v[32:33], v15 offset:36864
    v_mfma_f32_16x16x32_bf16 v[156:159], v[36:39], v[184:187], v[156:159]
    ds_read_b64_tr_b16 v[34:35], v15 offset:43008
    s_add_u32 s74, s74, s68
    v_mfma_f32_16x16x32_bf16 v[164:167], v[36:39], v[188:191], v[164:167]
    ds_read_b64_tr_b16 v[36:37], v12 offset:36992
    s_waitcnt lgkmcnt(5)
    v_mfma_f32_16x16x32_bf16 v[88:91], v[20:23], v[192:195], v[88:91]
    ds_read_b64_tr_b16 v[38:39], v12 offset:43136
    s_cmp_ge_u32 s6, 48
    v_mfma_f32_16x16x32_bf16 v[96:99], v[20:23], v[196:199], v[96:99]
    s_cselect_b32 s74, 0x40000000, s74
    ds_read_b64_tr_b16 v[20:21], v13 offset:36992
    v_mfma_f32_16x16x32_bf16 v[92:95], v[24:27], v[192:195], v[92:95]
    ds_read_b64_tr_b16 v[22:23], v13 offset:43136
    s_or_b32 s42, s74, s13
    v_mfma_f32_16x16x32_bf16 v[100:103], v[24:27], v[196:199], v[100:103]
    ds_read_b64_tr_b16 v[24:25], v14 offset:36992
    s_waitcnt lgkmcnt(5)
    v_mfma_f32_16x16x32_bf16 v[104:107], v[28:31], v[192:195], v[104:107]
    ds_read_b64_tr_b16 v[26:27], v14 offset:43136
    v_mfma_f32_16x16x32_bf16 v[112:115], v[28:31], v[196:199], v[112:115]
    buffer_load_dwordx4 v[176:179], v11, s[60:63], s74 offen offset:0
    ds_read_b64_tr_b16 v[28:29], v15 offset:36992
    v_mfma_f32_16x16x32_bf16 v[108:111], v[32:35], v[192:195], v[108:111]
    ds_read_b64_tr_b16 v[30:31], v15 offset:43136
    v_mfma_f32_16x16x32_bf16 v[116:119], v[32:35], v[196:199], v[116:119]
    buffer_load_dwordx4 v[180:183], v11, s[60:63], s42 offen offset:1024
    ds_read_b64_tr_b16 v[32:33], v12 offset:37120
    s_waitcnt lgkmcnt(5)
    v_mfma_f32_16x16x32_bf16 v[120:123], v[36:39], v[192:195], v[120:123]
    ds_read_b64_tr_b16 v[34:35], v12 offset:43264
    s_add_u32 s6, s6, 1
    v_mfma_f32_16x16x32_bf16 v[128:131], v[36:39], v[196:199], v[128:131]
    s_add_u32 s8, s8, 1
    ds_read_b64_tr_b16 v[36:37], v13 offset:37120
    s_waitcnt vmcnt(10)
    s_barrier
    v_mfma_f32_16x16x32_bf16 v[124:127], v[20:23], v[192:195], v[124:127]
    ds_read_b64_tr_b16 v[38:39], v13 offset:43264
    s_cmp_eq_u32 s8, 6
    v_mfma_f32_16x16x32_bf16 v[132:135], v[20:23], v[196:199], v[132:135]
    s_cselect_b32 s8, 0, s8
    ds_read_b64_tr_b16 v[20:21], v12 offset:49152
    s_waitcnt lgkmcnt(5)
    v_mfma_f32_16x16x32_bf16 v[136:139], v[24:27], v[192:195], v[136:139]
    ds_read_b64_tr_b16 v[22:23], v12 offset:55296
    s_cmp_eq_u32 s8, s15
    v_mfma_f32_16x16x32_bf16 v[144:147], v[24:27], v[196:199], v[144:147]
    s_addc_u32 s7, s7, 0
    ds_read_b64_tr_b16 v[24:25], v13 offset:49152
    v_mfma_f32_16x16x32_bf16 v[140:143], v[28:31], v[192:195], v[140:143]
    ds_read_b64_tr_b16 v[26:27], v13 offset:55296
    s_and_b32 s7, s7, 3
    v_mfma_f32_16x16x32_bf16 v[148:151], v[28:31], v[196:199], v[148:151]
    s_mul_i32 s74, s7, 98304
    ds_read_b64_tr_b16 v[28:29], v14 offset:49152
    s_waitcnt lgkmcnt(5)
    v_mfma_f32_16x16x32_bf16 v[152:155], v[32:35], v[192:195], v[152:155]
    ds_read_b64_tr_b16 v[30:31], v14 offset:55296
    s_lshl_b32 s73, s8, 13
    v_mfma_f32_16x16x32_bf16 v[160:163], v[32:35], v[196:199], v[160:163]
    s_add_u32 s74, s74, s73
    ds_read_b64_tr_b16 v[32:33], v15 offset:49152
    v_mfma_f32_16x16x32_bf16 v[156:159], v[36:39], v[192:195], v[156:159]
    ds_read_b64_tr_b16 v[34:35], v15 offset:55296
    s_add_u32 s74, s74, s68
    v_mfma_f32_16x16x32_bf16 v[164:167], v[36:39], v[196:199], v[164:167]
    ds_read_b64_tr_b16 v[36:37], v12 offset:49280
    s_waitcnt lgkmcnt(5)
    v_mfma_f32_16x16x32_bf16 v[88:91], v[20:23], v[200:203], v[88:91]
    ds_read_b64_tr_b16 v[38:39], v12 offset:55424
    s_cmp_ge_u32 s6, 48
    v_mfma_f32_16x16x32_bf16 v[96:99], v[20:23], v[204:207], v[96:99]
    s_cselect_b32 s74, 0x40000000, s74
    ds_read_b64_tr_b16 v[20:21], v13 offset:49280
    v_mfma_f32_16x16x32_bf16 v[92:95], v[24:27], v[200:203], v[92:95]
    ds_read_b64_tr_b16 v[22:23], v13 offset:55424
    s_or_b32 s42, s74, s13
    v_mfma_f32_16x16x32_bf16 v[100:103], v[24:27], v[204:207], v[100:103]
    ds_read_b64_tr_b16 v[24:25], v14 offset:49280
    s_waitcnt lgkmcnt(5)
    v_mfma_f32_16x16x32_bf16 v[104:107], v[28:31], v[200:203], v[104:107]
    ds_read_b64_tr_b16 v[26:27], v14 offset:55424
    v_mfma_f32_16x16x32_bf16 v[112:115], v[28:31], v[204:207], v[112:115]
    buffer_load_dwordx4 v[184:187], v11, s[60:63], s74 offen offset:0
    ds_read_b64_tr_b16 v[28:29], v15 offset:49280
    v_mfma_f32_16x16x32_bf16 v[108:111], v[32:35], v[200:203], v[108:111]
    ds_read_b64_tr_b16 v[30:31], v15 offset:55424
    v_mfma_f32_16x16x32_bf16 v[116:119], v[32:35], v[204:207], v[116:119]
    buffer_load_dwordx4 v[188:191], v11, s[60:63], s42 offen offset:1024
    ds_read_b64_tr_b16 v[32:33], v12 offset:49408
    s_waitcnt lgkmcnt(5)
    v_mfma_f32_16x16x32_bf16 v[120:123], v[36:39], v[200:203], v[120:123]
    ds_read_b64_tr_b16 v[34:35], v12 offset:55552
    s_add_u32 s6, s6, 1
    v_mfma_f32_16x16x32_bf16 v[128:131], v[36:39], v[204:207], v[128:131]
    s_add_u32 s8, s8, 1
    ds_read_b64_tr_b16 v[36:37], v13 offset:49408
    s_waitcnt vmcnt(10)
    s_barrier
    v_mfma_f32_16x16x32_bf16 v[124:127], v[20:23], v[200:203], v[124:127]
    ds_read_b64_tr_b16 v[38:39], v13 offset:55552
    s_cmp_eq_u32 s8, 6
    v_mfma_f32_16x16x32_bf16 v[132:135], v[20:23], v[204:207], v[132:135]
    s_cselect_b32 s8, 0, s8
    ds_read_b64_tr_b16 v[20:21], v16 offset:0
    s_waitcnt lgkmcnt(5)
    v_mfma_f32_16x16x32_bf16 v[136:139], v[24:27], v[200:203], v[136:139]
    ds_read_b64_tr_b16 v[22:23], v16 offset:6144
    s_cmp_eq_u32 s8, s15
    v_mfma_f32_16x16x32_bf16 v[144:147], v[24:27], v[204:207], v[144:147]
    s_addc_u32 s7, s7, 0
    ds_read_b64_tr_b16 v[24:25], v17 offset:0
    v_mfma_f32_16x16x32_bf16 v[140:143], v[28:31], v[200:203], v[140:143]
    ds_read_b64_tr_b16 v[26:27], v17 offset:6144
    s_and_b32 s7, s7, 3
    v_mfma_f32_16x16x32_bf16 v[148:151], v[28:31], v[204:207], v[148:151]
    s_mul_i32 s74, s7, 98304
    ds_read_b64_tr_b16 v[28:29], v18 offset:0
    s_waitcnt lgkmcnt(5)
    v_mfma_f32_16x16x32_bf16 v[152:155], v[32:35], v[200:203], v[152:155]
    ds_read_b64_tr_b16 v[30:31], v18 offset:6144
    s_lshl_b32 s73, s8, 13
    v_mfma_f32_16x16x32_bf16 v[160:163], v[32:35], v[204:207], v[160:163]
    s_add_u32 s74, s74, s73
    ds_read_b64_tr_b16 v[32:33], v19 offset:0
    v_mfma_f32_16x16x32_bf16 v[156:159], v[36:39], v[200:203], v[156:159]
    ds_read_b64_tr_b16 v[34:35], v19 offset:6144
    s_add_u32 s74, s74, s68
    v_mfma_f32_16x16x32_bf16 v[164:167], v[36:39], v[204:207], v[164:167]
    ds_read_b64_tr_b16 v[36:37], v16 offset:128
    s_waitcnt lgkmcnt(5)
    v_mfma_f32_16x16x32_bf16 v[88:91], v[20:23], v[208:211], v[88:91]
    ds_read_b64_tr_b16 v[38:39], v16 offset:6272
    s_cmp_ge_u32 s6, 48
    v_mfma_f32_16x16x32_bf16 v[96:99], v[20:23], v[212:215], v[96:99]
    s_cselect_b32 s74, 0x40000000, s74
    ds_read_b64_tr_b16 v[20:21], v17 offset:128
    v_mfma_f32_16x16x32_bf16 v[92:95], v[24:27], v[208:211], v[92:95]
    ds_read_b64_tr_b16 v[22:23], v17 offset:6272
    s_or_b32 s42, s74, s13
    v_mfma_f32_16x16x32_bf16 v[100:103], v[24:27], v[212:215], v[100:103]
    ds_read_b64_tr_b16 v[24:25], v18 offset:128
    s_waitcnt lgkmcnt(5)
    v_mfma_f32_16x16x32_bf16 v[104:107], v[28:31], v[208:211], v[104:107]
    ds_read_b64_tr_b16 v[26:27], v18 offset:6272
    v_mfma_f32_16x16x32_bf16 v[112:115], v[28:31], v[212:215], v[112:115]
    buffer_load_dwordx4 v[192:195], v11, s[60:63], s74 offen offset:0
    ds_read_b64_tr_b16 v[28:29], v19 offset:128
    v_mfma_f32_16x16x32_bf16 v[108:111], v[32:35], v[208:211], v[108:111]
    ds_read_b64_tr_b16 v[30:31], v19 offset:6272
    v_mfma_f32_16x16x32_bf16 v[116:119], v[32:35], v[212:215], v[116:119]
    buffer_load_dwordx4 v[196:199], v11, s[60:63], s42 offen offset:1024
    ds_read_b64_tr_b16 v[32:33], v16 offset:256
    s_waitcnt lgkmcnt(5)
    v_mfma_f32_16x16x32_bf16 v[120:123], v[36:39], v[208:211], v[120:123]
    ds_read_b64_tr_b16 v[34:35], v16 offset:6400
    s_add_u32 s6, s6, 1
    v_mfma_f32_16x16x32_bf16 v[128:131], v[36:39], v[212:215], v[128:131]
    s_add_u32 s8, s8, 1
    ds_read_b64_tr_b16 v[36:37], v17 offset:256
    s_waitcnt vmcnt(10)
    s_barrier
    v_mfma_f32_16x16x32_bf16 v[124:127], v[20:23], v[208:211], v[124:127]
    ds_read_b64_tr_b16 v[38:39], v17 offset:6400
    s_cmp_eq_u32 s8, 6
    v_mfma_f32_16x16x32_bf16 v[132:135], v[20:23], v[212:215], v[132:135]
    s_cselect_b32 s8, 0, s8
    ds_read_b64_tr_b16 v[20:21], v16 offset:12288
    s_waitcnt lgkmcnt(5)
    v_mfma_f32_16x16x32_bf16 v[136:139], v[24:27], v[208:211], v[136:139]
    ds_read_b64_tr_b16 v[22:23], v16 offset:18432
    s_cmp_eq_u32 s8, s15
    v_mfma_f32_16x16x32_bf16 v[144:147], v[24:27], v[212:215], v[144:147]
    s_addc_u32 s7, s7, 0
    ds_read_b64_tr_b16 v[24:25], v17 offset:12288
    v_mfma_f32_16x16x32_bf16 v[140:143], v[28:31], v[208:211], v[140:143]
    ds_read_b64_tr_b16 v[26:27], v17 offset:18432
    s_and_b32 s7, s7, 3
    v_mfma_f32_16x16x32_bf16 v[148:151], v[28:31], v[212:215], v[148:151]
    s_mul_i32 s74, s7, 98304
    ds_read_b64_tr_b16 v[28:29], v18 offset:12288
    s_waitcnt lgkmcnt(5)
    v_mfma_f32_16x16x32_bf16 v[152:155], v[32:35], v[208:211], v[152:155]
    ds_read_b64_tr_b16 v[30:31], v18 offset:18432
    s_lshl_b32 s73, s8, 13
    v_mfma_f32_16x16x32_bf16 v[160:163], v[32:35], v[212:215], v[160:163]
    s_add_u32 s74, s74, s73
    ds_read_b64_tr_b16 v[32:33], v19 offset:12288
    v_mfma_f32_16x16x32_bf16 v[156:159], v[36:39], v[208:211], v[156:159]
    ds_read_b64_tr_b16 v[34:35], v19 offset:18432
    s_add_u32 s74, s74, s68
    v_mfma_f32_16x16x32_bf16 v[164:167], v[36:39], v[212:215], v[164:167]
    ds_read_b64_tr_b16 v[36:37], v16 offset:12416
    s_waitcnt lgkmcnt(5)
    v_mfma_f32_16x16x32_bf16 v[88:91], v[20:23], v[216:219], v[88:91]
    ds_read_b64_tr_b16 v[38:39], v16 offset:18560
    s_cmp_ge_u32 s6, 48
    v_mfma_f32_16x16x32_bf16 v[96:99], v[20:23], v[220:223], v[96:99]
    s_cselect_b32 s74, 0x40000000, s74
    ds_read_b64_tr_b16 v[20:21], v17 offset:12416
    v_mfma_f32_16x16x32_bf16 v[92:95], v[24:27], v[216:219], v[92:95]
    ds_read_b64_tr_b16 v[22:23], v17 offset:18560
    s_or_b32 s42, s74, s13
    v_mfma_f32_16x16x32_bf16 v[100:103], v[24:27], v[220:223], v[100:103]
    ds_read_b64_tr_b16 v[24:25], v18 offset:12416
    s_waitcnt lgkmcnt(5)
    v_mfma_f32_16x16x32_bf16 v[104:107], v[28:31], v[216:219], v[104:107]
    ds_read_b64_tr_b16 v[26:27], v18 offset:18560
    v_mfma_f32_16x16x32_bf16 v[112:115], v[28:31], v[220:223], v[112:115]
    buffer_load_dwordx4 v[200:203], v11, s[60:63], s74 offen offset:0
    ds_read_b64_tr_b16 v[28:29], v19 offset:12416
    v_mfma_f32_16x16x32_bf16 v[108:111], v[32:35], v[216:219], v[108:111]
    ds_read_b64_tr_b16 v[30:31], v19 offset:18560
    v_mfma_f32_16x16x32_bf16 v[116:119], v[32:35], v[220:223], v[116:119]
    buffer_load_dwordx4 v[204:207], v11, s[60:63], s42 offen offset:1024
    ds_read_b64_tr_b16 v[32:33], v16 offset:12544
    s_waitcnt lgkmcnt(5)
    v_mfma_f32_16x16x32_bf16 v[120:123], v[36:39], v[216:219], v[120:123]
    ds_read_b64_tr_b16 v[34:35], v16 offset:18688
    s_add_u32 s6, s6, 1
    v_mfma_f32_16x16x32_bf16 v[128:131], v[36:39], v[220:223], v[128:131]
    s_add_u32 s8, s8, 1
    ds_read_b64_tr_b16 v[36:37], v17 offset:12544
    s_waitcnt vmcnt(10)
    s_barrier
    v_mfma_f32_16x16x32_bf16 v[124:127], v[20:23], v[216:219], v[124:127]
    ds_read_b64_tr_b16 v[38:39], v17 offset:18688
    s_cmp_eq_u32 s8, 6
    v_mfma_f32_16x16x32_bf16 v[132:135], v[20:23], v[220:223], v[132:135]
    s_cselect_b32 s8, 0, s8
    ds_read_b64_tr_b16 v[20:21], v16 offset:24576
    s_waitcnt lgkmcnt(5)
    v_mfma_f32_16x16x32_bf16 v[136:139], v[24:27], v[216:219], v[136:139]
    ds_read_b64_tr_b16 v[22:23], v16 offset:30720
    s_cmp_eq_u32 s8, s15
    v_mfma_f32_16x16x32_bf16 v[144:147], v[24:27], v[220:223], v[144:147]
    s_addc_u32 s7, s7, 0
    ds_read_b64_tr_b16 v[24:25], v17 offset:24576
    v_mfma_f32_16x16x32_bf16 v[140:143], v[28:31], v[216:219], v[140:143]
    ds_read_b64_tr_b16 v[26:27], v17 offset:30720
    s_and_b32 s7, s7, 3
    v_mfma_f32_16x16x32_bf16 v[148:151], v[28:31], v[220:223], v[148:151]
    s_mul_i32 s74, s7, 98304
    ds_read_b64_tr_b16 v[28:29], v18 offset:24576
    s_waitcnt lgkmcnt(5)
    v_mfma_f32_16x16x32_bf16 v[152:155], v[32:35], v[216:219], v[152:155]
    ds_read_b64_tr_b16 v[30:31], v18 offset:30720
    s_lshl_b32 s73, s8, 13
    v_mfma_f32_16x16x32_bf16 v[160:163], v[32:35], v[220:223], v[160:163]
    s_add_u32 s74, s74, s73
    ds_read_b64_tr_b16 v[32:33], v19 offset:24576
    v_mfma_f32_16x16x32_bf16 v[156:159], v[36:39], v[216:219], v[156:159]
    ds_read_b64_tr_b16 v[34:35], v19 offset:30720
    s_add_u32 s74, s74, s68
    v_mfma_f32_16x16x32_bf16 v[164:167], v[36:39], v[220:223], v[164:167]
    ds_read_b64_tr_b16 v[36:37], v16 offset:24704
    s_waitcnt lgkmcnt(5)
    v_mfma_f32_16x16x32_bf16 v[88:91], v[20:23], v[224:227], v[88:91]
    ds_read_b64_tr_b16 v[38:39], v16 offset:30848
    s_cmp_ge_u32 s6, 48
    v_mfma_f32_16x16x32_bf16 v[96:99], v[20:23], v[228:231], v[96:99]
    s_cselect_b32 s74, 0x40000000, s74
    ds_read_b64_tr_b16 v[20:21], v17 offset:24704
    v_mfma_f32_16x16x32_bf16 v[92:95], v[24:27], v[224:227], v[92:95]
    ds_read_b64_tr_b16 v[22:23], v17 offset:30848
    s_or_b32 s42, s74, s13
    v_mfma_f32_16x16x32_bf16 v[100:103], v[24:27], v[228:231], v[100:103]
    ds_read_b64_tr_b16 v[24:25], v18 offset:24704
    s_waitcnt lgkmcnt(5)
    v_mfma_f32_16x16x32_bf16 v[104:107], v[28:31], v[224:227], v[104:107]
    ds_read_b64_tr_b16 v[26:27], v18 offset:30848
    v_mfma_f32_16x16x32_bf16 v[112:115], v[28:31], v[228:231], v[112:115]
    buffer_load_dwordx4 v[208:211], v11, s[60:63], s74 offen offset:0
    ds_read_b64_tr_b16 v[28:29], v19 offset:24704
    v_mfma_f32_16x16x32_bf16 v[108:111], v[32:35], v[224:227], v[108:111]
    ds_read_b64_tr_b16 v[30:31], v19 offset:30848
    v_mfma_f32_16x16x32_bf16 v[116:119], v[32:35], v[228:231], v[116:119]
    buffer_load_dwordx4 v[212:215], v11, s[60:63], s42 offen offset:1024
    ds_read_b64_tr_b16 v[32:33], v16 offset:24832
    s_waitcnt lgkmcnt(5)
    v_mfma_f32_16x16x32_bf16 v[120:123], v[36:39], v[224:227], v[120:123]
    ds_read_b64_tr_b16 v[34:35], v16 offset:30976
    s_add_u32 s6, s6, 1
    v_mfma_f32_16x16x32_bf16 v[128:131], v[36:39], v[228:231], v[128:131]
    s_add_u32 s8, s8, 1
    ds_read_b64_tr_b16 v[36:37], v17 offset:24832
    s_waitcnt vmcnt(10)
    s_barrier
    v_mfma_f32_16x16x32_bf16 v[124:127], v[20:23], v[224:227], v[124:127]
    ds_read_b64_tr_b16 v[38:39], v17 offset:30976
    s_cmp_eq_u32 s8, 6
    v_mfma_f32_16x16x32_bf16 v[132:135], v[20:23], v[228:231], v[132:135]
    s_cselect_b32 s8, 0, s8
    ds_read_b64_tr_b16 v[20:21], v12 offset:0
    s_waitcnt lgkmcnt(5)
    v_mfma_f32_16x16x32_bf16 v[136:139], v[24:27], v[224:227], v[136:139]
    ds_read_b64_tr_b16 v[22:23], v12 offset:6144
    s_cmp_eq_u32 s8, s15
    v_mfma_f32_16x16x32_bf16 v[144:147], v[24:27], v[228:231], v[144:147]
    s_addc_u32 s7, s7, 0
    ds_read_b64_tr_b16 v[24:25], v13 offset:0
    v_mfma_f32_16x16x32_bf16 v[140:143], v[28:31], v[224:227], v[140:143]
    ds_read_b64_tr_b16 v[26:27], v13 offset:6144
    s_and_b32 s7, s7, 3
    v_mfma_f32_16x16x32_bf16 v[148:151], v[28:31], v[228:231], v[148:151]
    s_mul_i32 s74, s7, 98304
    ds_read_b64_tr_b16 v[28:29], v14 offset:0
    s_waitcnt lgkmcnt(5)
    v_mfma_f32_16x16x32_bf16 v[152:155], v[32:35], v[224:227], v[152:155]
    ds_read_b64_tr_b16 v[30:31], v14 offset:6144
    s_lshl_b32 s73, s8, 13
    v_mfma_f32_16x16x32_bf16 v[160:163], v[32:35], v[228:231], v[160:163]
    s_add_u32 s74, s74, s73
    ds_read_b64_tr_b16 v[32:33], v15 offset:0
    v_mfma_f32_16x16x32_bf16 v[156:159], v[36:39], v[224:227], v[156:159]
    ds_read_b64_tr_b16 v[34:35], v15 offset:6144
    s_add_u32 s74, s74, s68
    v_mfma_f32_16x16x32_bf16 v[164:167], v[36:39], v[228:231], v[164:167]
    s_add_u32 s72, s72, 1
    s_cmp_lt_u32 s72, 6
    s_cbranch_scc1 K1_G_tail
    s_lshl_b32 s79, s90, 2
    s_add_u32 s79, s79, s82
    s_mul_i32 s79, s79, 163840
    s_add_u32 s79, s79, 0x2800000
    s_cmp_eq_u32 s76, 1
    s_cbranch_scc1 K1_fin1
    s_cmp_eq_u32 s76, 2
    s_cbranch_scc1 K1_fin2
    s_cmp_eq_u32 s76, 3
    s_cbranch_scc1 K1_fin3
K1_fin0:
    s_add_u32 s73, s79, 4096
    v_cvt_pk_bf16_f32 v52, v96, v97
    v_cvt_pk_bf16_f32 v53, v98, v99
    v_cvt_pk_bf16_f32 v54, v100, v101
    v_cvt_pk_bf16_f32 v55, v102, v103
    s_or_b32 s73, s73, s13
    buffer_store_dwordx4 v[52:55], v46, s[60:63], s73 offen offset:0 sc1
    s_add_u32 s73, s79, 8192
    v_cvt_pk_bf16_f32 v56, v104, v105
    v_cvt_pk_bf16_f32 v57, v106, v107
    v_cvt_pk_bf16_f32 v58, v108, v109
    v_cvt_pk_bf16_f32 v59, v110, v111
    buffer_store_dwordx4 v[56:59], v46, s[60:63], s73 offen offset:0 sc1
    s_add_u32 s73, s79, 12288
    v_cvt_pk_bf16_f32 v60, v112, v113
    v_cvt_pk_bf16_f32 v61, v114, v115
    v_cvt_pk_bf16_f32 v62, v116, v117
    v_cvt_pk_bf16_f32 v63, v118, v119
    s_or_b32 s73, s73, s13
    buffer_store_dwordx4 v[60:63], v46, s[60:63], s73 offen offset:0 sc1
    s_add_u32 s73, s79, 20480
    v_cvt_pk_bf16_f32 v68, v128, v129
    v_cvt_pk_bf16_f32 v69, v130, v131
    v_cvt_pk_bf16_f32 v70, v132, v133
    v_cvt_pk_bf16_f32 v71, v134, v135
    s_or_b32 s73, s73, s13
    buffer_store_dwordx4 v[68:71], v46, s[60:63], s73 offen offset:0 sc1
    s_add_u32 s73, s79, 24576
    v_cvt_pk_bf16_f32 v72, v136, v137
    v_cvt_pk_bf16_f32 v73, v138, v139
    v_cvt_pk_bf16_f32 v74, v140, v141
    v_cvt_pk_bf16_f32 v75, v142, v143
    buffer_store_dwordx4 v[72:75], v46, s[60:63], s73 offen offset:0 sc1
    s_add_u32 s73, s79, 28672
    v_cvt_pk_bf16_f32 v76, v144, v145
    v_cvt_pk_bf16_f32 v77, v146, v147
    v_cvt_pk_bf16_f32 v78, v148, v149
    v_cvt_pk_bf16_f32 v79, v150, v151
    s_or_b32 s73, s73, s13
    buffer_store_dwordx4 v[76:79], v46, s[60:63], s73 offen offset:0 sc1
    s_add_u32 s73, s79, 36864
    v_cvt_pk_bf16_f32 v84, v160, v161
    v_cvt_pk_bf16_f32 v85, v162, v163
    v_cvt_pk_bf16_f32 v86, v164, v165
    v_cvt_pk_bf16_f32 v87, v166, v167
    s_or_b32 s73, s73, s13
    buffer_store_dwordx4 v[84:87], v46, s[60:63], s73 offen offset:0 sc1
    s_mov_b32 s44, s36
    s_and_b32 s45, s37, 0xffff
    s_mov_b32 s46, 0x230000
    s_mov_b32 s47, 0x20000
    s_lshr_b32 s80, s78, 10
    v_min_u32 v4, 2, v0
    v_add_u32 v4, 1, v4
    v_and_b32 v4, 3, v4
    s_lshl_b32 s73, s90, 4
    s_add_u32 s73, s73, s82
    s_lshl_b32 s73, s73, 7
    s_add_u32 s73, s73, s80
    s_add_u32 s73, s73, 0x3e00050
    v_lshl_add_u32 v4, v4, 9, s73
    s_add_u32 s42, s73, 0
    s_add_u32 s74, s83, 5
    v_mov_b32 v8, 0
    v_mov_b32 v9, s74
    v_and_b32 v1, 15, v0
    s_lshl_b32 s74, s80, 3
    v_add_u32 v1, s74, v1
    v_mul_u32_u24 v1, 0xa00, v1
    v_bfe_u32 v2, v0, 4, 1
    v_lshrrev_b32 v3, 5, v0
    v_lshl_or_b32 v2, v2, 1, v3
    v_lshl_add_u32 v1, v2, 4, v1
    s_mul_i32 s10, s75, 286720
    s_mul_i32 s74, s14, 320
    s_add_u32 s10, s10, s74
    s_mul_i32 s74, s92, 1280
    s_add_u32 s10, s10, s74
    s_waitcnt vmcnt(0)
    s_mov_b64 exec, 1
    buffer_store_dword v9, v8, s[60:63], s42 offen offset:0 sc1
    s_mov_b64 exec, -1
    s_mov_b32 s74, 0
K1_poll177:
    buffer_load_dword v5, v4, s[60:63], 0 offen sc1
    s_waitcnt vmcnt(0)
    s_add_u32 s73, s83, 5
    v_subrev_u32 v5, s73, v5
    v_cmp_lt_u32 vcc, 2, v5
    s_cbranch_vccz K1_polld178
    s_sleep 4
    s_add_u32 s74, s74, 1
    s_cmp_lt_u32 s74, 0x400000
    s_cbranch_scc1 K1_poll177
K1_polld178:
    s_add_u32 s73, s79, 40960
    buffer_load_dwordx4 v[168:171], v46, s[60:63], s73 offen offset:0 sc1
    s_add_u32 s73, s79, 81920
    buffer_load_dwordx4 v[172:175], v46, s[60:63], s73 offen offset:0 sc1
    s_add_u32 s73, s79, 122880
    buffer_load_dwordx4 v[176:179], v46, s[60:63], s73 offen offset:0 sc1
    s_add_u32 s73, s79, 57344
    buffer_load_dwordx4 v[180:183], v46, s[60:63], s73 offen offset:0 sc1
    s_add_u32 s73, s79, 98304
    buffer_load_dwordx4 v[184:187], v46, s[60:63], s73 offen offset:0 sc1
    s_add_u32 s73, s79, 139264
    buffer_load_dwordx4 v[188:191], v46, s[60:63], s73 offen offset:0 sc1
    s_add_u32 s73, s79, 73728
    buffer_load_dwordx4 v[192:195], v46, s[60:63], s73 offen offset:0 sc1
    s_add_u32 s73, s79, 114688
    buffer_load_dwordx4 v[196:199], v46, s[60:63], s73 offen offset:0 sc1
    s_add_u32 s73, s79, 155648
    buffer_load_dwordx4 v[200:203], v46, s[60:63], s73 offen offset:0 sc1
    s_waitcnt vmcnt(6)
    v_lshlrev_b32 v2, 16, v168
    v_and_b32 v3, 0xffff0000, v168
    v_add_f32 v88, v88, v2
    v_add_f32 v89, v89, v3
    v_lshlrev_b32 v2, 16, v169
    v_and_b32 v3, 0xffff0000, v169
    v_add_f32 v90, v90, v2
    v_add_f32 v91, v91, v3
    v_lshlrev_b32 v2, 16, v170
    v_and_b32 v3, 0xffff0000, v170
    v_add_f32 v92, v92, v2
    v_add_f32 v93, v93, v3
    v_lshlrev_b32 v2, 16, v171
    v_and_b32 v3, 0xffff0000, v171
    v_add_f32 v94, v94, v2
    v_add_f32 v95, v95, v3
    v_lshlrev_b32 v2, 16, v172
    v_and_b32 v3, 0xffff0000, v172
    v_add_f32 v88, v88, v2
    v_add_f32 v89, v89, v3
    v_lshlrev_b32 v2, 16, v173
    v_and_b32 v3, 0xffff0000, v173
    v_add_f32 v90, v90, v2
    v_add_f32 v91, v91, v3
    v_lshlrev_b32 v2, 16, v174
    v_and_b32 v3, 0xffff0000, v174
    v_add_f32 v92, v92, v2
    v_add_f32 v93, v93, v3
    v_lshlrev_b32 v2, 16, v175
    v_and_b32 v3, 0xffff0000, v175
    v_add_f32 v94, v94, v2
    v_add_f32 v95, v95, v3
    v_lshlrev_b32 v2, 16, v176
    v_and_b32 v3, 0xffff0000, v176
    v_add_f32 v88, v88, v2
    v_add_f32 v89, v89, v3
    v_lshlrev_b32 v2, 16, v177
    v_and_b32 v3, 0xffff0000, v177
    v_add_f32 v90, v90, v2
    v_add_f32 v91, v91, v3
    v_lshlrev_b32 v2, 16, v178
    v_and_b32 v3, 0xffff0000, v178
    v_add_f32 v92, v92, v2
    v_add_f32 v93, v93, v3
    v_lshlrev_b32 v2, 16, v179
    v_and_b32 v3, 0xffff0000, v179
    v_add_f32 v94, v94, v2
    v_add_f32 v95, v95, v3
    v_cvt_pk_bf16_f32 v48, v88, v89
    v_cvt_pk_bf16_f32 v49, v90, v91
    v_cvt_pk_bf16_f32 v50, v92, v93
    v_cvt_pk_bf16_f32 v51, v94, v95
    s_add_u32 s73, s10, 0
    s_nop 0
    v_permlane16_swap_b32 v48, v50
    v_permlane16_swap_b32 v49, v51
    buffer_store_dwordx4 v[48:51], v1, s[44:47], s73 offen offset:0 nt
    s_waitcnt vmcnt(4)
    v_lshlrev_b32 v2, 16, v180
    v_and_b32 v3, 0xffff0000, v180
    v_add_f32 v120, v120, v2
    v_add_f32 v121, v121, v3
    v_lshlrev_b32 v2, 16, v181
    v_and_b32 v3, 0xffff0000, v181
    v_add_f32 v122, v122, v2
    v_add_f32 v123, v123, v3
    v_lshlrev_b32 v2, 16, v182
    v_and_b32 v3, 0xffff0000, v182
    v_add_f32 v124, v124, v2
    v_add_f32 v125, v125, v3
    v_lshlrev_b32 v2, 16, v183
    v_and_b32 v3, 0xffff0000, v183
    v_add_f32 v126, v126, v2
    v_add_f32 v127, v127, v3
    v_lshlrev_b32 v2, 16, v184
    v_and_b32 v3, 0xffff0000, v184
    v_add_f32 v120, v120, v2
    v_add_f32 v121, v121, v3
    v_lshlrev_b32 v2, 16, v185
    v_and_b32 v3, 0xffff0000, v185
    v_add_f32 v122, v122, v2
    v_add_f32 v123, v123, v3
    v_lshlrev_b32 v2, 16, v186
    v_and_b32 v3, 0xffff0000, v186
    v_add_f32 v124, v124, v2
    v_add_f32 v125, v125, v3
    v_lshlrev_b32 v2, 16, v187
    v_and_b32 v3, 0xffff0000, v187
    v_add_f32 v126, v126, v2
    v_add_f32 v127, v127, v3
    v_lshlrev_b32 v2, 16, v188
    v_and_b32 v3, 0xffff0000, v188
    v_add_f32 v120, v120, v2
    v_add_f32 v121, v121, v3
    v_lshlrev_b32 v2, 16, v189
    v_and_b32 v3, 0xffff0000, v189
    v_add_f32 v122, v122, v2
    v_add_f32 v123, v123, v3
    v_lshlrev_b32 v2, 16, v190
    v_and_b32 v3, 0xffff0000, v190
    v_add_f32 v124, v124, v2
    v_add_f32 v125, v125, v3
    v_lshlrev_b32 v2, 16, v191
    v_and_b32 v3, 0xffff0000, v191
    v_add_f32 v126, v126, v2
    v_add_f32 v127, v127, v3
    v_cvt_pk_bf16_f32 v64, v120, v121
    v_cvt_pk_bf16_f32 v65, v122, v123
    v_cvt_pk_bf16_f32 v66, v124, v125
    v_cvt_pk_bf16_f32 v67, v126, v127
    s_add_u32 s73, s10, 128
    s_nop 0
    v_permlane16_swap_b32 v64, v66
    v_permlane16_swap_b32 v65, v67
    buffer_store_dwordx4 v[64:67], v1, s[44:47], s73 offen offset:0 nt
    s_waitcnt vmcnt(2)
    v_lshlrev_b32 v2, 16, v192
    v_and_b32 v3, 0xffff0000, v192
    v_add_f32 v152, v152, v2
    v_add_f32 v153, v153, v3
    v_lshlrev_b32 v2, 16, v193
    v_and_b32 v3, 0xffff0000, v193
    v_add_f32 v154, v154, v2
    v_add_f32 v155, v155, v3
    v_lshlrev_b32 v2, 16, v194
    v_and_b32 v3, 0xffff0000, v194
    v_add_f32 v156, v156, v2
    v_add_f32 v157, v157, v3
    v_lshlrev_b32 v2, 16, v195
    v_and_b32 v3, 0xffff0000, v195
    v_add_f32 v158, v158, v2
    v_add_f32 v159, v159, v3
    v_lshlrev_b32 v2, 16, v196
    v_and_b32 v3, 0xffff0000, v196
    v_add_f32 v152, v152, v2
    v_add_f32 v153, v153, v3
    v_lshlrev_b32 v2, 16, v197
    v_and_b32 v3, 0xffff0000, v197
    v_add_f32 v154, v154, v2
    v_add_f32 v155, v155, v3
    v_lshlrev_b32 v2, 16, v198
    v_and_b32 v3, 0xffff0000, v198
    v_add_f32 v156, v156, v2
    v_add_f32 v157, v157, v3
    v_lshlrev_b32 v2, 16, v199
    v_and_b32 v3, 0xffff0000, v199
    v_add_f32 v158, v158, v2
    v_add_f32 v159, v159, v3
    v_lshlrev_b32 v2, 16, v200
    v_and_b32 v3, 0xffff0000, v200
    v_add_f32 v152, v152, v2
    v_add_f32 v153, v153, v3
    v_lshlrev_b32 v2, 16, v201
    v_and_b32 v3, 0xffff0000, v201
    v_add_f32 v154, v154, v2
    v_add_f32 v155, v155, v3
    v_lshlrev_b32 v2, 16, v202
    v_and_b32 v3, 0xffff0000, v202
    v_add_f32 v156, v156, v2
    v_add_f32 v157, v157, v3
    v_lshlrev_b32 v2, 16, v203
    v_and_b32 v3, 0xffff0000, v203
    v_add_f32 v158, v158, v2
    v_add_f32 v159, v159, v3
    v_cvt_pk_bf16_f32 v80, v152, v153
    v_cvt_pk_bf16_f32 v81, v154, v155
    v_cvt_pk_bf16_f32 v82, v156, v157
    v_cvt_pk_bf16_f32 v83, v158, v159
    s_add_u32 s73, s10, 256
    s_nop 0
    v_permlane16_swap_b32 v80, v82
    v_permlane16_swap_b32 v81, v83
    buffer_store_dwordx4 v[80:83], v1, s[44:47], s73 offen offset:0 nt
    s_branch K1_fe
K1_fin1:
    s_add_u32 s73, s79, 40960
    v_cvt_pk_bf16_f32 v48, v88, v89
    v_cvt_pk_bf16_f32 v49, v90, v91
    v_cvt_pk_bf16_f32 v50, v92, v93
    v_cvt_pk_bf16_f32 v51, v94, v95
    buffer_store_dwordx4 v[48:51], v46, s[60:63], s73 offen offset:0 sc1
    s_add_u32 s73, s79, 49152
    v_cvt_pk_bf16_f32 v56, v104, v105
    v_cvt_pk_bf16_f32 v57, v106, v107
    v_cvt_pk_bf16_f32 v58, v108, v109
    v_cvt_pk_bf16_f32 v59, v110, v111
    buffer_store_dwordx4 v[56:59], v46, s[60:63], s73 offen offset:0 sc1
    s_add_u32 s73, s79, 53248
    v_cvt_pk_bf16_f32 v60, v112, v113
    v_cvt_pk_bf16_f32 v61, v114, v115
    v_cvt_pk_bf16_f32 v62, v116, v117
    v_cvt_pk_bf16_f32 v63, v118, v119
    s_or_b32 s73, s73, s13
    buffer_store_dwordx4 v[60:63], v46, s[60:63], s73 offen offset:0 sc1
    s_add_u32 s73, s79, 57344
    v_cvt_pk_bf16_f32 v64, v120, v121
    v_cvt_pk_bf16_f32 v65, v122, v123
    v_cvt_pk_bf16_f32 v66, v124, v125
    v_cvt_pk_bf16_f32 v67, v126, v127
    buffer_store_dwordx4 v[64:67], v46, s[60:63], s73 offen offset:0 sc1
    s_add_u32 s73, s79, 65536
    v_cvt_pk_bf16_f32 v72, v136, v137
    v_cvt_pk_bf16_f32 v73, v138, v139
    v_cvt_pk_bf16_f32 v74, v140, v141
    v_cvt_pk_bf16_f32 v75, v142, v143
    buffer_store_dwordx4 v[72:75], v46, s[60:63], s73 offen offset:0 sc1
    s_add_u32 s73, s79, 69632
    v_cvt_pk_bf16_f32 v76, v144, v145
    v_cvt_pk_bf16_f32 v77, v146, v147
    v_cvt_pk_bf16_f32 v78, v148, v149
    v_cvt_pk_bf16_f32 v79, v150, v151
    s_or_b32 s73, s73, s13
    buffer_store_dwordx4 v[76:79], v46, s[60:63], s73 offen offset:0 sc1
    s_add_u32 s73, s79, 73728
    v_cvt_pk_bf16_f32 v80, v152, v153
    v_cvt_pk_bf16_f32 v81, v154, v155
    v_cvt_pk_bf16_f32 v82, v156, v157
    v_cvt_pk_bf16_f32 v83, v158, v159
    buffer_store_dwordx4 v[80:83], v46, s[60:63], s73 offen offset:0 sc1
    s_mov_b32 s44, s36
    s_and_b32 s45, s37, 0xffff
    s_mov_b32 s46, 0x230000
    s_mov_b32 s47, 0x20000
    s_lshr_b32 s80, s78, 10
    v_min_u32 v4, 2, v0
    v_add_u32 v4, 2, v4
    v_and_b32 v4, 3, v4
    s_lshl_b32 s73, s90, 4
    s_add_u32 s73, s73, s82
    s_lshl_b32 s73, s73, 7
    s_add_u32 s73, s73, s80
    s_add_u32 s73, s73, 0x3e00050
    v_lshl_add_u32 v4, v4, 9, s73
    s_add_u32 s42, s73, 512
    s_add_u32 s74, s83, 5
    v_mov_b32 v8, 0
    v_mov_b32 v9, s74
    v_and_b32 v1, 15, v0
    s_lshl_b32 s74, s80, 3
    v_add_u32 v1, s74, v1
    v_mul_u32_u24 v1, 0xa00, v1
    v_bfe_u32 v2, v0, 4, 1
    v_lshrrev_b32 v3, 5, v0
    v_lshl_or_b32 v2, v2, 1, v3
    v_lshl_add_u32 v1, v2, 4, v1
    s_mul_i32 s10, s75, 286720
    s_mul_i32 s74, s14, 320
    s_add_u32 s10, s10, s74
    s_mul_i32 s74, s92, 1280
    s_add_u32 s10, s10, s74
    s_or_b32 s10, s10, s13
    s_or_b32 s79, s79, s13
    s_waitcnt vmcnt(0)
    s_mov_b64 exec, 1
    buffer_store_dword v9, v8, s[60:63], s42 offen offset:0 sc1
    s_mov_b64 exec, -1
    s_mov_b32 s74, 0
K1_poll179:
    buffer_load_dword v5, v4, s[60:63], 0 offen sc1
    s_waitcnt vmcnt(0)
    s_add_u32 s73, s83, 5
    v_subrev_u32 v5, s73, v5
    v_cmp_lt_u32 vcc, 2, v5
    s_cbranch_vccz K1_polld180
    s_sleep 4
    s_add_u32 s74, s74, 1
    s_cmp_lt_u32 s74, 0x400000
    s_cbranch_scc1 K1_poll179
K1_polld180:
    s_add_u32 s73, s79, 86016
    buffer_load_dwordx4 v[168:171], v46, s[60:63], s73 offen offset:0 sc1
    s_add_u32 s73, s79, 126976
    buffer_load_dwordx4 v[172:175], v46, s[60:63], s73 offen offset:0 sc1
    s_add_u32 s73, s79, 4096
    buffer_load_dwordx4 v[176:179], v46, s[60:63], s73 offen offset:0 sc1
    s_add_u32 s73, s79, 102400
    buffer_load_dwordx4 v[180:183], v46, s[60:63], s73 offen offset:0 sc1
    s_add_u32 s73, s79, 143360
    buffer_load_dwordx4 v[184:187], v46, s[60:63], s73 offen offset:0 sc1
    s_add_u32 s73, s79, 20480
    buffer_load_dwordx4 v[188:191], v46, s[60:63], s73 offen offset:0 sc1
    s_add_u32 s73, s79, 118784
    buffer_load_dwordx4 v[192:195], v46, s[60:63], s73 offen offset:0 sc1
    s_add_u32 s73, s79, 159744
    buffer_load_dwordx4 v[196:199], v46, s[60:63], s73 offen offset:0 sc1
    s_add_u32 s73, s79, 36864
    buffer_load_dwordx4 v[200:203], v46, s[60:63], s73 offen offset:0 sc1
    s_waitcnt vmcnt(6)
    v_lshlrev_b32 v2, 16, v168
    v_and_b32 v3, 0xffff0000, v168
    v_add_f32 v96, v96, v2
    v_add_f32 v97, v97, v3
    v_lshlrev_b32 v2, 16, v169
    v_and_b32 v3, 0xffff0000, v169
    v_add_f32 v98, v98, v2
    v_add_f32 v99, v99, v3
    v_lshlrev_b32 v2, 16, v170
    v_and_b32 v3, 0xffff0000, v170
    v_add_f32 v100, v100, v2
    v_add_f32 v101, v101, v3
    v_lshlrev_b32 v2, 16, v171
    v_and_b32 v3, 0xffff0000, v171
    v_add_f32 v102, v102, v2
    v_add_f32 v103, v103, v3
    v_lshlrev_b32 v2, 16, v172
    v_and_b32 v3, 0xffff0000, v172
    v_add_f32 v96, v96, v2
    v_add_f32 v97, v97, v3
    v_lshlrev_b32 v2, 16, v173
    v_and_b32 v3, 0xffff0000, v173
    v_add_f32 v98, v98, v2
    v_add_f32 v99, v99, v3
    v_lshlrev_b32 v2, 16, v174
    v_and_b32 v3, 0xffff0000, v174
    v_add_f32 v100, v100, v2
    v_add_f32 v101, v101, v3
    v_lshlrev_b32 v2, 16, v175
    v_and_b32 v3, 0xffff0000, v175
    v_add_f32 v102, v102, v2
    v_add_f32 v103, v103, v3
    v_lshlrev_b32 v2, 16, v176
    v_and_b32 v3, 0xffff0000, v176
    v_add_f32 v96, v96, v2
    v_add_f32 v97, v97, v3
    v_lshlrev_b32 v2, 16, v177
    v_and_b32 v3, 0xffff0000, v177
    v_add_f32 v98, v98, v2
    v_add_f32 v99, v99, v3
    v_lshlrev_b32 v2, 16, v178
    v_and_b32 v3, 0xffff0000, v178
    v_add_f32 v100, v100, v2
    v_add_f32 v101, v101, v3
    v_lshlrev_b32 v2, 16, v179
    v_and_b32 v3, 0xffff0000, v179
    v_add_f32 v102, v102, v2
    v_add_f32 v103, v103, v3
    v_cvt_pk_bf16_f32 v52, v96, v97
    v_cvt_pk_bf16_f32 v53, v98, v99
    v_cvt_pk_bf16_f32 v54, v100, v101
    v_cvt_pk_bf16_f32 v55, v102, v103
    s_add_u32 s73, s10, 40960
    s_nop 0
    v_permlane16_swap_b32 v52, v54
    v_permlane16_swap_b32 v53, v55
    buffer_store_dwordx4 v[52:55], v1, s[44:47], s73 offen offset:0 nt
    s_waitcnt vmcnt(4)
    v_lshlrev_b32 v2, 16, v180
    v_and_b32 v3, 0xffff0000, v180
    v_add_f32 v128, v128, v2
    v_add_f32 v129, v129, v3
    v_lshlrev_b32 v2, 16, v181
    v_and_b32 v3, 0xffff0000, v181
    v_add_f32 v130, v130, v2
    v_add_f32 v131, v131, v3
    v_lshlrev_b32 v2, 16, v182
    v_and_b32 v3, 0xffff0000, v182
    v_add_f32 v132, v132, v2
    v_add_f32 v133, v133, v3
    v_lshlrev_b32 v2, 16, v183
    v_and_b32 v3, 0xffff0000, v183
    v_add_f32 v134, v134, v2
    v_add_f32 v135, v135, v3
    v_lshlrev_b32 v2, 16, v184
    v_and_b32 v3, 0xffff0000, v184
    v_add_f32 v128, v128, v2
    v_add_f32 v129, v129, v3
    v_lshlrev_b32 v2, 16, v185
    v_and_b32 v3, 0xffff0000, v185
    v_add_f32 v130, v130, v2
    v_add_f32 v131, v131, v3
    v_lshlrev_b32 v2, 16, v186
    v_and_b32 v3, 0xffff0000, v186
    v_add_f32 v132, v132, v2
    v_add_f32 v133, v133, v3
    v_lshlrev_b32 v2, 16, v187
    v_and_b32 v3, 0xffff0000, v187
    v_add_f32 v134, v134, v2
    v_add_f32 v135, v135, v3
    v_lshlrev_b32 v2, 16, v188
    v_and_b32 v3, 0xffff0000, v188
    v_add_f32 v128, v128, v2
    v_add_f32 v129, v129, v3
    v_lshlrev_b32 v2, 16, v189
    v_and_b32 v3, 0xffff0000, v189
    v_add_f32 v130, v130, v2
    v_add_f32 v131, v131, v3
    v_lshlrev_b32 v2, 16, v190
    v_and_b32 v3, 0xffff0000, v190
    v_add_f32 v132, v132, v2
    v_add_f32 v133, v133, v3
    v_lshlrev_b32 v2, 16, v191
    v_and_b32 v3, 0xffff0000, v191
    v_add_f32 v134, v134, v2
    v_add_f32 v135, v135, v3
    v_cvt_pk_bf16_f32 v68, v128, v129
    v_cvt_pk_bf16_f32 v69, v130, v131
    v_cvt_pk_bf16_f32 v70, v132, v133
    v_cvt_pk_bf16_f32 v71, v134, v135
    s_add_u32 s73, s10, 41088
    s_nop 0
    v_permlane16_swap_b32 v68, v70
    v_permlane16_swap_b32 v69, v71
    buffer_store_dwordx4 v[68:71], v1, s[44:47], s73 offen offset:0 nt
    s_waitcnt vmcnt(2)
    v_lshlrev_b32 v2, 16, v192
    v_and_b32 v3, 0xffff0000, v192
    v_add_f32 v160, v160, v2
    v_add_f32 v161, v161, v3
    v_lshlrev_b32 v2, 16, v193
    v_and_b32 v3, 0xffff0000, v193
    v_add_f32 v162, v162, v2
    v_add_f32 v163, v163, v3
    v_lshlrev_b32 v2, 16, v194
    v_and_b32 v3, 0xffff0000, v194
    v_add_f32 v164, v164, v2
    v_add_f32 v165, v165, v3
    v_lshlrev_b32 v2, 16, v195
    v_and_b32 v3, 0xffff0000, v195
    v_add_f32 v166, v166, v2
    v_add_f32 v167, v167, v3
    v_lshlrev_b32 v2, 16, v196
    v_and_b32 v3, 0xffff0000, v196
    v_add_f32 v160, v160, v2
    v_add_f32 v161, v161, v3
    v_lshlrev_b32 v2, 16, v197
    v_and_b32 v3, 0xffff0000, v197
    v_add_f32 v162, v162, v2
    v_add_f32 v163, v163, v3
    v_lshlrev_b32 v2, 16, v198
    v_and_b32 v3, 0xffff0000, v198
    v_add_f32 v164, v164, v2
    v_add_f32 v165, v165, v3
    v_lshlrev_b32 v2, 16, v199
    v_and_b32 v3, 0xffff0000, v199
    v_add_f32 v166, v166, v2
    v_add_f32 v167, v167, v3
    v_lshlrev_b32 v2, 16, v200
    v_and_b32 v3, 0xffff0000, v200
    v_add_f32 v160, v160, v2
    v_add_f32 v161, v161, v3
    v_lshlrev_b32 v2, 16, v201
    v_and_b32 v3, 0xffff0000, v201
    v_add_f32 v162, v162, v2
    v_add_f32 v163, v163, v3
    v_lshlrev_b32 v2, 16, v202
    v_and_b32 v3, 0xffff0000, v202
    v_add_f32 v164, v164, v2
    v_add_f32 v165, v165, v3
    v_lshlrev_b32 v2, 16, v203
    v_and_b32 v3, 0xffff0000, v203
    v_add_f32 v166, v166, v2
    v_add_f32 v167, v167, v3
    v_cvt_pk_bf16_f32 v84, v160, v161
    v_cvt_pk_bf16_f32 v85, v162, v163
    v_cvt_pk_bf16_f32 v86, v164, v165
    v_cvt_pk_bf16_f32 v87, v166, v167
    s_add_u32 s73, s10, 41216
    s_nop 0
    v_permlane16_swap_b32 v84, v86
    v_permlane16_swap_b32 v85, v87
    buffer_store_dwordx4 v[84:87], v1, s[44:47], s73 offen offset:0 nt
    s_branch K1_fe
K1_fin2:
    s_add_u32 s73, s79, 81920
    v_cvt_pk_bf16_f32 v48, v88, v89
    v_cvt_pk_bf16_f32 v49, v90, v91
    v_cvt_pk_bf16_f32 v50, v92, v93
    v_cvt_pk_bf16_f32 v51, v94, v95
    buffer_store_dwordx4 v[48:51], v46, s[60:63], s73 offen offset:0 sc1
    s_add_u32 s73, s79, 86016
    v_cvt_pk_bf16_f32 v52, v96, v97
    v_cvt_pk_bf16_f32 v53, v98, v99
    v_cvt_pk_bf16_f32 v54, v100, v101
    v_cvt_pk_bf16_f32 v55, v102, v103
    s_or_b32 s73, s73, s13
    buffer_store_dwordx4 v[52:55], v46, s[60:63], s73 offen offset:0 sc1
    s_add_u32 s73, s79, 94208
    v_cvt_pk_bf16_f32 v60, v112, v113
    v_cvt_pk_bf16_f32 v61, v114, v115
    v_cvt_pk_bf16_f32 v62, v116, v117
    v_cvt_pk_bf16_f32 v63, v118, v119
    s_or_b32 s73, s73, s13
    buffer_store_dwordx4 v[60:63], v46, s[60:63], s73 offen offset:0 sc1
    s_add_u32 s73, s79, 98304
    v_cvt_pk_bf16_f32 v64, v120, v121
    v_cvt_pk_bf16_f32 v65, v122, v123
    v_cvt_pk_bf16_f32 v66, v124, v125
    v_cvt_pk_bf16_f32 v67, v126, v127
    buffer_store_dwordx4 v[64:67], v46, s[60:63], s73 offen offset:0 sc1
    s_add_u32 s73, s79, 102400
    v_cvt_pk_bf16_f32 v68, v128, v129
    v_cvt_pk_bf16_f32 v69, v130, v131
    v_cvt_pk_bf16_f32 v70, v132, v133
    v_cvt_pk_bf16_f32 v71, v134, v135
    s_or_b32 s73, s73, s13
    buffer_store_dwordx4 v[68:71], v46, s[60:63], s73 offen offset:0 sc1
    s_add_u32 s73, s79, 110592
    v_cvt_pk_bf16_f32 v76, v144, v145
    v_cvt_pk_bf16_f32 v77, v146, v147
    v_cvt_pk_bf16_f32 v78, v148, v149
    v_cvt_pk_bf16_f32 v79, v150, v151
    s_or_b32 s73, s73, s13
    buffer_store_dwordx4 v[76:79], v46, s[60:63], s73 offen offset:0 sc1
    s_add_u32 s73, s79, 114688
    v_cvt_pk_bf16_f32 v80, v152, v153
    v_cvt_pk_bf16_f32 v81, v154, v155
    v_cvt_pk_bf16_f32 v82, v156, v157
    v_cvt_pk_bf16_f32 v83, v158, v159
    buffer_store_dwordx4 v[80:83], v46, s[60:63], s73 offen offset:0 sc1
    s_add_u32 s73, s79, 118784
    v_cvt_pk_bf16_f32 v84, v160, v161
    v_cvt_pk_bf16_f32 v85, v162, v163
    v_cvt_pk_bf16_f32 v86, v164, v165
    v_cvt_pk_bf16_f32 v87, v166, v167
    s_or_b32 s73, s73, s13
    buffer_store_dwordx4 v[84:87], v46, s[60:63], s73 offen offset:0 sc1
    s_mov_b32 s44, s36
    s_and_b32 s45, s37, 0xffff
    s_mov_b32 s46, 0x230000
    s_mov_b32 s47, 0x20000
    s_lshr_b32 s80, s78, 10
    v_min_u32 v4, 2, v0
    v_add_u32 v4, 3, v4
    v_and_b32 v4, 3, v4
    s_lshl_b32 s73, s90, 4
    s_add_u32 s73, s73, s82
    s_lshl_b32 s73, s73, 7
    s_add_u32 s73, s73, s80
    s_add_u32 s73, s73, 0x3e00050
    v_lshl_add_u32 v4, v4, 9, s73
    s_add_u32 s42, s73, 1024
    s_add_u32 s74, s83, 5
    v_mov_b32 v8, 0
    v_mov_b32 v9, s74
    v_and_b32 v1, 15, v0
    s_lshl_b32 s74, s80, 3
    v_add_u32 v1, s74, v1
    v_mul_u32_u24 v1, 0xa00, v1
    v_bfe_u32 v2, v0, 4, 1
    v_lshrrev_b32 v3, 5, v0
    v_lshl_or_b32 v2, v2, 1, v3
    v_lshl_add_u32 v1, v2, 4, v1
    s_mul_i32 s10, s75, 286720
    s_mul_i32 s74, s14, 320
    s_add_u32 s10, s10, s74
    s_mul_i32 s74, s92, 1280
    s_add_u32 s10, s10, s74
    s_waitcnt vmcnt(0)
    s_mov_b64 exec, 1
    buffer_store_dword v9, v8, s[60:63], s42 offen offset:0 sc1
    s_mov_b64 exec, -1
    s_mov_b32 s74, 0
K1_poll181:
    buffer_load_dword v5, v4, s[60:63], 0 offen sc1
    s_waitcnt vmcnt(0)
    s_add_u32 s73, s83, 5
    v_subrev_u32 v5, s73, v5
    v_cmp_lt_u32 vcc, 2, v5
    s_cbranch_vccz K1_polld182
    s_sleep 4
    s_add_u32 s74, s74, 1
    s_cmp_lt_u32 s74, 0x400000
    s_cbranch_scc1 K1_poll181
K1_polld182:
    s_add_u32 s73, s79, 131072
    buffer_load_dwordx4 v[168:171], v46, s[60:63], s73 offen offset:0 sc1
    s_add_u32 s73, s79, 8192
    buffer_load_dwordx4 v[172:175], v46, s[60:63], s73 offen offset:0 sc1
    s_add_u32 s73, s79, 49152
    buffer_load_dwordx4 v[176:179], v46, s[60:63], s73 offen offset:0 sc1
    s_add_u32 s73, s79, 147456
    buffer_load_dwordx4 v[180:183], v46, s[60:63], s73 offen offset:0 sc1
    s_add_u32 s73, s79, 24576
    buffer_load_dwordx4 v[184:187], v46, s[60:63], s73 offen offset:0 sc1
    s_add_u32 s73, s79, 65536
    buffer_load_dwordx4 v[188:191], v46, s[60:63], s73 offen offset:0 sc1
    s_waitcnt vmcnt(3)
    v_lshlrev_b32 v2, 16, v168
    v_and_b32 v3, 0xffff0000, v168
    v_add_f32 v104, v104, v2
    v_add_f32 v105, v105, v3
    v_lshlrev_b32 v2, 16, v169
    v_and_b32 v3, 0xffff0000, v169
    v_add_f32 v106, v106, v2
    v_add_f32 v107, v107, v3
    v_lshlrev_b32 v2, 16, v170
    v_and_b32 v3, 0xffff0000, v170
    v_add_f32 v108, v108, v2
    v_add_f32 v109, v109, v3
    v_lshlrev_b32 v2, 16, v171
    v_and_b32 v3, 0xffff0000, v171
    v_add_f32 v110, v110, v2
    v_add_f32 v111, v111, v3
    v_lshlrev_b32 v2, 16, v172
    v_and_b32 v3, 0xffff0000, v172
    v_add_f32 v104, v104, v2
    v_add_f32 v105, v105, v3
    v_lshlrev_b32 v2, 16, v173
    v_and_b32 v3, 0xffff0000, v173
    v_add_f32 v106, v106, v2
    v_add_f32 v107, v107, v3
    v_lshlrev_b32 v2, 16, v174
    v_and_b32 v3, 0xffff0000, v174
    v_add_f32 v108, v108, v2
    v_add_f32 v109, v109, v3
    v_lshlrev_b32 v2, 16, v175
    v_and_b32 v3, 0xffff0000, v175
    v_add_f32 v110, v110, v2
    v_add_f32 v111, v111, v3
    v_lshlrev_b32 v2, 16, v176
    v_and_b32 v3, 0xffff0000, v176
    v_add_f32 v104, v104, v2
    v_add_f32 v105, v105, v3
    v_lshlrev_b32 v2, 16, v177
    v_and_b32 v3, 0xffff0000, v177
    v_add_f32 v106, v106, v2
    v_add_f32 v107, v107, v3
    v_lshlrev_b32 v2, 16, v178
    v_and_b32 v3, 0xffff0000, v178
    v_add_f32 v108, v108, v2
    v_add_f32 v109, v109, v3
    v_lshlrev_b32 v2, 16, v179
    v_and_b32 v3, 0xffff0000, v179
    v_add_f32 v110, v110, v2
    v_add_f32 v111, v111, v3
    v_cvt_pk_bf16_f32 v56, v104, v105
    v_cvt_pk_bf16_f32 v57, v106, v107
    v_cvt_pk_bf16_f32 v58, v108, v109
    v_cvt_pk_bf16_f32 v59, v110, v111
    s_add_u32 s73, s10, 64
    s_nop 0
    v_permlane16_swap_b32 v56, v58
    v_permlane16_swap_b32 v57, v59
    buffer_store_dwordx4 v[56:59], v1, s[44:47], s73 offen offset:0 nt
    s_waitcnt vmcnt(1)
    v_lshlrev_b32 v2, 16, v180
    v_and_b32 v3, 0xffff0000, v180
    v_add_f32 v136, v136, v2
    v_add_f32 v137, v137, v3
    v_lshlrev_b32 v2, 16, v181
    v_and_b32 v3, 0xffff0000, v181
    v_add_f32 v138, v138, v2
    v_add_f32 v139, v139, v3
    v_lshlrev_b32 v2, 16, v182
    v_and_b32 v3, 0xffff0000, v182
    v_add_f32 v140, v140, v2
    v_add_f32 v141, v141, v3
    v_lshlrev_b32 v2, 16, v183
    v_and_b32 v3, 0xffff0000, v183
    v_add_f32 v142, v142, v2
    v_add_f32 v143, v143, v3
    v_lshlrev_b32 v2, 16, v184
    v_and_b32 v3, 0xffff0000, v184
    v_add_f32 v136, v136, v2
    v_add_f32 v137, v137, v3
    v_lshlrev_b32 v2, 16, v185
    v_and_b32 v3, 0xffff0000, v185
    v_add_f32 v138, v138, v2
    v_add_f32 v139, v139, v3
    v_lshlrev_b32 v2, 16, v186
    v_and_b32 v3, 0xffff0000, v186
    v_add_f32 v140, v140, v2
    v_add_f32 v141, v141, v3
    v_lshlrev_b32 v2, 16, v187
    v_and_b32 v3, 0xffff0000, v187
    v_add_f32 v142, v142, v2
    v_add_f32 v143, v143, v3
    v_lshlrev_b32 v2, 16, v188
    v_and_b32 v3, 0xffff0000, v188
    v_add_f32 v136, v136, v2
    v_add_f32 v137, v137, v3
    v_lshlrev_b32 v2, 16, v189
    v_and_b32 v3, 0xffff0000, v189
    v_add_f32 v138, v138, v2
    v_add_f32 v139, v139, v3
    v_lshlrev_b32 v2, 16, v190
    v_and_b32 v3, 0xffff0000, v190
    v_add_f32 v140, v140, v2
    v_add_f32 v141, v141, v3
    v_lshlrev_b32 v2, 16, v191
    v_and_b32 v3, 0xffff0000, v191
    v_add_f32 v142, v142, v2
    v_add_f32 v143, v143, v3
    v_cvt_pk_bf16_f32 v72, v136, v137
    v_cvt_pk_bf16_f32 v73, v138, v139
    v_cvt_pk_bf16_f32 v74, v140, v141
    v_cvt_pk_bf16_f32 v75, v142, v143
    s_add_u32 s73, s10, 192
    s_nop 0
    v_permlane16_swap_b32 v72, v74
    v_permlane16_swap_b32 v73, v75
    buffer_store_dwordx4 v[72:75], v1, s[44:47], s73 offen offset:0 nt
    s_branch K1_fe
K1_fin3:
    s_add_u32 s73, s79, 122880
    v_cvt_pk_bf16_f32 v48, v88, v89
    v_cvt_pk_bf16_f32 v49, v90, v91
    v_cvt_pk_bf16_f32 v50, v92, v93
    v_cvt_pk_bf16_f32 v51, v94, v95
    buffer_store_dwordx4 v[48:51], v46, s[60:63], s73 offen offset:0 sc1
    s_add_u32 s73, s79, 126976
    v_cvt_pk_bf16_f32 v52, v96, v97
    v_cvt_pk_bf16_f32 v53, v98, v99
    v_cvt_pk_bf16_f32 v54, v100, v101
    v_cvt_pk_bf16_f32 v55, v102, v103
    s_or_b32 s73, s73, s13
    buffer_store_dwordx4 v[52:55], v46, s[60:63], s73 offen offset:0 sc1
    s_add_u32 s73, s79, 131072
    v_cvt_pk_bf16_f32 v56, v104, v105
    v_cvt_pk_bf16_f32 v57, v106, v107
    v_cvt_pk_bf16_f32 v58, v108, v109
    v_cvt_pk_bf16_f32 v59, v110, v111
    buffer_store_dwordx4 v[56:59], v46, s[60:63], s73 offen offset:0 sc1
    s_add_u32 s73, s79, 139264
    v_cvt_pk_bf16_f32 v64, v120, v121
    v_cvt_pk_bf16_f32 v65, v122, v123
    v_cvt_pk_bf16_f32 v66, v124, v125
    v_cvt_pk_bf16_f32 v67, v126, v127
    buffer_store_dwordx4 v[64:67], v46, s[60:63], s73 offen offset:0 sc1
    s_add_u32 s73, s79, 143360
    v_cvt_pk_bf16_f32 v68, v128, v129
    v_cvt_pk_bf16_f32 v69, v130, v131
    v_cvt_pk_bf16_f32 v70, v132, v133
    v_cvt_pk_bf16_f32 v71, v134, v135
    s_or_b32 s73, s73, s13
    buffer_store_dwordx4 v[68:71], v46, s[60:63], s73 offen offset:0 sc1
    s_add_u32 s73, s79, 147456
    v_cvt_pk_bf16_f32 v72, v136, v137
    v_cvt_pk_bf16_f32 v73, v138, v139
    v_cvt_pk_bf16_f32 v74, v140, v141
    v_cvt_pk_bf16_f32 v75, v142, v143
    buffer_store_dwordx4 v[72:75], v46, s[60:63], s73 offen offset:0 sc1
    s_add_u32 s73, s79, 155648
    v_cvt_pk_bf16_f32 v80, v152, v153
    v_cvt_pk_bf16_f32 v81, v154, v155
    v_cvt_pk_bf16_f32 v82, v156, v157
    v_cvt_pk_bf16_f32 v83, v158, v159
    buffer_store_dwordx4 v[80:83], v46, s[60:63], s73 offen offset:0 sc1
    s_add_u32 s73, s79, 159744
    v_cvt_pk_bf16_f32 v84, v160, v161
    v_cvt_pk_bf16_f32 v85, v162, v163
    v_cvt_pk_bf16_f32 v86, v164, v165
    v_cvt_pk_bf16_f32 v87, v166, v167
    s_or_b32 s73, s73, s13
    buffer_store_dwordx4 v[84:87], v46, s[60:63], s73 offen offset:0 sc1
    s_mov_b32 s44, s36
    s_and_b32 s45, s37, 0xffff
    s_mov_b32 s46, 0x230000
    s_mov_b32 s47, 0x20000
    s_lshr_b32 s80, s78, 10
    v_min_u32 v4, 2, v0
    v_add_u32 v4, 4, v4
    v_and_b32 v4, 3, v4
    s_lshl_b32 s73, s90, 4
    s_add_u32 s73, s73, s82
    s_lshl_b32 s73, s73, 7
    s_add_u32 s73, s73, s80
    s_add_u32 s73, s73, 0x3e00050
    v_lshl_add_u32 v4, v4, 9, s73
    s_add_u32 s42, s73, 1536
    s_add_u32 s74, s83, 5
    v_mov_b32 v8, 0
    v_mov_b32 v9, s74
    v_and_b32 v1, 15, v0
    s_lshl_b32 s74, s80, 3
    v_add_u32 v1, s74, v1
    v_mul_u32_u24 v1, 0xa00, v1
    v_bfe_u32 v2, v0, 4, 1
    v_lshrrev_b32 v3, 5, v0
    v_lshl_or_b32 v2, v2, 1, v3
    v_lshl_add_u32 v1, v2, 4, v1
    s_mul_i32 s10, s75, 286720
    s_mul_i32 s74, s14, 320
    s_add_u32 s10, s10, s74
    s_mul_i32 s74, s92, 1280
    s_add_u32 s10, s10, s74
    s_or_b32 s10, s10, s13
    s_or_b32 s79, s79, s13
    s_waitcnt vmcnt(0)
    s_mov_b64 exec, 1
    buffer_store_dword v9, v8, s[60:63], s42 offen offset:0 sc1
    s_mov_b64 exec, -1
    s_mov_b32 s74, 0
K1_poll183:
    buffer_load_dword v5, v4, s[60:63], 0 offen sc1
    s_waitcnt vmcnt(0)
    s_add_u32 s73, s83, 5
    v_subrev_u32 v5, s73, v5
    v_cmp_lt_u32 vcc, 2, v5
    s_cbranch_vccz K1_polld184
    s_sleep 4
    s_add_u32 s74, s74, 1
    s_cmp_lt_u32 s74, 0x400000
    s_cbranch_scc1 K1_poll183
K1_polld184:
    s_add_u32 s73, s79, 12288
    buffer_load_dwordx4 v[168:171], v46, s[60:63], s73 offen offset:0 sc1
    s_add_u32 s73, s79, 53248
    buffer_load_dwordx4 v[172:175], v46, s[60:63], s73 offen offset:0 sc1
    s_add_u32 s73, s79, 94208
    buffer_load_dwordx4 v[176:179], v46, s[60:63], s73 offen offset:0 sc1
    s_add_u32 s73, s79, 28672
    buffer_load_dwordx4 v[180:183], v46, s[60:63], s73 offen offset:0 sc1
    s_add_u32 s73, s79, 69632
    buffer_load_dwordx4 v[184:187], v46, s[60:63], s73 offen offset:0 sc1
    s_add_u32 s73, s79, 110592
    buffer_load_dwordx4 v[188:191], v46, s[60:63], s73 offen offset:0 sc1
    s_waitcnt vmcnt(3)
    v_lshlrev_b32 v2, 16, v168
    v_and_b32 v3, 0xffff0000, v168
    v_add_f32 v112, v112, v2
    v_add_f32 v113, v113, v3
    v_lshlrev_b32 v2, 16, v169
    v_and_b32 v3, 0xffff0000, v169
    v_add_f32 v114, v114, v2
    v_add_f32 v115, v115, v3
    v_lshlrev_b32 v2, 16, v170
    v_and_b32 v3, 0xffff0000, v170
    v_add_f32 v116, v116, v2
    v_add_f32 v117, v117, v3
    v_lshlrev_b32 v2, 16, v171
    v_and_b32 v3, 0xffff0000, v171
    v_add_f32 v118, v118, v2
    v_add_f32 v119, v119, v3
    v_lshlrev_b32 v2, 16, v172
    v_and_b32 v3, 0xffff0000, v172
    v_add_f32 v112, v112, v2
    v_add_f32 v113, v113, v3
    v_lshlrev_b32 v2, 16, v173
    v_and_b32 v3, 0xffff0000, v173
    v_add_f32 v114, v114, v2
    v_add_f32 v115, v115, v3
    v_lshlrev_b32 v2, 16, v174
    v_and_b32 v3, 0xffff0000, v174
    v_add_f32 v116, v116, v2
    v_add_f32 v117, v117, v3
    v_lshlrev_b32 v2, 16, v175
    v_and_b32 v3, 0xffff0000, v175
    v_add_f32 v118, v118, v2
    v_add_f32 v119, v119, v3
    v_lshlrev_b32 v2, 16, v176
    v_and_b32 v3, 0xffff0000, v176
    v_add_f32 v112, v112, v2
    v_add_f32 v113, v113, v3
    v_lshlrev_b32 v2, 16, v177
    v_and_b32 v3, 0xffff0000, v177
    v_add_f32 v114, v114, v2
    v_add_f32 v115, v115, v3
    v_lshlrev_b32 v2, 16, v178
    v_and_b32 v3, 0xffff0000, v178
    v_add_f32 v116, v116, v2
    v_add_f32 v117, v117, v3
    v_lshlrev_b32 v2, 16, v179
    v_and_b32 v3, 0xffff0000, v179
    v_add_f32 v118, v118, v2
    v_add_f32 v119, v119, v3
    v_cvt_pk_bf16_f32 v60, v112, v113
    v_cvt_pk_bf16_f32 v61, v114, v115
    v_cvt_pk_bf16_f32 v62, v116, v117
    v_cvt_pk_bf16_f32 v63, v118, v119
    s_add_u32 s73, s10, 41024
    s_nop 0
    v_permlane16_swap_b32 v60, v62
    v_permlane16_swap_b32 v61, v63
    buffer_store_dwordx4 v[60:63], v1, s[44:47], s73 offen offset:0 nt
    s_waitcnt vmcnt(1)
    v_lshlrev_b32 v2, 16, v180
    v_and_b32 v3, 0xffff0000, v180
    v_add_f32 v144, v144, v2
    v_add_f32 v145, v145, v3
    v_lshlrev_b32 v2, 16, v181
    v_and_b32 v3, 0xffff0000, v181
    v_add_f32 v146, v146, v2
    v_add_f32 v147, v147, v3
    v_lshlrev_b32 v2, 16, v182
    v_and_b32 v3, 0xffff0000, v182
    v_add_f32 v148, v148, v2
    v_add_f32 v149, v149, v3
    v_lshlrev_b32 v2, 16, v183
    v_and_b32 v3, 0xffff0000, v183
    v_add_f32 v150, v150, v2
    v_add_f32 v151, v151, v3
    v_lshlrev_b32 v2, 16, v184
    v_and_b32 v3, 0xffff0000, v184
    v_add_f32 v144, v144, v2
    v_add_f32 v145, v145, v3
    v_lshlrev_b32 v2, 16, v185
    v_and_b32 v3, 0xffff0000, v185
    v_add_f32 v146, v146, v2
    v_add_f32 v147, v147, v3
    v_lshlrev_b32 v2, 16, v186
    v_and_b32 v3, 0xffff0000, v186
    v_add_f32 v148, v148, v2
    v_add_f32 v149, v149, v3
    v_lshlrev_b32 v2, 16, v187
    v_and_b32 v3, 0xffff0000, v187
    v_add_f32 v150, v150, v2
    v_add_f32 v151, v151, v3
    v_lshlrev_b32 v2, 16, v188
    v_and_b32 v3, 0xffff0000, v188
    v_add_f32 v144, v144, v2
    v_add_f32 v145, v145, v3
    v_lshlrev_b32 v2, 16, v189
    v_and_b32 v3, 0xffff0000, v189
    v_add_f32 v146, v146, v2
    v_add_f32 v147, v147, v3
    v_lshlrev_b32 v2, 16, v190
    v_and_b32 v3, 0xffff0000, v190
    v_add_f32 v148, v148, v2
    v_add_f32 v149, v149, v3
    v_lshlrev_b32 v2, 16, v191
    v_and_b32 v3, 0xffff0000, v191
    v_add_f32 v150, v150, v2
    v_add_f32 v151, v151, v3
    v_cvt_pk_bf16_f32 v76, v144, v145
    v_cvt_pk_bf16_f32 v77, v146, v147
    v_cvt_pk_bf16_f32 v78, v148, v149
    v_cvt_pk_bf16_f32 v79, v150, v151
    s_add_u32 s73, s10, 41152
    s_nop 0
    v_permlane16_swap_b32 v76, v78
    v_permlane16_swap_b32 v77, v79
    buffer_store_dwordx4 v[76:79], v1, s[44:47], s73 offen offset:0 nt
K1_fe:
K1_pend:
K1_done:
    s_endpgm
K1_sp10:
    s_call_b64 s[96:97], K1_aspin
    s_branch K1_sp10b
K1_sp11:
    s_call_b64 s[96:97], K1_aspin
    s_branch K1_sp11b
K1_sp13:
    s_call_b64 s[96:97], K1_aspin
    s_branch K1_sp13b
K1_sp14:
    s_call_b64 s[96:97], K1_aspin
    s_branch K1_sp14b
K1_sl15:
    s_call_b64 s[96:97], K1_slow1x
    s_branch K1_sl15b
K1_sp17:
    s_call_b64 s[96:97], K1_aspin
    s_branch K1_sp17b
K1_sp18:
    s_call_b64 s[96:97], K1_aspin
    s_branch K1_sp18b
K1_sl19:
    s_call_b64 s[96:97], K1_slow0x
    s_branch K1_sl19b
K1_sp21:
    s_call_b64 s[96:97], K1_aspin
    s_branch K1_sp21b
K1_sp22:
    s_call_b64 s[96:97], K1_aspin
    s_branch K1_sp22b
K1_sl23:
    s_call_b64 s[96:97], K1_slow1x
    s_branch K1_sl23b
K1_sp25:
    s_call_b64 s[96:97], K1_aspin
    s_branch K1_sp25b
K1_sp26:
    s_call_b64 s[96:97], K1_aspin
    s_branch K1_sp26b
K1_sl27:
    s_call_b64 s[96:97], K1_slow0x
    s_branch K1_sl27b
K1_sp28:
    s_call_b64 s[96:97], K1_aspin
    s_branch K1_sp28b
K1_sl29:
    s_call_b64 s[96:97], K1_slow0x
    s_branch K1_sl29b
K1_sp30:
    s_call_b64 s[96:97], K1_aspin
    s_branch K1_sp30b
K1_sl31:
    s_call_b64 s[96:97], K1_slow1x
    s_branch K1_sl31b
K1_sp32:
    s_call_b64 s[96:97], K1_aspin
    s_branch K1_sp32b
K1_sp33:
    s_call_b64 s[96:97], K1_aspin
    s_branch K1_sp33b
K1_sp34:
    s_call_b64 s[96:97], K1_aspin
    s_branch K1_sp34b
K1_sp36:
    s_call_b64 s[96:97], K1_aspin
    s_branch K1_sp36b
K1_sp37:
    s_call_b64 s[96:97], K1_aspin
    s_branch K1_sp37b
K1_sl38:
    s_call_b64 s[96:97], K1_slow1
    s_branch K1_sl38b
K1_sp40:
    s_call_b64 s[96:97], K1_aspin
    s_branch K1_sp40b
K1_sp41:
    s_call_b64 s[96:97], K1_aspin
    s_branch K1_sp41b
K1_sl42:
    s_call_b64 s[96:97], K1_slow0
    s_branch K1_sl42b
K1_sp44:
    s_call_b64 s[96:97], K1_aspin
    s_branch K1_sp44b
K1_sp45:
    s_call_b64 s[96:97], K1_aspin
    s_branch K1_sp45b
K1_sl46:
    s_call_b64 s[96:97], K1_slow1
    s_branch K1_sl46b
K1_sp48:
    s_call_b64 s[96:97], K1_aspin
    s_branch K1_sp48b
K1_sp49:
    s_call_b64 s[96:97], K1_aspin
    s_branch K1_sp49b
K1_sl50:
    s_call_b64 s[96:97], K1_slow0
    s_branch K1_sl50b
K1_sp51:
    s_call_b64 s[96:97], K1_aspin
    s_branch K1_sp51b
K1_sl52:
    s_call_b64 s[96:97], K1_slow0
    s_branch K1_sl52b
K1_sp53:
    s_call_b64 s[96:97], K1_aspin
    s_branch K1_sp53b
K1_sl54:
    s_call_b64 s[96:97], K1_slow1
    s_branch K1_sl54b
K1_sp55:
    s_call_b64 s[96:97], K1_aspin
    s_branch K1_sp55b
K1_gs65:
    s_call_b64 s[96:97], K1_gspa
    s_branch K1_gs65b
K1_gs67:
    s_call_b64 s[96:97], K1_gspa
    s_branch K1_gs67b
K1_gs69:
    s_call_b64 s[96:97], K1_gspa
    s_branch K1_gs69b
K1_gs71:
    s_call_b64 s[96:97], K1_gspa
    s_branch K1_gs71b
K1_gs75:
    s_call_b64 s[96:97], K1_gspa
    s_branch K1_gs75b
K1_gs77:
    s_call_b64 s[96:97], K1_gspa
    s_branch K1_gs77b
K1_gs79:
    s_call_b64 s[96:97], K1_gspa
    s_branch K1_gs79b
K1_gs81:
    s_call_b64 s[96:97], K1_gspa
    s_branch K1_gs81b
K1_gs83:
    s_call_b64 s[96:97], K1_gspa
    s_branch K1_gs83b
K1_gs85:
    s_call_b64 s[96:97], K1_gspa
    s_branch K1_gs85b
K1_gs87:
    s_call_b64 s[96:97], K1_gspa
    s_branch K1_gs87b
K1_gs89:
    s_call_b64 s[96:97], K1_gspa
    s_branch K1_gs89b
K1_gs91:
    s_call_b64 s[96:97], K1_gspa
    s_branch K1_gs91b
K1_gs92:
    s_call_b64 s[96:97], K1_gspa
    s_branch K1_gs92b
K1_gs94:
    s_call_b64 s[96:97], K1_gspa
    s_branch K1_gs94b
K1_gs96:
    s_call_b64 s[96:97], K1_gspa
    s_branch K1_gs96b
K1_gs98:
    s_call_b64 s[96:97], K1_gspa
    s_branch K1_gs98b
K1_gs100:
    s_call_b64 s[96:97], K1_gspa
    s_branch K1_gs100b
K1_gs102:
    s_call_b64 s[96:97], K1_gspa
    s_branch K1_gs102b
K1_gs104:
    s_call_b64 s[96:97], K1_gspa
    s_branch K1_gs104b
K1_gs106:
    s_call_b64 s[96:97], K1_gspa
    s_branch K1_gs106b
K1_gs108:
    s_call_b64 s[96:97], K1_gspa
    s_branch K1_gs108b
K1_gs109:
    s_call_b64 s[96:97], K1_gspa
    s_branch K1_gs109b
K1_gs111:
    s_call_b64 s[96:97], K1_gspa
    s_branch K1_gs111b
K1_gs115:
    s_call_b64 s[96:97], K1_gspa
    s_branch K1_gs115b
K1_gs117:
    s_call_b64 s[96:97], K1_gspa
    s_branch K1_gs117b
K1_gs119:
    s_call_b64 s[96:97], K1_gspa
    s_branch K1_gs119b
K1_gs121:
    s_call_b64 s[96:97], K1_gspa
    s_branch K1_gs121b
K1_gs123:
    s_call_b64 s[96:97], K1_gspa
    s_branch K1_gs123b
K1_gs125:
    s_call_b64 s[96:97], K1_gspa
    s_branch K1_gs125b
K1_gs128:
    s_call_b64 s[96:97], K1_gspa
    s_branch K1_gs128b
K1_gs130:
    s_call_b64 s[96:97], K1_gspa
    s_branch K1_gs130b
K1_gs132:
    s_call_b64 s[96:97], K1_gspa
    s_branch K1_gs132b
K1_gs134:
    s_call_b64 s[96:97], K1_gspa
    s_branch K1_gs134b
K1_gs136:
    s_call_b64 s[96:97], K1_gspa
    s_branch K1_gs136b
K1_gs138:
    s_call_b64 s[96:97], K1_gspa
    s_branch K1_gs138b
K1_gs139:
    s_call_b64 s[96:97], K1_gspa
    s_branch K1_gs139b
K1_gs141:
    s_call_b64 s[96:97], K1_gspa
    s_branch K1_gs141b
K1_gs143:
    s_call_b64 s[96:97], K1_gspa
    s_branch K1_gs143b
K1_gs145:
    s_call_b64 s[96:97], K1_gspa
    s_branch K1_gs145b
K1_gs147:
    s_call_b64 s[96:97], K1_gspa
    s_branch K1_gs147b
K1_gs150:
    s_call_b64 s[96:97], K1_gspa
    s_branch K1_gs150b
K1_gs158:
    s_call_b64 s[96:97], K1_gspa
    s_branch K1_gs158b
K1_gs160:
    s_call_b64 s[96:97], K1_gspa
    s_branch K1_gs160b
K1_gs162:
    s_call_b64 s[96:97], K1_gspa
    s_branch K1_gs162b
K1_gs163:
    s_call_b64 s[96:97], K1_gspw
    s_branch K1_gs163b
K1_gs165:
    s_call_b64 s[96:97], K1_gspa
    s_branch K1_gs165b
K1_gs166:
    s_call_b64 s[96:97], K1_gspa
    s_branch K1_gs166b
K1_gs167:
    s_call_b64 s[96:97], K1_gspa
    s_branch K1_gs167b
K1_gs168:
    s_call_b64 s[96:97], K1_gspa
    s_branch K1_gs168b
K1_gs169:
    s_call_b64 s[96:97], K1_gspa
    s_branch K1_gs169b
K1_gs170:
    s_call_b64 s[96:97], K1_gspa
    s_branch K1_gs170b
K1_gs171:
    s_call_b64 s[96:97], K1_gspa
    s_branch K1_gs171b
K1_gs174:
    s_call_b64 s[96:97], K1_gspa
    s_branch K1_gs174b
K1_gs175:
    s_call_b64 s[96:97], K1_gspa
    s_branch K1_gs175b
K1_aspin:
    s_mov_b32 s66, 0
K1_aspinl:
    ds_read_b32 v254, v10 offset:64
    s_waitcnt lgkmcnt(0)
    v_cmp_gt_i32 vcc, v255, v254
    s_cbranch_vccz K1_aspind
    s_sleep 3
    s_add_u32 s66, s66, 1
    s_cmp_lt_u32 s66, 0x4000000
    s_cbranch_scc1 K1_aspinl
K1_aspind:
    s_setpc_b64 s[96:97]
K1_gspa:
    s_mov_b32 s66, 0
K1_gspal:
    ds_read_b32 v1, v7 offset:0
    s_waitcnt lgkmcnt(0)
    v_cmp_gt_i32 vcc, s71, v1
    s_cbranch_vccz K1_gspad
    s_sleep 3
    s_add_u32 s66, s66, 1
    s_cmp_lt_u32 s66, 0x4000000
    s_cbranch_scc1 K1_gspal
K1_gspad:
    s_setpc_b64 s[96:97]
K1_gspw:
    s_mov_b32 s66, 0
K1_gspwl:
    ds_read_b32 v2, v7 offset:128
    s_waitcnt lgkmcnt(0)
    v_cmp_gt_i32 vcc, s71, v2
    s_cbranch_vccz K1_gspwd
    s_sleep 3
    s_add_u32 s66, s66, 1
    s_cmp_lt_u32 s66, 0x4000000
    s_cbranch_scc1 K1_gspwl
K1_gspwd:
    s_setpc_b64 s[96:97]
K1_slow0:
    s_nop 15
    v_max3_f32 v2, v92, v93, v94
    v_max3_f32 v3, v95, v96, v97
    v_max3_f32 v2, v2, v98, v99
    v_max3_f32 v4, v100, v101, v102
    v_max3_f32 v5, v103, v104, v105
    v_max3_f32 v4, v4, v106, v107
    v_max_f32 v2, v2, v3
    v_mov_b32 v3, v2
    v_max_f32 v4, v4, v5
    v_mov_b32 v5, v4
    s_nop 1
    v_permlane32_swap_b32 v2, v3
    v_permlane32_swap_b32 v4, v5
    v_max_f32 v2, v2, v3
    v_mov_b32 v3, v2
    v_max_f32 v4, v4, v5
    v_mov_b32 v5, v4
    s_nop 1
    v_permlane16_swap_b32 v2, v3
    v_permlane16_swap_b32 v4, v5
    v_max_f32 v2, v2, v3
    v_max_f32 v4, v4, v5
    v_max_f32 v2, 0, v2
    v_exp_f32 v6, -v2
    v_mov_b32 v3, v2
    v_mov_b32 v7, v6
    v_pk_add_f32 v[92:93], v[92:93], v[2:3] neg_lo:[0,1] neg_hi:[0,1]
    v_pk_add_f32 v[94:95], v[94:95], v[2:3] neg_lo:[0,1] neg_hi:[0,1]
    v_pk_add_f32 v[96:97], v[96:97], v[2:3] neg_lo:[0,1] neg_hi:[0,1]
    v_pk_add_f32 v[98:99], v[98:99], v[2:3] neg_lo:[0,1] neg_hi:[0,1]
    v_pk_add_f32 v[108:109], v[108:109], v[2:3] neg_lo:[0,1] neg_hi:[0,1]
    v_pk_add_f32 v[110:111], v[110:111], v[2:3] neg_lo:[0,1] neg_hi:[0,1]
    v_pk_add_f32 v[112:113], v[112:113], v[2:3] neg_lo:[0,1] neg_hi:[0,1]
    v_pk_add_f32 v[114:115], v[114:115], v[2:3] neg_lo:[0,1] neg_hi:[0,1]
    v_pk_add_f32 v[124:125], v[124:125], v[2:3] neg_lo:[0,1] neg_hi:[0,1]
    v_pk_add_f32 v[126:127], v[126:127], v[2:3] neg_lo:[0,1] neg_hi:[0,1]
    v_mul_f32 v132, v6, v132
    v_mul_f32 v134, v6, v134
    v_pk_mul_f32 v[156:157], v[156:157], v[6:7]
    v_pk_mul_f32 v[158:159], v[158:159], v[6:7]
    v_pk_mul_f32 v[164:165], v[164:165], v[6:7]
    v_pk_mul_f32 v[166:167], v[166:167], v[6:7]
    v_pk_mul_f32 v[172:173], v[172:173], v[6:7]
    v_pk_mul_f32 v[174:175], v[174:175], v[6:7]
    v_pk_mul_f32 v[180:181], v[180:181], v[6:7]
    v_pk_mul_f32 v[182:183], v[182:183], v[6:7]
    v_pk_mul_f32 v[188:189], v[188:189], v[6:7]
    v_pk_mul_f32 v[190:191], v[190:191], v[6:7]
    v_pk_mul_f32 v[196:197], v[196:197], v[6:7]
    v_pk_mul_f32 v[198:199], v[198:199], v[6:7]
    v_pk_mul_f32 v[204:205], v[204:205], v[6:7]
    v_pk_mul_f32 v[206:207], v[206:207], v[6:7]
    v_pk_mul_f32 v[212:213], v[212:213], v[6:7]
    v_pk_mul_f32 v[214:215], v[214:215], v[6:7]
    v_pk_mul_f32 v[220:221], v[220:221], v[6:7]
    v_pk_mul_f32 v[222:223], v[222:223], v[6:7]
    v_pk_mul_f32 v[228:229], v[228:229], v[6:7]
    v_pk_mul_f32 v[230:231], v[230:231], v[6:7]
    v_pk_mul_f32 v[236:237], v[236:237], v[6:7]
    v_pk_mul_f32 v[238:239], v[238:239], v[6:7]
    v_pk_mul_f32 v[244:245], v[244:245], v[6:7]
    v_pk_mul_f32 v[246:247], v[246:247], v[6:7]
    v_max_f32 v4, 0, v4
    v_exp_f32 v8, -v4
    v_mov_b32 v5, v4
    v_mov_b32 v9, v8
    v_pk_add_f32 v[100:101], v[100:101], v[4:5] neg_lo:[0,1] neg_hi:[0,1]
    v_pk_add_f32 v[102:103], v[102:103], v[4:5] neg_lo:[0,1] neg_hi:[0,1]
    v_pk_add_f32 v[104:105], v[104:105], v[4:5] neg_lo:[0,1] neg_hi:[0,1]
    v_pk_add_f32 v[106:107], v[106:107], v[4:5] neg_lo:[0,1] neg_hi:[0,1]
    v_pk_add_f32 v[116:117], v[116:117], v[4:5] neg_lo:[0,1] neg_hi:[0,1]
    v_pk_add_f32 v[118:119], v[118:119], v[4:5] neg_lo:[0,1] neg_hi:[0,1]
    v_pk_add_f32 v[120:121], v[120:121], v[4:5] neg_lo:[0,1] neg_hi:[0,1]
    v_pk_add_f32 v[122:123], v[122:123], v[4:5] neg_lo:[0,1] neg_hi:[0,1]
    v_pk_add_f32 v[128:129], v[128:129], v[4:5] neg_lo:[0,1] neg_hi:[0,1]
    v_pk_add_f32 v[130:131], v[130:131], v[4:5] neg_lo:[0,1] neg_hi:[0,1]
    v_mul_f32 v133, v8, v133
    v_mul_f32 v135, v8, v135
    v_pk_mul_f32 v[160:161], v[160:161], v[8:9]
    v_pk_mul_f32 v[162:163], v[162:163], v[8:9]
    v_pk_mul_f32 v[168:169], v[168:169], v[8:9]
    v_pk_mul_f32 v[170:171], v[170:171], v[8:9]
    v_pk_mul_f32 v[176:177], v[176:177], v[8:9]
    v_pk_mul_f32 v[178:179], v[178:179], v[8:9]
    v_pk_mul_f32 v[184:185], v[184:185], v[8:9]
    v_pk_mul_f32 v[186:187], v[186:187], v[8:9]
    v_pk_mul_f32 v[192:193], v[192:193], v[8:9]
    v_pk_mul_f32 v[194:195], v[194:195], v[8:9]
    v_pk_mul_f32 v[200:201], v[200:201], v[8:9]
    v_pk_mul_f32 v[202:203], v[202:203], v[8:9]
    v_pk_mul_f32 v[208:209], v[208:209], v[8:9]
    v_pk_mul_f32 v[210:211], v[210:211], v[8:9]
    v_pk_mul_f32 v[216:217], v[216:217], v[8:9]
    v_pk_mul_f32 v[218:219], v[218:219], v[8:9]
    v_pk_mul_f32 v[224:225], v[224:225], v[8:9]
    v_pk_mul_f32 v[226:227], v[226:227], v[8:9]
    v_pk_mul_f32 v[232:233], v[232:233], v[8:9]
    v_pk_mul_f32 v[234:235], v[234:235], v[8:9]
    v_pk_mul_f32 v[240:241], v[240:241], v[8:9]
    v_pk_mul_f32 v[242:243], v[242:243], v[8:9]
    v_pk_mul_f32 v[248:249], v[248:249], v[8:9]
    v_pk_mul_f32 v[250:251], v[250:251], v[8:9]
    v_exp_f32 v2, v92
    v_exp_f32 v3, v93
    v_exp_f32 v4, v94
    v_exp_f32 v5, v95
    v_cvt_pk_bf16_f32 v140, v2, v3
    v_add_f32 v132, v134, v2
    v_add_f32 v132, v132, v3
    v_exp_f32 v252, v96
    v_exp_f32 v253, v97
    v_cvt_pk_bf16_f32 v141, v4, v5
    v_add_f32 v132, v132, v4
    v_add_f32 v132, v132, v5
    v_exp_f32 v2, v98
    v_exp_f32 v3, v99
    v_cvt_pk_bf16_f32 v142, v252, v253
    v_add_f32 v132, v132, v252
    v_add_f32 v132, v132, v253
    v_exp_f32 v4, v100
    v_exp_f32 v5, v101
    v_cvt_pk_bf16_f32 v143, v2, v3
    v_add_f32 v132, v132, v2
    v_add_f32 v132, v132, v3
    v_exp_f32 v252, v102
    v_exp_f32 v253, v103
    v_cvt_pk_bf16_f32 v144, v4, v5
    v_add_f32 v133, v135, v4
    v_add_f32 v133, v133, v5
    v_exp_f32 v2, v104
    v_exp_f32 v3, v105
    v_cvt_pk_bf16_f32 v145, v252, v253
    v_add_f32 v133, v133, v252
    v_add_f32 v133, v133, v253
    v_exp_f32 v4, v106
    v_exp_f32 v5, v107
    v_cvt_pk_bf16_f32 v146, v2, v3
    v_add_f32 v133, v133, v2
    v_add_f32 v133, v133, v3
    v_cvt_pk_bf16_f32 v147, v4, v5
    v_add_f32 v133, v133, v4
    v_add_f32 v133, v133, v5
    s_nop 1
    s_setpc_b64 s[96:97]
K1_slow1:
    s_nop 15
    v_max3_f32 v2, v108, v109, v110
    v_max3_f32 v3, v111, v112, v113
    v_max3_f32 v2, v2, v114, v115
    v_max3_f32 v4, v116, v117, v118
    v_max3_f32 v5, v119, v120, v121
    v_max3_f32 v4, v4, v122, v123
    v_max_f32 v2, v2, v3
    v_mov_b32 v3, v2
    v_max_f32 v4, v4, v5
    v_mov_b32 v5, v4
    s_nop 1
    v_permlane32_swap_b32 v2, v3
    v_permlane32_swap_b32 v4, v5
    v_max_f32 v2, v2, v3
    v_mov_b32 v3, v2
    v_max_f32 v4, v4, v5
    v_mov_b32 v5, v4
    s_nop 1
    v_permlane16_swap_b32 v2, v3
    v_permlane16_swap_b32 v4, v5
    v_max_f32 v2, v2, v3
    v_max_f32 v4, v4, v5
    v_max_f32 v2, 0, v2
    v_exp_f32 v6, -v2
    v_mov_b32 v3, v2
    v_mov_b32 v7, v6
    v_pk_add_f32 v[92:93], v[92:93], v[2:3] neg_lo:[0,1] neg_hi:[0,1]
    v_pk_add_f32 v[94:95], v[94:95], v[2:3] neg_lo:[0,1] neg_hi:[0,1]
    v_pk_add_f32 v[96:97], v[96:97], v[2:3] neg_lo:[0,1] neg_hi:[0,1]
    v_pk_add_f32 v[98:99], v[98:99], v[2:3] neg_lo:[0,1] neg_hi:[0,1]
    v_pk_add_f32 v[108:109], v[108:109], v[2:3] neg_lo:[0,1] neg_hi:[0,1]
    v_pk_add_f32 v[110:111], v[110:111], v[2:3] neg_lo:[0,1] neg_hi:[0,1]
    v_pk_add_f32 v[112:113], v[112:113], v[2:3] neg_lo:[0,1] neg_hi:[0,1]
    v_pk_add_f32 v[114:115], v[114:115], v[2:3] neg_lo:[0,1] neg_hi:[0,1]
    v_pk_add_f32 v[124:125], v[124:125], v[2:3] neg_lo:[0,1] neg_hi:[0,1]
    v_pk_add_f32 v[126:127], v[126:127], v[2:3] neg_lo:[0,1] neg_hi:[0,1]
    v_mul_f32 v132, v6, v132
    v_mul_f32 v134, v6, v134
    v_pk_mul_f32 v[156:157], v[156:157], v[6:7]
    v_pk_mul_f32 v[158:159], v[158:159], v[6:7]
    v_pk_mul_f32 v[164:165], v[164:165], v[6:7]
    v_pk_mul_f32 v[166:167], v[166:167], v[6:7]
    v_pk_mul_f32 v[172:173], v[172:173], v[6:7]
    v_pk_mul_f32 v[174:175], v[174:175], v[6:7]
    v_pk_mul_f32 v[180:181], v[180:181], v[6:7]
    v_pk_mul_f32 v[182:183], v[182:183], v[6:7]
    v_pk_mul_f32 v[188:189], v[188:189], v[6:7]
    v_pk_mul_f32 v[190:191], v[190:191], v[6:7]
    v_pk_mul_f32 v[196:197], v[196:197], v[6:7]
    v_pk_mul_f32 v[198:199], v[198:199], v[6:7]
    v_pk_mul_f32 v[204:205], v[204:205], v[6:7]
    v_pk_mul_f32 v[206:207], v[206:207], v[6:7]
    v_pk_mul_f32 v[212:213], v[212:213], v[6:7]
    v_pk_mul_f32 v[214:215], v[214:215], v[6:7]
    v_pk_mul_f32 v[220:221], v[220:221], v[6:7]
    v_pk_mul_f32 v[222:223], v[222:223], v[6:7]
    v_pk_mul_f32 v[228:229], v[228:229], v[6:7]
    v_pk_mul_f32 v[230:231], v[230:231], v[6:7]
    v_pk_mul_f32 v[236:237], v[236:237], v[6:7]
    v_pk_mul_f32 v[238:239], v[238:239], v[6:7]
    v_pk_mul_f32 v[244:245], v[244:245], v[6:7]
    v_pk_mul_f32 v[246:247], v[246:247], v[6:7]
    v_max_f32 v4, 0, v4
    v_exp_f32 v8, -v4
    v_mov_b32 v5, v4
    v_mov_b32 v9, v8
    v_pk_add_f32 v[100:101], v[100:101], v[4:5] neg_lo:[0,1] neg_hi:[0,1]
    v_pk_add_f32 v[102:103], v[102:103], v[4:5] neg_lo:[0,1] neg_hi:[0,1]
    v_pk_add_f32 v[104:105], v[104:105], v[4:5] neg_lo:[0,1] neg_hi:[0,1]
    v_pk_add_f32 v[106:107], v[106:107], v[4:5] neg_lo:[0,1] neg_hi:[0,1]
    v_pk_add_f32 v[116:117], v[116:117], v[4:5] neg_lo:[0,1] neg_hi:[0,1]
    v_pk_add_f32 v[118:119], v[118:119], v[4:5] neg_lo:[0,1] neg_hi:[0,1]
    v_pk_add_f32 v[120:121], v[120:121], v[4:5] neg_lo:[0,1] neg_hi:[0,1]
    v_pk_add_f32 v[122:123], v[122:123], v[4:5] neg_lo:[0,1] neg_hi:[0,1]
    v_pk_add_f32 v[128:129], v[128:129], v[4:5] neg_lo:[0,1] neg_hi:[0,1]
    v_pk_add_f32 v[130:131], v[130:131], v[4:5] neg_lo:[0,1] neg_hi:[0,1]
    v_mul_f32 v133, v8, v133
    v_mul_f32 v135, v8, v135
    v_pk_mul_f32 v[160:161], v[160:161], v[8:9]
    v_pk_mul_f32 v[162:163], v[162:163], v[8:9]
    v_pk_mul_f32 v[168:169], v[168:169], v[8:9]
    v_pk_mul_f32 v[170:171], v[170:171], v[8:9]
    v_pk_mul_f32 v[176:177], v[176:177], v[8:9]
    v_pk_mul_f32 v[178:179], v[178:179], v[8:9]
    v_pk_mul_f32 v[184:185], v[184:185], v[8:9]
    v_pk_mul_f32 v[186:187], v[186:187], v[8:9]
    v_pk_mul_f32 v[192:193], v[192:193], v[8:9]
    v_pk_mul_f32 v[194:195], v[194:195], v[8:9]
    v_pk_mul_f32 v[200:201], v[200:201], v[8:9]
    v_pk_mul_f32 v[202:203], v[202:203], v[8:9]
    v_pk_mul_f32 v[208:209], v[208:209], v[8:9]
    v_pk_mul_f32 v[210:211], v[210:211], v[8:9]
    v_pk_mul_f32 v[216:217], v[216:217], v[8:9]
    v_pk_mul_f32 v[218:219], v[218:219], v[8:9]
    v_pk_mul_f32 v[224:225], v[224:225], v[8:9]
    v_pk_mul_f32 v[226:227], v[226:227], v[8:9]
    v_pk_mul_f32 v[232:233], v[232:233], v[8:9]
    v_pk_mul_f32 v[234:235], v[234:235], v[8:9]
    v_pk_mul_f32 v[240:241], v[240:241], v[8:9]
    v_pk_mul_f32 v[242:243], v[242:243], v[8:9]
    v_pk_mul_f32 v[248:249], v[248:249], v[8:9]
    v_pk_mul_f32 v[250:251], v[250:251], v[8:9]
    v_exp_f32 v2, v108
    v_exp_f32 v3, v109
    v_exp_f32 v4, v110
    v_exp_f32 v5, v111
    v_cvt_pk_bf16_f32 v148, v2, v3
    v_add_f32 v134, v132, v2
    v_add_f32 v134, v134, v3
    v_exp_f32 v252, v112
    v_exp_f32 v253, v113
    v_cvt_pk_bf16_f32 v149, v4, v5
    v_add_f32 v134, v134, v4
    v_add_f32 v134, v134, v5
    v_exp_f32 v2, v114
    v_exp_f32 v3, v115
    v_cvt_pk_bf16_f32 v150, v252, v253
    v_add_f32 v134, v134, v252
    v_add_f32 v134, v134, v253
    v_exp_f32 v4, v116
    v_exp_f32 v5, v117
    v_cvt_pk_bf16_f32 v151, v2, v3
    v_add_f32 v134, v134, v2
    v_add_f32 v134, v134, v3
    v_exp_f32 v252, v118
    v_exp_f32 v253, v119
    v_cvt_pk_bf16_f32 v152, v4, v5
    v_add_f32 v135, v133, v4
    v_add_f32 v135, v135, v5
    v_exp_f32 v2, v120
    v_exp_f32 v3, v121
    v_cvt_pk_bf16_f32 v153, v252, v253
    v_add_f32 v135, v135, v252
    v_add_f32 v135, v135, v253
    v_exp_f32 v4, v122
    v_exp_f32 v5, v123
    v_cvt_pk_bf16_f32 v154, v2, v3
    v_add_f32 v135, v135, v2
    v_add_f32 v135, v135, v3
    v_cvt_pk_bf16_f32 v155, v4, v5
    v_add_f32 v135, v135, v4
    v_add_f32 v135, v135, v5
    s_nop 1
    s_setpc_b64 s[96:97]
K1_slow0x:
    s_nop 15
    v_max3_f32 v2, v92, v93, v94
    v_max3_f32 v3, v95, v96, v97
    v_max3_f32 v2, v2, v98, v99
    v_max_f32 v2, v2, v3
    v_mov_b32 v3, v2
    s_nop 1
    v_permlane32_swap_b32 v2, v3
    v_max_f32 v2, v2, v3
    v_mov_b32 v3, v2
    s_nop 1
    v_permlane16_swap_b32 v2, v3
    v_max_f32 v2, v2, v3
    v_max_f32 v2, 0, v2
    v_exp_f32 v6, -v2
    v_mov_b32 v3, v2
    v_mov_b32 v7, v6
    v_pk_add_f32 v[92:93], v[92:93], v[2:3] neg_lo:[0,1] neg_hi:[0,1]
    v_pk_add_f32 v[94:95], v[94:95], v[2:3] neg_lo:[0,1] neg_hi:[0,1]
    v_pk_add_f32 v[96:97], v[96:97], v[2:3] neg_lo:[0,1] neg_hi:[0,1]
    v_pk_add_f32 v[98:99], v[98:99], v[2:3] neg_lo:[0,1] neg_hi:[0,1]
    v_pk_add_f32 v[108:109], v[108:109], v[2:3] neg_lo:[0,1] neg_hi:[0,1]
    v_pk_add_f32 v[110:111], v[110:111], v[2:3] neg_lo:[0,1] neg_hi:[0,1]
    v_pk_add_f32 v[112:113], v[112:113], v[2:3] neg_lo:[0,1] neg_hi:[0,1]
    v_pk_add_f32 v[114:115], v[114:115], v[2:3] neg_lo:[0,1] neg_hi:[0,1]
    v_pk_add_f32 v[124:125], v[124:125], v[2:3] neg_lo:[0,1] neg_hi:[0,1]
    v_pk_add_f32 v[126:127], v[126:127], v[2:3] neg_lo:[0,1] neg_hi:[0,1]
    v_mul_f32 v132, v6, v132
    v_mul_f32 v134, v6, v134
    v_pk_mul_f32 v[156:157], v[156:157], v[6:7]
    v_pk_mul_f32 v[158:159], v[158:159], v[6:7]
    v_pk_mul_f32 v[164:165], v[164:165], v[6:7]
    v_pk_mul_f32 v[166:167], v[166:167], v[6:7]
    v_pk_mul_f32 v[172:173], v[172:173], v[6:7]
    v_pk_mul_f32 v[174:175], v[174:175], v[6:7]
    v_pk_mul_f32 v[180:181], v[180:181], v[6:7]
    v_pk_mul_f32 v[182:183], v[182:183], v[6:7]
    v_pk_mul_f32 v[188:189], v[188:189], v[6:7]
    v_pk_mul_f32 v[190:191], v[190:191], v[6:7]
    v_pk_mul_f32 v[196:197], v[196:197], v[6:7]
    v_pk_mul_f32 v[198:199], v[198:199], v[6:7]
    v_pk_mul_f32 v[204:205], v[204:205], v[6:7]
    v_pk_mul_f32 v[206:207], v[206:207], v[6:7]
    v_pk_mul_f32 v[212:213], v[212:213], v[6:7]
    v_pk_mul_f32 v[214:215], v[214:215], v[6:7]
    v_pk_mul_f32 v[220:221], v[220:221], v[6:7]
    v_pk_mul_f32 v[222:223], v[222:223], v[6:7]
    v_pk_mul_f32 v[228:229], v[228:229], v[6:7]
    v_pk_mul_f32 v[230:231], v[230:231], v[6:7]
    v_pk_mul_f32 v[236:237], v[236:237], v[6:7]
    v_pk_mul_f32 v[238:239], v[238:239], v[6:7]
    v_pk_mul_f32 v[244:245], v[244:245], v[6:7]
    v_pk_mul_f32 v[246:247], v[246:247], v[6:7]
    v_exp_f32 v2, v92
    v_exp_f32 v3, v93
    v_exp_f32 v4, v94
    v_exp_f32 v5, v95
    v_cvt_pk_bf16_f32 v140, v2, v3
    v_add_f32 v132, v134, v2
    v_add_f32 v132, v132, v3
    v_exp_f32 v252, v96
    v_exp_f32 v253, v97
    v_cvt_pk_bf16_f32 v141, v4, v5
    v_add_f32 v132, v132, v4
    v_add_f32 v132, v132, v5
    v_exp_f32 v2, v98
    v_exp_f32 v3, v99
    v_cvt_pk_bf16_f32 v142, v252, v253
    v_add_f32 v132, v132, v252
    v_add_f32 v132, v132, v253
    v_cvt_pk_bf16_f32 v143, v2, v3
    v_add_f32 v132, v132, v2
    v_add_f32 v132, v132, v3
    s_nop 1
    s_setpc_b64 s[96:97]
K1_slow1x:
    s_nop 15
    v_max3_f32 v2, v108, v109, v110
    v_max3_f32 v3, v111, v112, v113
    v_max3_f32 v2, v2, v114, v115
    v_max_f32 v2, v2, v3
    v_mov_b32 v3, v2
    s_nop 1
    v_permlane32_swap_b32 v2, v3
    v_max_f32 v2, v2, v3
    v_mov_b32 v3, v2
    s_nop 1
    v_permlane16_swap_b32 v2, v3
    v_max_f32 v2, v2, v3
    v_max_f32 v2, 0, v2
    v_exp_f32 v6, -v2
    v_mov_b32 v3, v2
    v_mov_b32 v7, v6
    v_pk_add_f32 v[92:93], v[92:93], v[2:3] neg_lo:[0,1] neg_hi:[0,1]
    v_pk_add_f32 v[94:95], v[94:95], v[2:3] neg_lo:[0,1] neg_hi:[0,1]
    v_pk_add_f32 v[96:97], v[96:97], v[2:3] neg_lo:[0,1] neg_hi:[0,1]
    v_pk_add_f32 v[98:99], v[98:99], v[2:3] neg_lo:[0,1] neg_hi:[0,1]
    v_pk_add_f32 v[108:109], v[108:109], v[2:3] neg_lo:[0,1] neg_hi:[0,1]
    v_pk_add_f32 v[110:111], v[110:111], v[2:3] neg_lo:[0,1] neg_hi:[0,1]
    v_pk_add_f32 v[112:113], v[112:113], v[2:3] neg_lo:[0,1] neg_hi:[0,1]
    v_pk_add_f32 v[114:115], v[114:115], v[2:3] neg_lo:[0,1] neg_hi:[0,1]
    v_pk_add_f32 v[124:125], v[124:125], v[2:3] neg_lo:[0,1] neg_hi:[0,1]
    v_pk_add_f32 v[126:127], v[126:127], v[2:3] neg_lo:[0,1] neg_hi:[0,1]
    v_mul_f32 v132, v6, v132
    v_mul_f32 v134, v6, v134
    v_pk_mul_f32 v[156:157], v[156:157], v[6:7]
    v_pk_mul_f32 v[158:159], v[158:159], v[6:7]
    v_pk_mul_f32 v[164:165], v[164:165], v[6:7]
    v_pk_mul_f32 v[166:167], v[166:167], v[6:7]
    v_pk_mul_f32 v[172:173], v[172:173], v[6:7]
    v_pk_mul_f32 v[174:175], v[174:175], v[6:7]
    v_pk_mul_f32 v[180:181], v[180:181], v[6:7]
    v_pk_mul_f32 v[182:183], v[182:183], v[6:7]
    v_pk_mul_f32 v[188:189], v[188:189], v[6:7]
    v_pk_mul_f32 v[190:191], v[190:191], v[6:7]
    v_pk_mul_f32 v[196:197], v[196:197], v[6:7]
    v_pk_mul_f32 v[198:199], v[198:199], v[6:7]
    v_pk_mul_f32 v[204:205], v[204:205], v[6:7]
    v_pk_mul_f32 v[206:207], v[206:207], v[6:7]
    v_pk_mul_f32 v[212:213], v[212:213], v[6:7]
    v_pk_mul_f32 v[214:215], v[214:215], v[6:7]
    v_pk_mul_f32 v[220:221], v[220:221], v[6:7]
    v_pk_mul_f32 v[222:223], v[222:223], v[6:7]
    v_pk_mul_f32 v[228:229], v[228:229], v[6:7]
    v_pk_mul_f32 v[230:231], v[230:231], v[6:7]
    v_pk_mul_f32 v[236:237], v[236:237], v[6:7]
    v_pk_mul_f32 v[238:239], v[238:239], v[6:7]
    v_pk_mul_f32 v[244:245], v[244:245], v[6:7]
    v_pk_mul_f32 v[246:247], v[246:247], v[6:7]
    v_exp_f32 v2, v108
    v_exp_f32 v3, v109
    v_exp_f32 v4, v110
    v_exp_f32 v5, v111
    v_cvt_pk_bf16_f32 v148, v2, v3
    v_add_f32 v134, v132, v2
    v_add_f32 v134, v134, v3
    v_exp_f32 v252, v112
    v_exp_f32 v253, v113
    v_cvt_pk_bf16_f32 v149, v4, v5
    v_add_f32 v134, v134, v4
    v_add_f32 v134, v134, v5
    v_exp_f32 v2, v114
    v_exp_f32 v3, v115
    v_cvt_pk_bf16_f32 v150, v252, v253
    v_add_f32 v134, v134, v252
    v_add_f32 v134, v134, v253
    v_cvt_pk_bf16_f32 v151, v2, v3
    v_add_f32 v134, v134, v2
    v_add_f32 v134, v134, v3
    s_nop 1
    s_setpc_b64 s[96:97]
K1_codeend:
.section .rodata,"a"
.p2align 6
.amdhsa_kernel concat_heads__gqa_block_cached__mha_block_cached__near_ridge_kernel
  .amdhsa_next_free_vgpr 256
  .amdhsa_next_free_sgpr 102
  .amdhsa_accum_offset 256
  .amdhsa_group_segment_fixed_size 0
  .amdhsa_kernarg_size 104
  .amdhsa_user_sgpr_count 2
  .amdhsa_user_sgpr_kernarg_segment_ptr 1
  .amdhsa_system_sgpr_workgroup_id_x 1
.end_amdhsa_kernel
```
